```python
import torch

def _softmax(x, axis=-1):
    return torch.softmax(x, dim=axis)
def _gelu(x):
    return torch.nn.functional.gelu(x, approximate="tanh")
def _silu(x):
    return torch.nn.functional.silu(x)
def _sigmoid(x):
    return torch.sigmoid(x)
def _layernorm(x, axis=-1, eps=1e-5):
    m = x.mean(dim=axis, keepdim=True)
    v = x.var(dim=axis, keepdim=True, unbiased=False)
    return (x - m) / torch.sqrt(v + eps)
def _scatter_add(tgt, idx, src, axis=0):
    return tgt.clone().index_add_(axis, idx, src)
def _segment_sum(src, seg, n):
    out = torch.zeros((n,) + src.shape[1:], dtype=src.dtype)
    return out.index_add_(0, seg, src)
def _pad(x, pw):
    flat = tuple(v for pair in reversed(pw) for v in pair)
    return torch.nn.functional.pad(x, flat)

kernel_name = 'gated_mix__grouped_kv_mqa__moe_arch_mod__prompt'

def setup_inputs():

    _w = (lambda a: (lambda t: t.to(torch.bfloat16) if t.is_floating_point() else t)(torch.as_tensor(a)))
    def _A_setup():
        B, S, D, H = 1, 2048, 576, 32
        Dh = D // H
        return {
            "x": _w((lambda *s: torch.randn(*s, dtype=torch.bfloat16) * 0.05)(B, S, D)),
            "wq": _w((lambda *s: torch.randn(*s, dtype=torch.bfloat16) * 0.8)(D, H * Dh)),
            "wk": _w((lambda *s: torch.randn(*s, dtype=torch.bfloat16) * 0.8)(D, Dh)),
            "wv": _w((lambda *s: torch.randn(*s, dtype=torch.bfloat16) * 0.2)(D, Dh)),
            "wo": _w((lambda *s: torch.randn(*s, dtype=torch.bfloat16) * 0.2)(H * Dh, D)),
        }
    _A_in = _A_setup()

    def _B_setup():
        B, S, D, F, C = 1, 2048, 576, 4608, 2
        return {
            "x": _w((lambda *s: torch.randn(*s, dtype=torch.bfloat16) * 0.05)(B, S, D)),
            "w_r": _w((lambda *s: torch.randn(*s, dtype=torch.bfloat16) * 1.6)(D)),
            "w_gate": _w((lambda *s: torch.randn(*s, dtype=torch.bfloat16) * 0.1)(D, F)),
            "w_up": _w((lambda *s: torch.randn(*s, dtype=torch.bfloat16) * 0.1)(D, F)),
            "w_down": _w((lambda *s: torch.randn(*s, dtype=torch.bfloat16) * 0.1)(F, D)),
        }
    _B_in = _B_setup()

    return {
        "A_x": _A_in["x"],
        "A_wq": _A_in["wq"],
        "A_wk": _A_in["wk"],
        "A_wv": _A_in["wv"],
        "A_wo": _A_in["wo"],
        "B_x": _B_in["x"],
        "B_w_r": _B_in["w_r"],
        "B_w_gate": _B_in["w_gate"],
        "B_w_up": _B_in["w_up"],
        "B_w_down": _B_in["w_down"],
        "gate_w": _w((lambda *s: torch.randn(*s, dtype=torch.bfloat16) * 0.05)(576) * 16.0),
    }

def reference(A_x, A_wq, A_wk, A_wv, A_wo, B_x, B_w_r, B_w_gate, B_w_up, B_w_down, gate_w):
    def _A_ref(x, wq, wk, wv, wo):
        B, S, D = x.shape
        H = 32
        Dh = D // H
        q = (lambda x, *d: x.permute(*d))((x @ wq).reshape(B, S, H, Dh), 0, 2, 1, 3)
        k = x @ wk
        v = x @ wv
        scores = torch.einsum("bhqd,bkd->bhqk", q, k) * (Dh ** -0.5)
        p = _softmax(scores, axis=-1)
        o = torch.einsum("bhqk,bkd->bhqd", p, v)
        return (lambda x, *d: x.permute(*d))(o, 0, 2, 1, 3).reshape(B, S, H * Dh) @ wo

    def _B_ref(x, w_r, w_gate, w_up, w_down):
        B, S, D = x.shape
        C = 2
        r = x @ w_r
        idx = torch.argsort(-r, axis=-1)[:, :C]
        idx_e = (lambda x, n, axis: torch.repeat_interleave(x, n, dim=axis))(idx.reshape(B, C, 1), D, axis=2)
        x_sel = (lambda x, i, axis: torch.take_along_dim(x, i, dim=axis))(x, idx_e, axis=1)
        g = _silu(x_sel @ w_gate)
        u = x_sel @ w_up
        y = (g * u) @ w_down
        r_sel = _sigmoid((lambda x, i, axis: torch.take_along_dim(x, i, dim=axis))(r, idx, axis=1))
        y = y * r_sel.reshape(B, C, 1)
        b_off = (torch.arange(B) * S).reshape(B, 1)
        flat_idx = (idx + b_off).reshape(B * C)
        zero = (x * 0.0).reshape(B * S, D)
        upd = _scatter_add(zero, flat_idx, y.reshape(B * C, D), axis=0)
        return x + upd.reshape(B, S, D)

    x = A_x
    g = _sigmoid((x * gate_w).sum(-1, keepdims=True))
    a = _A_ref(x, A_wq, A_wk, A_wv, A_wo)
    b = _B_ref(x, B_w_r, B_w_gate, B_w_up, B_w_down)
    return g * a + (1 - g) * b
```

```asm
; @launch grid=(256,1,1) block=(768,1,1) lds=163840
.amdgcn_target "amdgcn-amd-amdhsa--gfx950"
.text
.globl gated_mix__grouped_kv_mqa__moe_arch_mod__prompt_kernel
.p2align 8
.type gated_mix__grouped_kv_mqa__moe_arch_mod__prompt_kernel,@function
gated_mix__grouped_kv_mqa__moe_arch_mod__prompt_kernel:
    s_cmp_ge_u32 s2, 256
    s_cbranch_scc1 L_end
    s_load_dwordx8 s[4:11], s[0:1], 0
    s_load_dwordx8 s[12:19], s[0:1], 32
    s_load_dwordx4 s[20:23], s[0:1], 64
    s_load_dwordx8 s[24:31], s[0:1], 80
    v_lshrrev_b32 v1, 6, v0
    v_and_b32 v156, 63, v0
    v_readfirstlane_b32 s33, v1
    s_and_b32 s36, s2, 7
    s_lshr_b32 s37, s2, 3
    s_and_b32 s35, s37, 7
    s_lshr_b32 s37, s37, 3
    s_lshl_b32 s36, s36, 2
    s_add_u32 s34, s36, s37
    s_lshl_b32 s41, s34, 6
    s_waitcnt lgkmcnt(0)
    s_mov_b32 s44, s4
    s_and_b32 s45, s5, 0xffff
    s_mov_b32 s46, 2359296
    s_mov_b32 s47, 0x20000
    s_mov_b32 s48, s6
    s_and_b32 s49, s7, 0xffff
    s_mov_b32 s50, 663552
    s_mov_b32 s51, 0x20000
    s_mov_b32 s52, s30
    s_and_b32 s53, s31, 0xffff
    s_mov_b32 s54, 2592768
    s_mov_b32 s55, 0x20000
    s_mov_b32 s60, s30
    s_and_b32 s61, s31, 0xffff
    s_mov_b32 s62, 151552
    s_mov_b32 s63, 0x20000
    s_mov_b32 s64, s26
    s_and_b32 s65, s27, 0xffff
    s_mov_b32 s66, 2359296
    s_mov_b32 s67, 0x20000
    s_mov_b32 s68, s28
    s_and_b32 s69, s29, 0xffff
    s_mov_b32 s70, 256
    s_mov_b32 s71, 0x20000
    s_cmp_ge_u32 s33, 8
    s_cbranch_scc1 L_helper_1
    s_and_b32 s39, s33, 3
    s_lshr_b32 s40, s33, 2
    v_and_b32 v159, 15, v156
    v_lshrrev_b32 v160, 4, v156
    v_and_b32 v157, 31, v156
    v_lshrrev_b32 v158, 5, v156
    v_mov_b32 v72, 163584
    v_mov_b32 v74, 0
    v_mov_b32 v75, 0
    v_mov_b32 v76, 0
    v_mov_b32 v77, 0
    ds_write_b128 v72, v[74:77]
    ds_write_b128 v72, v[74:77] offset:16
    s_cmp_lg_u32 s35, 7
    s_cbranch_scc1 L_noclr_2
    s_cmp_lg_u32 s33, 0
    s_cbranch_scc1 L_noclr_2
    v_mov_b32 v74, 0
    v_mov_b32 v75, 0
    v_mov_b32 v76, 0
    v_mov_b32 v77, 0
    s_lshl_b32 s36, s34, 10
    s_add_u32 s36, s36, 197888
    v_lshlrev_b32 v72, 4, v156
    buffer_store_dwordx4 v[74:77], v72, s[52:55], s36 offen sc1
    s_mov_b32 s36, 230656
    s_cmp_eq_u32 s34, 0
    s_cbranch_scc0 L_noffc_3
    s_mov_b64 exec, 1
    buffer_store_dwordx4 v[74:77], v72, s[52:55], s36 offen sc1
L_noffc_3:
    s_waitcnt vmcnt(0)
    s_mov_b64 exec, 1
    v_mov_b32 v72, 0
    v_mov_b32 v73, 1
    buffer_atomic_add v73, v72, s[68:71], 0 offen sc1
    s_mov_b64 exec, -1
L_noclr_2:
    s_cmp_eq_u32 s35, 0
    s_cbranch_scc1 L_dk_4
    s_cmp_eq_u32 s35, 1
    s_cbranch_scc1 L_dv_5
    s_cmp_eq_u32 s35, 2
    s_cbranch_scc1 L_dg_6
    s_lshl_b32 s36, s39, 4
    v_add_u32 v72, s36, v159
    v_lshlrev_b32 v72, 7, v72
    v_lshrrev_b32 v73, 1, v159
    v_xor_b32 v73, v73, v160
    v_lshl_add_u32 v150, v73, 4, v72
    v_xor_b32 v151, 64, v150
    v_bfe_u32 v72, v156, 2, 2
    v_lshlrev_b32 v72, 1, v72
    v_lshl_add_u32 v72, v160, 3, v72
    v_mul_u32_u24 v72, 144, v72
    v_and_b32 v73, 3, v156
    v_lshl_add_u32 v72, v73, 3, v72
    s_mul_i32 s36, s40, 96
    s_add_u32 s36, s36, 73728
    v_add_u32 v148, s36, v72
    v_add_u32 v149, 41472, v148
    s_waitcnt lgkmcnt(0)
    s_barrier
    s_cmp_eq_u32 s40, 0
    s_cbranch_scc0 L_p1f1_8
    s_barrier
    ds_read_b128 v[12:15], v150 offset:0
    ds_read_b128 v[16:19], v151 offset:0
    ds_read_b128 v[20:23], v150 offset:8192
    ds_read_b64_tr_b16 v[24:25], v148 offset:0
    ds_read_b64_tr_b16 v[26:27], v148 offset:144
    ds_read_b64_tr_b16 v[28:29], v148 offset:32
    ds_read_b64_tr_b16 v[30:31], v148 offset:176
    ds_read_b64_tr_b16 v[32:33], v148 offset:64
    ds_read_b64_tr_b16 v[34:35], v148 offset:208
    ds_read_b64_tr_b16 v[36:37], v148 offset:4608
    ds_read_b64_tr_b16 v[38:39], v148 offset:4752
    ds_read_b64_tr_b16 v[40:41], v148 offset:4640
    ds_read_b64_tr_b16 v[42:43], v148 offset:4784
    ds_read_b64_tr_b16 v[44:45], v148 offset:4672
    ds_read_b64_tr_b16 v[46:47], v148 offset:4816
    ds_read_b64_tr_b16 v[48:49], v148 offset:9216
    ds_read_b64_tr_b16 v[50:51], v148 offset:9360
    ds_read_b64_tr_b16 v[52:53], v148 offset:9248
    ds_read_b64_tr_b16 v[54:55], v148 offset:9392
    ds_read_b64_tr_b16 v[56:57], v148 offset:9280
    ds_read_b64_tr_b16 v[58:59], v148 offset:9424
    s_waitcnt lgkmcnt(12)
    v_mfma_f32_16x16x32_bf16 v[0:3], v[24:27], v[12:15], 0
    v_mfma_f32_16x16x32_bf16 v[4:7], v[28:31], v[12:15], 0
    v_mfma_f32_16x16x32_bf16 v[8:11], v[32:35], v[12:15], 0
    ds_read_b128 v[12:15], v151 offset:8192
    ds_read_b64_tr_b16 v[60:61], v148 offset:13824
    ds_read_b64_tr_b16 v[62:63], v148 offset:13968
    ds_read_b64_tr_b16 v[64:65], v148 offset:13856
    ds_read_b64_tr_b16 v[66:67], v148 offset:14000
    ds_read_b64_tr_b16 v[68:69], v148 offset:13888
    ds_read_b64_tr_b16 v[70:71], v148 offset:14032
    s_waitcnt lgkmcnt(13)
    v_mfma_f32_16x16x32_bf16 v[0:3], v[36:39], v[16:19], v[0:3]
    v_mfma_f32_16x16x32_bf16 v[4:7], v[40:43], v[16:19], v[4:7]
    v_mfma_f32_16x16x32_bf16 v[8:11], v[44:47], v[16:19], v[8:11]
    ds_read_b128 v[16:19], v150 offset:16384
    s_waitcnt lgkmcnt(8)
    v_mfma_f32_16x16x32_bf16 v[0:3], v[48:51], v[20:23], v[0:3]
    v_mfma_f32_16x16x32_bf16 v[4:7], v[52:55], v[20:23], v[4:7]
    v_mfma_f32_16x16x32_bf16 v[8:11], v[56:59], v[20:23], v[8:11]
    ds_read_b128 v[20:23], v151 offset:16384
    s_waitcnt lgkmcnt(2)
    v_mfma_f32_16x16x32_bf16 v[0:3], v[60:63], v[12:15], v[0:3]
    v_mfma_f32_16x16x32_bf16 v[4:7], v[64:67], v[12:15], v[4:7]
    v_mfma_f32_16x16x32_bf16 v[8:11], v[68:71], v[12:15], v[8:11]
    s_barrier
    ds_read_b128 v[12:15], v150 offset:24576
    ds_read_b64_tr_b16 v[24:25], v148 offset:18432
    ds_read_b64_tr_b16 v[26:27], v148 offset:18576
    ds_read_b64_tr_b16 v[28:29], v148 offset:18464
    ds_read_b64_tr_b16 v[30:31], v148 offset:18608
    ds_read_b64_tr_b16 v[32:33], v148 offset:18496
    ds_read_b64_tr_b16 v[34:35], v148 offset:18640
    ds_read_b64_tr_b16 v[36:37], v148 offset:23040
    ds_read_b64_tr_b16 v[38:39], v148 offset:23184
    ds_read_b64_tr_b16 v[40:41], v148 offset:23072
    ds_read_b64_tr_b16 v[42:43], v148 offset:23216
    ds_read_b64_tr_b16 v[44:45], v148 offset:23104
    ds_read_b64_tr_b16 v[46:47], v148 offset:23248
    ds_read_b64_tr_b16 v[48:49], v148 offset:27648
    ds_read_b64_tr_b16 v[50:51], v148 offset:27792
    ds_read_b64_tr_b16 v[52:53], v148 offset:27680
    ds_read_b64_tr_b16 v[54:55], v148 offset:27824
    ds_read_b64_tr_b16 v[56:57], v148 offset:27712
    ds_read_b64_tr_b16 v[58:59], v148 offset:27856
    s_waitcnt lgkmcnt(12)
    v_mfma_f32_16x16x32_bf16 v[0:3], v[24:27], v[16:19], v[0:3]
    v_mfma_f32_16x16x32_bf16 v[4:7], v[28:31], v[16:19], v[4:7]
    v_mfma_f32_16x16x32_bf16 v[8:11], v[32:35], v[16:19], v[8:11]
    ds_read_b128 v[16:19], v151 offset:24576
    ds_read_b64_tr_b16 v[60:61], v148 offset:32256
    ds_read_b64_tr_b16 v[62:63], v148 offset:32400
    ds_read_b64_tr_b16 v[64:65], v148 offset:32288
    ds_read_b64_tr_b16 v[66:67], v148 offset:32432
    ds_read_b64_tr_b16 v[68:69], v148 offset:32320
    ds_read_b64_tr_b16 v[70:71], v148 offset:32464
    s_waitcnt lgkmcnt(13)
    v_mfma_f32_16x16x32_bf16 v[0:3], v[36:39], v[20:23], v[0:3]
    v_mfma_f32_16x16x32_bf16 v[4:7], v[40:43], v[20:23], v[4:7]
    v_mfma_f32_16x16x32_bf16 v[8:11], v[44:47], v[20:23], v[8:11]
    ds_read_b128 v[20:23], v150 offset:32768
    s_waitcnt lgkmcnt(8)
    v_mfma_f32_16x16x32_bf16 v[0:3], v[48:51], v[12:15], v[0:3]
    v_mfma_f32_16x16x32_bf16 v[4:7], v[52:55], v[12:15], v[4:7]
    v_mfma_f32_16x16x32_bf16 v[8:11], v[56:59], v[12:15], v[8:11]
    ds_read_b128 v[12:15], v151 offset:32768
    s_waitcnt lgkmcnt(2)
    v_mfma_f32_16x16x32_bf16 v[0:3], v[60:63], v[16:19], v[0:3]
    v_mfma_f32_16x16x32_bf16 v[4:7], v[64:67], v[16:19], v[4:7]
    v_mfma_f32_16x16x32_bf16 v[8:11], v[68:71], v[16:19], v[8:11]
    s_barrier
    ds_read_b128 v[16:19], v150 offset:40960
    ds_read_b64_tr_b16 v[24:25], v148 offset:36864
    ds_read_b64_tr_b16 v[26:27], v148 offset:37008
    ds_read_b64_tr_b16 v[28:29], v148 offset:36896
    ds_read_b64_tr_b16 v[30:31], v148 offset:37040
    ds_read_b64_tr_b16 v[32:33], v148 offset:36928
    ds_read_b64_tr_b16 v[34:35], v148 offset:37072
    ds_read_b64_tr_b16 v[36:37], v149 offset:0
    ds_read_b64_tr_b16 v[38:39], v149 offset:144
    ds_read_b64_tr_b16 v[40:41], v149 offset:32
    ds_read_b64_tr_b16 v[42:43], v149 offset:176
    ds_read_b64_tr_b16 v[44:45], v149 offset:64
    ds_read_b64_tr_b16 v[46:47], v149 offset:208
    ds_read_b64_tr_b16 v[48:49], v149 offset:4608
    ds_read_b64_tr_b16 v[50:51], v149 offset:4752
    ds_read_b64_tr_b16 v[52:53], v149 offset:4640
    ds_read_b64_tr_b16 v[54:55], v149 offset:4784
    ds_read_b64_tr_b16 v[56:57], v149 offset:4672
    ds_read_b64_tr_b16 v[58:59], v149 offset:4816
    s_waitcnt lgkmcnt(12)
    v_mfma_f32_16x16x32_bf16 v[0:3], v[24:27], v[20:23], v[0:3]
    v_mfma_f32_16x16x32_bf16 v[4:7], v[28:31], v[20:23], v[4:7]
    v_mfma_f32_16x16x32_bf16 v[8:11], v[32:35], v[20:23], v[8:11]
    ds_read_b128 v[20:23], v151 offset:40960
    ds_read_b64_tr_b16 v[60:61], v149 offset:9216
    ds_read_b64_tr_b16 v[62:63], v149 offset:9360
    ds_read_b64_tr_b16 v[64:65], v149 offset:9248
    ds_read_b64_tr_b16 v[66:67], v149 offset:9392
    ds_read_b64_tr_b16 v[68:69], v149 offset:9280
    ds_read_b64_tr_b16 v[70:71], v149 offset:9424
    s_waitcnt lgkmcnt(13)
    v_mfma_f32_16x16x32_bf16 v[0:3], v[36:39], v[12:15], v[0:3]
    v_mfma_f32_16x16x32_bf16 v[4:7], v[40:43], v[12:15], v[4:7]
    v_mfma_f32_16x16x32_bf16 v[8:11], v[44:47], v[12:15], v[8:11]
    ds_read_b128 v[12:15], v150 offset:49152
    s_waitcnt lgkmcnt(8)
    v_mfma_f32_16x16x32_bf16 v[0:3], v[48:51], v[16:19], v[0:3]
    v_mfma_f32_16x16x32_bf16 v[4:7], v[52:55], v[16:19], v[4:7]
    v_mfma_f32_16x16x32_bf16 v[8:11], v[56:59], v[16:19], v[8:11]
    ds_read_b128 v[16:19], v151 offset:49152
    s_waitcnt lgkmcnt(2)
    v_mfma_f32_16x16x32_bf16 v[0:3], v[60:63], v[20:23], v[0:3]
    v_mfma_f32_16x16x32_bf16 v[4:7], v[64:67], v[20:23], v[4:7]
    v_mfma_f32_16x16x32_bf16 v[8:11], v[68:71], v[20:23], v[8:11]
    s_barrier
    ds_read_b128 v[20:23], v150 offset:57344
    ds_read_b64_tr_b16 v[24:25], v149 offset:13824
    ds_read_b64_tr_b16 v[26:27], v149 offset:13968
    ds_read_b64_tr_b16 v[28:29], v149 offset:13856
    ds_read_b64_tr_b16 v[30:31], v149 offset:14000
    ds_read_b64_tr_b16 v[32:33], v149 offset:13888
    ds_read_b64_tr_b16 v[34:35], v149 offset:14032
    ds_read_b64_tr_b16 v[36:37], v149 offset:18432
    ds_read_b64_tr_b16 v[38:39], v149 offset:18576
    ds_read_b64_tr_b16 v[40:41], v149 offset:18464
    ds_read_b64_tr_b16 v[42:43], v149 offset:18608
    ds_read_b64_tr_b16 v[44:45], v149 offset:18496
    ds_read_b64_tr_b16 v[46:47], v149 offset:18640
    ds_read_b64_tr_b16 v[48:49], v149 offset:23040
    ds_read_b64_tr_b16 v[50:51], v149 offset:23184
    ds_read_b64_tr_b16 v[52:53], v149 offset:23072
    ds_read_b64_tr_b16 v[54:55], v149 offset:23216
    ds_read_b64_tr_b16 v[56:57], v149 offset:23104
    ds_read_b64_tr_b16 v[58:59], v149 offset:23248
    s_waitcnt lgkmcnt(12)
    v_mfma_f32_16x16x32_bf16 v[0:3], v[24:27], v[12:15], v[0:3]
    v_mfma_f32_16x16x32_bf16 v[4:7], v[28:31], v[12:15], v[4:7]
    v_mfma_f32_16x16x32_bf16 v[8:11], v[32:35], v[12:15], v[8:11]
    ds_read_b128 v[12:15], v151 offset:57344
    ds_read_b64_tr_b16 v[60:61], v149 offset:27648
    ds_read_b64_tr_b16 v[62:63], v149 offset:27792
    ds_read_b64_tr_b16 v[64:65], v149 offset:27680
    ds_read_b64_tr_b16 v[66:67], v149 offset:27824
    ds_read_b64_tr_b16 v[68:69], v149 offset:27712
    ds_read_b64_tr_b16 v[70:71], v149 offset:27856
    s_waitcnt lgkmcnt(13)
    v_mfma_f32_16x16x32_bf16 v[0:3], v[36:39], v[16:19], v[0:3]
    v_mfma_f32_16x16x32_bf16 v[4:7], v[40:43], v[16:19], v[4:7]
    v_mfma_f32_16x16x32_bf16 v[8:11], v[44:47], v[16:19], v[8:11]
    v_add_u32 v150, 8192, v150
    v_add_u32 v151, 8192, v151
    ds_read_b128 v[16:19], v150 offset:57344
    ds_read_b64_tr_b16 v[24:25], v149 offset:32256
    ds_read_b64_tr_b16 v[26:27], v149 offset:32400
    ds_read_b64_tr_b16 v[28:29], v149 offset:32288
    ds_read_b64_tr_b16 v[30:31], v149 offset:32432
    ds_read_b64_tr_b16 v[32:33], v149 offset:32320
    ds_read_b64_tr_b16 v[34:35], v149 offset:32464
    s_waitcnt lgkmcnt(14)
    v_mfma_f32_16x16x32_bf16 v[0:3], v[48:51], v[20:23], v[0:3]
    v_mfma_f32_16x16x32_bf16 v[4:7], v[52:55], v[20:23], v[4:7]
    v_mfma_f32_16x16x32_bf16 v[8:11], v[56:59], v[20:23], v[8:11]
    ds_read_b128 v[20:23], v151 offset:57344
    ds_read_b64_tr_b16 v[36:37], v149 offset:36864
    ds_read_b64_tr_b16 v[38:39], v149 offset:37008
    ds_read_b64_tr_b16 v[40:41], v149 offset:36896
    ds_read_b64_tr_b16 v[42:43], v149 offset:37040
    ds_read_b64_tr_b16 v[44:45], v149 offset:36928
    ds_read_b64_tr_b16 v[46:47], v149 offset:37072
    s_waitcnt lgkmcnt(14)
    v_mfma_f32_16x16x32_bf16 v[0:3], v[60:63], v[12:15], v[0:3]
    v_mfma_f32_16x16x32_bf16 v[4:7], v[64:67], v[12:15], v[4:7]
    v_mfma_f32_16x16x32_bf16 v[8:11], v[68:71], v[12:15], v[8:11]
    s_waitcnt lgkmcnt(7)
    v_mfma_f32_16x16x32_bf16 v[0:3], v[24:27], v[16:19], v[0:3]
    v_mfma_f32_16x16x32_bf16 v[4:7], v[28:31], v[16:19], v[4:7]
    v_mfma_f32_16x16x32_bf16 v[8:11], v[32:35], v[16:19], v[8:11]
    s_waitcnt lgkmcnt(0)
    v_mfma_f32_16x16x32_bf16 v[0:3], v[36:39], v[20:23], v[0:3]
    v_mfma_f32_16x16x32_bf16 v[4:7], v[40:43], v[20:23], v[4:7]
    v_mfma_f32_16x16x32_bf16 v[8:11], v[44:47], v[20:23], v[8:11]
    s_nop 7
    s_lshl_b32 s36, s39, 4
    v_add_u32 v80, s36, v159
    v_mul_u32_u24 v80, 144, v80
    v_lshl_add_u32 v80, v160, 3, v80
    s_mul_i32 s36, s40, 96
    s_add_u32 s36, s36, 73728
    v_add_u32 v80, s36, v80
    s_mov_b32 s36, 0x3eae1a93
    v_mul_f32 v72, s36, v0
    v_mul_f32 v73, s36, v1
    v_mul_f32 v74, s36, v2
    v_mul_f32 v75, s36, v3
    v_cvt_pk_bf16_f32 v16, v72, v73
    v_cvt_pk_bf16_f32 v17, v74, v75
    ds_write_b64 v80, v[16:17] offset:0
    v_mul_f32 v72, s36, v4
    v_mul_f32 v73, s36, v5
    v_mul_f32 v74, s36, v6
    v_mul_f32 v75, s36, v7
    v_cvt_pk_bf16_f32 v18, v72, v73
    v_cvt_pk_bf16_f32 v19, v74, v75
    ds_write_b64 v80, v[18:19] offset:32
    v_mul_f32 v72, s36, v8
    v_mul_f32 v73, s36, v9
    v_mul_f32 v74, s36, v10
    v_mul_f32 v75, s36, v11
    v_cvt_pk_bf16_f32 v20, v72, v73
    v_cvt_pk_bf16_f32 v21, v74, v75
    ds_write_b64 v80, v[20:21] offset:64
    s_branch L_p1e_9
L_p1f1_8:
    s_barrier
    ds_read_b128 v[12:15], v150 offset:0
    ds_read_b128 v[16:19], v151 offset:0
    ds_read_b128 v[20:23], v150 offset:8192
    ds_read_b64_tr_b16 v[24:25], v148 offset:0
    ds_read_b64_tr_b16 v[26:27], v148 offset:144
    ds_read_b64_tr_b16 v[28:29], v148 offset:32
    ds_read_b64_tr_b16 v[30:31], v148 offset:176
    ds_read_b64_tr_b16 v[32:33], v148 offset:4608
    ds_read_b64_tr_b16 v[34:35], v148 offset:4752
    ds_read_b64_tr_b16 v[36:37], v148 offset:4640
    ds_read_b64_tr_b16 v[38:39], v148 offset:4784
    ds_read_b64_tr_b16 v[40:41], v148 offset:9216
    ds_read_b64_tr_b16 v[42:43], v148 offset:9360
    ds_read_b64_tr_b16 v[44:45], v148 offset:9248
    ds_read_b64_tr_b16 v[46:47], v148 offset:9392
    s_waitcnt lgkmcnt(8)
    v_mfma_f32_16x16x32_bf16 v[0:3], v[24:27], v[12:15], 0
    v_mfma_f32_16x16x32_bf16 v[4:7], v[28:31], v[12:15], 0
    ds_read_b128 v[12:15], v151 offset:8192
    ds_read_b64_tr_b16 v[48:49], v148 offset:13824
    ds_read_b64_tr_b16 v[50:51], v148 offset:13968
    ds_read_b64_tr_b16 v[52:53], v148 offset:13856
    ds_read_b64_tr_b16 v[54:55], v148 offset:14000
    s_waitcnt lgkmcnt(9)
    v_mfma_f32_16x16x32_bf16 v[0:3], v[32:35], v[16:19], v[0:3]
    v_mfma_f32_16x16x32_bf16 v[4:7], v[36:39], v[16:19], v[4:7]
    ds_read_b128 v[16:19], v150 offset:16384
    s_waitcnt lgkmcnt(6)
    v_mfma_f32_16x16x32_bf16 v[0:3], v[40:43], v[20:23], v[0:3]
    v_mfma_f32_16x16x32_bf16 v[4:7], v[44:47], v[20:23], v[4:7]
    ds_read_b128 v[20:23], v151 offset:16384
    s_waitcnt lgkmcnt(2)
    v_mfma_f32_16x16x32_bf16 v[0:3], v[48:51], v[12:15], v[0:3]
    v_mfma_f32_16x16x32_bf16 v[4:7], v[52:55], v[12:15], v[4:7]
    s_barrier
    ds_read_b128 v[12:15], v150 offset:24576
    ds_read_b64_tr_b16 v[24:25], v148 offset:18432
    ds_read_b64_tr_b16 v[26:27], v148 offset:18576
    ds_read_b64_tr_b16 v[28:29], v148 offset:18464
    ds_read_b64_tr_b16 v[30:31], v148 offset:18608
    ds_read_b64_tr_b16 v[32:33], v148 offset:23040
    ds_read_b64_tr_b16 v[34:35], v148 offset:23184
    ds_read_b64_tr_b16 v[36:37], v148 offset:23072
    ds_read_b64_tr_b16 v[38:39], v148 offset:23216
    ds_read_b64_tr_b16 v[40:41], v148 offset:27648
    ds_read_b64_tr_b16 v[42:43], v148 offset:27792
    ds_read_b64_tr_b16 v[44:45], v148 offset:27680
    ds_read_b64_tr_b16 v[46:47], v148 offset:27824
    s_waitcnt lgkmcnt(8)
    v_mfma_f32_16x16x32_bf16 v[0:3], v[24:27], v[16:19], v[0:3]
    v_mfma_f32_16x16x32_bf16 v[4:7], v[28:31], v[16:19], v[4:7]
    ds_read_b128 v[16:19], v151 offset:24576
    ds_read_b64_tr_b16 v[48:49], v148 offset:32256
    ds_read_b64_tr_b16 v[50:51], v148 offset:32400
    ds_read_b64_tr_b16 v[52:53], v148 offset:32288
    ds_read_b64_tr_b16 v[54:55], v148 offset:32432
    s_waitcnt lgkmcnt(9)
    v_mfma_f32_16x16x32_bf16 v[0:3], v[32:35], v[20:23], v[0:3]
    v_mfma_f32_16x16x32_bf16 v[4:7], v[36:39], v[20:23], v[4:7]
    ds_read_b128 v[20:23], v150 offset:32768
    s_waitcnt lgkmcnt(6)
    v_mfma_f32_16x16x32_bf16 v[0:3], v[40:43], v[12:15], v[0:3]
    v_mfma_f32_16x16x32_bf16 v[4:7], v[44:47], v[12:15], v[4:7]
    ds_read_b128 v[12:15], v151 offset:32768
    s_waitcnt lgkmcnt(2)
    v_mfma_f32_16x16x32_bf16 v[0:3], v[48:51], v[16:19], v[0:3]
    v_mfma_f32_16x16x32_bf16 v[4:7], v[52:55], v[16:19], v[4:7]
    s_barrier
    ds_read_b128 v[16:19], v150 offset:40960
    ds_read_b64_tr_b16 v[24:25], v148 offset:36864
    ds_read_b64_tr_b16 v[26:27], v148 offset:37008
    ds_read_b64_tr_b16 v[28:29], v148 offset:36896
    ds_read_b64_tr_b16 v[30:31], v148 offset:37040
    ds_read_b64_tr_b16 v[32:33], v149 offset:0
    ds_read_b64_tr_b16 v[34:35], v149 offset:144
    ds_read_b64_tr_b16 v[36:37], v149 offset:32
    ds_read_b64_tr_b16 v[38:39], v149 offset:176
    ds_read_b64_tr_b16 v[40:41], v149 offset:4608
    ds_read_b64_tr_b16 v[42:43], v149 offset:4752
    ds_read_b64_tr_b16 v[44:45], v149 offset:4640
    ds_read_b64_tr_b16 v[46:47], v149 offset:4784
    s_waitcnt lgkmcnt(8)
    v_mfma_f32_16x16x32_bf16 v[0:3], v[24:27], v[20:23], v[0:3]
    v_mfma_f32_16x16x32_bf16 v[4:7], v[28:31], v[20:23], v[4:7]
    ds_read_b128 v[20:23], v151 offset:40960
    ds_read_b64_tr_b16 v[48:49], v149 offset:9216
    ds_read_b64_tr_b16 v[50:51], v149 offset:9360
    ds_read_b64_tr_b16 v[52:53], v149 offset:9248
    ds_read_b64_tr_b16 v[54:55], v149 offset:9392
    s_waitcnt lgkmcnt(9)
    v_mfma_f32_16x16x32_bf16 v[0:3], v[32:35], v[12:15], v[0:3]
    v_mfma_f32_16x16x32_bf16 v[4:7], v[36:39], v[12:15], v[4:7]
    ds_read_b128 v[12:15], v150 offset:49152
    s_waitcnt lgkmcnt(6)
    v_mfma_f32_16x16x32_bf16 v[0:3], v[40:43], v[16:19], v[0:3]
    v_mfma_f32_16x16x32_bf16 v[4:7], v[44:47], v[16:19], v[4:7]
    ds_read_b128 v[16:19], v151 offset:49152
    s_waitcnt lgkmcnt(2)
    v_mfma_f32_16x16x32_bf16 v[0:3], v[48:51], v[20:23], v[0:3]
    v_mfma_f32_16x16x32_bf16 v[4:7], v[52:55], v[20:23], v[4:7]
    s_barrier
    ds_read_b128 v[20:23], v150 offset:57344
    ds_read_b64_tr_b16 v[24:25], v149 offset:13824
    ds_read_b64_tr_b16 v[26:27], v149 offset:13968
    ds_read_b64_tr_b16 v[28:29], v149 offset:13856
    ds_read_b64_tr_b16 v[30:31], v149 offset:14000
    ds_read_b64_tr_b16 v[32:33], v149 offset:18432
    ds_read_b64_tr_b16 v[34:35], v149 offset:18576
    ds_read_b64_tr_b16 v[36:37], v149 offset:18464
    ds_read_b64_tr_b16 v[38:39], v149 offset:18608
    ds_read_b64_tr_b16 v[40:41], v149 offset:23040
    ds_read_b64_tr_b16 v[42:43], v149 offset:23184
    ds_read_b64_tr_b16 v[44:45], v149 offset:23072
    ds_read_b64_tr_b16 v[46:47], v149 offset:23216
    s_waitcnt lgkmcnt(8)
    v_mfma_f32_16x16x32_bf16 v[0:3], v[24:27], v[12:15], v[0:3]
    v_mfma_f32_16x16x32_bf16 v[4:7], v[28:31], v[12:15], v[4:7]
    ds_read_b128 v[12:15], v151 offset:57344
    ds_read_b64_tr_b16 v[48:49], v149 offset:27648
    ds_read_b64_tr_b16 v[50:51], v149 offset:27792
    ds_read_b64_tr_b16 v[52:53], v149 offset:27680
    ds_read_b64_tr_b16 v[54:55], v149 offset:27824
    s_waitcnt lgkmcnt(9)
    v_mfma_f32_16x16x32_bf16 v[0:3], v[32:35], v[16:19], v[0:3]
    v_mfma_f32_16x16x32_bf16 v[4:7], v[36:39], v[16:19], v[4:7]
    v_add_u32 v150, 8192, v150
    v_add_u32 v151, 8192, v151
    ds_read_b128 v[16:19], v150 offset:57344
    ds_read_b64_tr_b16 v[24:25], v149 offset:32256
    ds_read_b64_tr_b16 v[26:27], v149 offset:32400
    ds_read_b64_tr_b16 v[28:29], v149 offset:32288
    ds_read_b64_tr_b16 v[30:31], v149 offset:32432
    s_waitcnt lgkmcnt(10)
    v_mfma_f32_16x16x32_bf16 v[0:3], v[40:43], v[20:23], v[0:3]
    v_mfma_f32_16x16x32_bf16 v[4:7], v[44:47], v[20:23], v[4:7]
    ds_read_b128 v[20:23], v151 offset:57344
    ds_read_b64_tr_b16 v[32:33], v149 offset:36864
    ds_read_b64_tr_b16 v[34:35], v149 offset:37008
    ds_read_b64_tr_b16 v[36:37], v149 offset:36896
    ds_read_b64_tr_b16 v[38:39], v149 offset:37040
    s_waitcnt lgkmcnt(10)
    v_mfma_f32_16x16x32_bf16 v[0:3], v[48:51], v[12:15], v[0:3]
    v_mfma_f32_16x16x32_bf16 v[4:7], v[52:55], v[12:15], v[4:7]
    s_waitcnt lgkmcnt(5)
    v_mfma_f32_16x16x32_bf16 v[0:3], v[24:27], v[16:19], v[0:3]
    v_mfma_f32_16x16x32_bf16 v[4:7], v[28:31], v[16:19], v[4:7]
    s_waitcnt lgkmcnt(0)
    v_mfma_f32_16x16x32_bf16 v[0:3], v[32:35], v[20:23], v[0:3]
    v_mfma_f32_16x16x32_bf16 v[4:7], v[36:39], v[20:23], v[4:7]
    s_nop 7
    s_lshl_b32 s36, s39, 4
    v_add_u32 v80, s36, v159
    v_mul_u32_u24 v80, 144, v80
    v_lshl_add_u32 v80, v160, 3, v80
    s_mul_i32 s36, s40, 96
    s_add_u32 s36, s36, 73728
    v_add_u32 v80, s36, v80
    s_mov_b32 s36, 0x3eae1a93
    v_mul_f32 v72, s36, v0
    v_mul_f32 v73, s36, v1
    v_mul_f32 v74, s36, v2
    v_mul_f32 v75, s36, v3
    v_cvt_pk_bf16_f32 v16, v72, v73
    v_cvt_pk_bf16_f32 v17, v74, v75
    ds_write_b64 v80, v[16:17] offset:0
    v_mul_f32 v72, s36, v4
    v_mul_f32 v73, s36, v5
    v_mul_f32 v74, s36, v6
    v_mul_f32 v75, s36, v7
    v_cvt_pk_bf16_f32 v18, v72, v73
    v_cvt_pk_bf16_f32 v19, v74, v75
    v_cmp_gt_u32 vcc, 2, v160
    s_nop 0
    s_and_saveexec_b64 s[76:77], vcc
    ds_write_b64 v80, v[18:19] offset:32
    s_mov_b64 exec, s[76:77]
L_p1e_9:
    s_waitcnt lgkmcnt(0)
    s_barrier
    s_mul_i32 s36, s35, 144
    s_mul_i32 s37, s40, 96
    s_add_u32 s36, s36, s37
    s_lshl_b32 s37, s39, 4
    v_add_u32 v72, s37, v159
    v_lshlrev_b32 v72, 7, v72
    v_lshrrev_b32 v73, 1, v159
    v_lshlrev_b32 v74, 3, v160
    v_add_u32 v74, s36, v74
    v_lshrrev_b32 v75, 7, v74
    v_lshl_add_u32 v75, v75, 13, v72
    v_bfe_u32 v76, v74, 4, 3
    v_xor_b32 v76, v76, v73
    v_lshl_add_u32 v75, v76, 4, v75
    v_and_b32 v74, 8, v74
    v_add_u32 v75, v75, v74
    ds_read_b64 v[162:163], v75
    v_lshlrev_b32 v74, 3, v160
    v_add_u32 v74, s36, v74
    v_add_u32 v74, 32, v74
    v_lshrrev_b32 v75, 7, v74
    v_lshl_add_u32 v75, v75, 13, v72
    v_bfe_u32 v76, v74, 4, 3
    v_xor_b32 v76, v76, v73
    v_lshl_add_u32 v75, v76, 4, v75
    v_and_b32 v74, 8, v74
    v_add_u32 v75, v75, v74
    ds_read_b64 v[164:165], v75
    v_lshlrev_b32 v74, 3, v160
    v_add_u32 v74, s36, v74
    v_add_u32 v74, 64, v74
    v_lshrrev_b32 v75, 7, v74
    v_lshl_add_u32 v75, v75, 13, v72
    v_bfe_u32 v76, v74, 4, 3
    v_xor_b32 v76, v76, v73
    v_lshl_add_u32 v75, v76, 4, v75
    v_and_b32 v74, 8, v74
    v_add_u32 v75, v75, v74
    ds_read_b64 v[166:167], v75
    s_branch L_dj_7
L_dk_4:
    s_mov_b32 s56, s8
    s_and_b32 s57, s9, 0xffff
    s_mov_b32 s58, 20736
    s_mov_b32 s59, 0x20000
    s_lshl_b32 s36, s33, 6
    s_add_u32 s36, s36, 0
    v_add_u32 v72, s36, v156
    v_mul_u32_u24 v72, 12, v72
    buffer_load_dwordx3 v[56:58], v72, s[56:59], 0 offen
    s_lshl_b32 s36, s33, 6
    s_add_u32 s36, s36, 512
    v_add_u32 v72, s36, v156
    v_mul_u32_u24 v72, 12, v72
    buffer_load_dwordx3 v[60:62], v72, s[56:59], 0 offen
    s_lshl_b32 s36, s33, 6
    s_add_u32 s36, s36, 1024
    v_add_u32 v72, s36, v156
    v_mul_u32_u24 v72, 12, v72
    buffer_load_dwordx3 v[64:66], v72, s[56:59], 0 offen
    s_cmp_ge_u32 s33, 3
    s_cbranch_scc1 L_elskip_10
    s_lshl_b32 s36, s33, 6
    s_add_u32 s36, s36, 1536
    v_add_u32 v72, s36, v156
    v_mul_u32_u24 v72, 12, v72
    buffer_load_dwordx3 v[68:70], v72, s[56:59], 0 offen
L_elskip_10:
    s_lshl_b32 s36, s39, 4
    v_add_u32 v72, s36, v159
    v_lshlrev_b32 v72, 7, v72
    v_lshrrev_b32 v73, 1, v159
    v_xor_b32 v73, v73, v160
    v_lshl_add_u32 v150, v73, 4, v72
    v_xor_b32 v151, 64, v150
    v_bfe_u32 v72, v156, 2, 2
    v_lshlrev_b32 v72, 1, v72
    v_lshl_add_u32 v72, v160, 3, v72
    v_mul_u32_u24 v72, 144, v72
    v_and_b32 v73, 3, v156
    v_lshl_add_u32 v72, v73, 3, v72
    s_mul_i32 s36, s40, 96
    s_add_u32 s36, s36, 73728
    v_add_u32 v148, s36, v72
    v_add_u32 v149, 41472, v148
    v_bfe_u32 v72, v156, 2, 2
    v_lshl_add_u32 v72, v160, 3, v72
    v_and_b32 v73, 1, v160
    v_lshl_add_u32 v74, v73, 2, v72
    v_xor_b32 v73, 1, v73
    v_lshl_add_u32 v75, v73, 2, v72
    v_and_b32 v73, 3, v156
    v_lshlrev_b32 v73, 3, v73
    v_lshl_add_u32 v52, v74, 5, v73
    v_lshl_add_u32 v53, v75, 5, v73
    v_add_u32 v52, 129024, v52
    v_add_u32 v53, 129024, v53
    v_lshlrev_b32 v54, 3, v72
    v_add_u32 v54, 147456, v54
    s_lshr_b32 s37, s39, 1
    s_and_b32 s36, s39, 1
    s_lshl_b32 s36, s36, 4
    v_add_u32 v72, s36, v159
    s_cmp_eq_u32 s40, 0
    s_cbranch_scc0 L_ka1_11
    v_lshrrev_b32 v73, 1, v160
    v_lshl_add_u32 v73, v73, 5, v72
    v_lshlrev_b32 v73, 4, v73
    v_and_b32 v74, 1, v160
    v_lshl_add_u32 v73, v74, 3, v73
    s_lshl_b32 s36, s37, 10
    s_add_u32 s36, s36, 156672
    v_add_u32 v55, s36, v73
    s_branch L_kae_12
L_ka1_11:
    v_lshlrev_b32 v73, 3, v72
    s_lshl_b32 s36, s37, 2
    s_add_u32 s36, s36, 158720
    v_add_u32 v55, s36, v73
L_kae_12:
    s_lshl_b32 s36, s33, 6
    s_add_u32 s36, s36, 0
    v_add_u32 v76, s36, v156
    v_mul_u32_u24 v77, 21846, v76
    v_lshrrev_b32 v77, 16, v77
    v_mul_u32_u24 v78, 3, v77
    v_sub_u32 v78, v76, v78
    v_lshrrev_b32 v79, 1, v77
    v_and_b32 v79, 4, v79
    v_xor_b32 v79, v77, v79
    v_lshlrev_b32 v79, 5, v79
    v_mul_u32_u24 v80, 12, v78
    v_add_u32 v79, v79, v80
    v_add_u32 v32, 129024, v79
    v_lshlrev_b32 v80, 3, v77
    v_add_u32 v80, 147456, v80
    v_add_u32 v81, 8, v32
    v_cmp_eq_u32 vcc, 2, v78
    s_nop 1
    v_cndmask_b32 v33, v81, v80, vcc
    s_lshl_b32 s36, s33, 6
    s_add_u32 s36, s36, 512
    v_add_u32 v76, s36, v156
    v_mul_u32_u24 v77, 21846, v76
    v_lshrrev_b32 v77, 16, v77
    v_mul_u32_u24 v78, 3, v77
    v_sub_u32 v78, v76, v78
    v_lshrrev_b32 v79, 1, v77
    v_and_b32 v79, 4, v79
    v_xor_b32 v79, v77, v79
    v_lshlrev_b32 v79, 5, v79
    v_mul_u32_u24 v80, 12, v78
    v_add_u32 v79, v79, v80
    v_add_u32 v34, 129024, v79
    v_lshlrev_b32 v80, 3, v77
    v_add_u32 v80, 147456, v80
    v_add_u32 v81, 8, v34
    v_cmp_eq_u32 vcc, 2, v78
    s_nop 1
    v_cndmask_b32 v35, v81, v80, vcc
    s_lshl_b32 s36, s33, 6
    s_add_u32 s36, s36, 1024
    v_add_u32 v76, s36, v156
    v_mul_u32_u24 v77, 21846, v76
    v_lshrrev_b32 v77, 16, v77
    v_mul_u32_u24 v78, 3, v77
    v_sub_u32 v78, v76, v78
    v_lshrrev_b32 v79, 1, v77
    v_and_b32 v79, 4, v79
    v_xor_b32 v79, v77, v79
    v_lshlrev_b32 v79, 5, v79
    v_mul_u32_u24 v80, 12, v78
    v_add_u32 v79, v79, v80
    v_add_u32 v36, 129024, v79
    v_lshlrev_b32 v80, 3, v77
    v_add_u32 v80, 147456, v80
    v_add_u32 v81, 8, v36
    v_cmp_eq_u32 vcc, 2, v78
    s_nop 1
    v_cndmask_b32 v37, v81, v80, vcc
    s_lshl_b32 s36, s33, 6
    s_add_u32 s36, s36, 1536
    v_add_u32 v76, s36, v156
    v_mul_u32_u24 v77, 21846, v76
    v_lshrrev_b32 v77, 16, v77
    v_mul_u32_u24 v78, 3, v77
    v_sub_u32 v78, v76, v78
    v_lshrrev_b32 v79, 1, v77
    v_and_b32 v79, 4, v79
    v_xor_b32 v79, v77, v79
    v_lshlrev_b32 v79, 5, v79
    v_mul_u32_u24 v80, 12, v78
    v_add_u32 v79, v79, v80
    v_add_u32 v38, 129024, v79
    v_lshlrev_b32 v80, 3, v77
    v_add_u32 v80, 147456, v80
    v_add_u32 v81, 8, v38
    v_cmp_eq_u32 vcc, 2, v78
    s_nop 1
    v_cndmask_b32 v39, v81, v80, vcc
    s_waitcnt vmcnt(0)
    ds_write2_b32 v32, v56, v57 offset0:0 offset1:1
    ds_write_b32 v33, v58
    ds_write2_b32 v34, v60, v61 offset0:0 offset1:1
    ds_write_b32 v35, v62
    ds_write2_b32 v36, v64, v65 offset0:0 offset1:1
    ds_write_b32 v37, v66
    s_cmp_ge_u32 s33, 3
    s_cbranch_scc1 L_ewskip_13
    ds_write2_b32 v38, v68, v69 offset0:0 offset1:1
    ds_write_b32 v39, v70
L_ewskip_13:
    s_waitcnt lgkmcnt(0)
    s_barrier
    s_cmp_eq_u32 s40, 0
    s_cbranch_scc0 L_k1_14
    ds_read_b128 v[32:35], v150 offset:0
    ds_read_b64_tr_b16 v[16:17], v52 offset:0
    ds_read_b64_tr_b16 v[18:19], v53 offset:0
    ds_read_b128 v[36:39], v151 offset:0
    ds_read_b64_tr_b16 v[20:21], v52 offset:1024
    ds_read_b64_tr_b16 v[22:23], v53 offset:1024
    ds_read_b128 v[40:43], v150 offset:8192
    ds_read_b64_tr_b16 v[24:25], v52 offset:2048
    ds_read_b64_tr_b16 v[26:27], v53 offset:2048
    ds_read_b128 v[44:47], v151 offset:8192
    ds_read_b64_tr_b16 v[28:29], v52 offset:3072
    ds_read_b64_tr_b16 v[30:31], v53 offset:3072
    s_waitcnt lgkmcnt(9)
    v_mfma_f32_16x16x32_bf16 v[12:15], v[16:19], v[32:35], 0
    ds_read_b128 v[32:35], v150 offset:16384
    ds_read_b64_tr_b16 v[16:17], v52 offset:4096
    ds_read_b64_tr_b16 v[18:19], v53 offset:4096
    s_waitcnt lgkmcnt(9)
    v_mfma_f32_16x16x32_bf16 v[12:15], v[20:23], v[36:39], v[12:15]
    ds_read_b128 v[36:39], v151 offset:16384
    ds_read_b64_tr_b16 v[20:21], v52 offset:5120
    ds_read_b64_tr_b16 v[22:23], v53 offset:5120
    s_waitcnt lgkmcnt(9)
    v_mfma_f32_16x16x32_bf16 v[12:15], v[24:27], v[40:43], v[12:15]
    ds_read_b128 v[40:43], v150 offset:24576
    ds_read_b64_tr_b16 v[24:25], v52 offset:6144
    ds_read_b64_tr_b16 v[26:27], v53 offset:6144
    s_waitcnt lgkmcnt(9)
    v_mfma_f32_16x16x32_bf16 v[12:15], v[28:31], v[44:47], v[12:15]
    ds_read_b128 v[44:47], v151 offset:24576
    ds_read_b64_tr_b16 v[28:29], v52 offset:7168
    ds_read_b64_tr_b16 v[30:31], v53 offset:7168
    s_waitcnt lgkmcnt(9)
    v_mfma_f32_16x16x32_bf16 v[12:15], v[16:19], v[32:35], v[12:15]
    ds_read_b128 v[32:35], v150 offset:32768
    ds_read_b64_tr_b16 v[16:17], v52 offset:8192
    ds_read_b64_tr_b16 v[18:19], v53 offset:8192
    s_waitcnt lgkmcnt(9)
    v_mfma_f32_16x16x32_bf16 v[12:15], v[20:23], v[36:39], v[12:15]
    ds_read_b128 v[36:39], v151 offset:32768
    ds_read_b64_tr_b16 v[20:21], v52 offset:9216
    ds_read_b64_tr_b16 v[22:23], v53 offset:9216
    s_waitcnt lgkmcnt(9)
    v_mfma_f32_16x16x32_bf16 v[12:15], v[24:27], v[40:43], v[12:15]
    ds_read_b128 v[40:43], v150 offset:40960
    ds_read_b64_tr_b16 v[24:25], v52 offset:10240
    ds_read_b64_tr_b16 v[26:27], v53 offset:10240
    s_waitcnt lgkmcnt(9)
    v_mfma_f32_16x16x32_bf16 v[12:15], v[28:31], v[44:47], v[12:15]
    ds_read_b128 v[44:47], v151 offset:40960
    ds_read_b64_tr_b16 v[28:29], v52 offset:11264
    ds_read_b64_tr_b16 v[30:31], v53 offset:11264
    s_waitcnt lgkmcnt(9)
    v_mfma_f32_16x16x32_bf16 v[12:15], v[16:19], v[32:35], v[12:15]
    ds_read_b128 v[32:35], v150 offset:49152
    ds_read_b64_tr_b16 v[16:17], v52 offset:12288
    ds_read_b64_tr_b16 v[18:19], v53 offset:12288
    s_waitcnt lgkmcnt(9)
    v_mfma_f32_16x16x32_bf16 v[12:15], v[20:23], v[36:39], v[12:15]
    ds_read_b128 v[36:39], v151 offset:49152
    ds_read_b64_tr_b16 v[20:21], v52 offset:13312
    ds_read_b64_tr_b16 v[22:23], v53 offset:13312
    s_waitcnt lgkmcnt(9)
    v_mfma_f32_16x16x32_bf16 v[12:15], v[24:27], v[40:43], v[12:15]
    ds_read_b128 v[40:43], v150 offset:57344
    ds_read_b64_tr_b16 v[24:25], v52 offset:14336
    ds_read_b64_tr_b16 v[26:27], v53 offset:14336
    s_waitcnt lgkmcnt(9)
    v_mfma_f32_16x16x32_bf16 v[12:15], v[28:31], v[44:47], v[12:15]
    ds_read_b128 v[44:47], v151 offset:57344
    ds_read_b64_tr_b16 v[28:29], v52 offset:15360
    ds_read_b64_tr_b16 v[30:31], v53 offset:15360
    s_waitcnt lgkmcnt(9)
    v_mfma_f32_16x16x32_bf16 v[12:15], v[16:19], v[32:35], v[12:15]
    v_add_u32 v150, 8192, v150
    v_add_u32 v151, 8192, v151
    ds_read_b128 v[32:35], v150 offset:57344
    ds_read_b64_tr_b16 v[16:17], v52 offset:16384
    ds_read_b64_tr_b16 v[18:19], v53 offset:16384
    s_waitcnt lgkmcnt(9)
    v_mfma_f32_16x16x32_bf16 v[12:15], v[20:23], v[36:39], v[12:15]
    ds_read_b128 v[36:39], v151 offset:57344
    ds_read_b64_tr_b16 v[20:21], v52 offset:17408
    ds_read_b64_tr_b16 v[22:23], v53 offset:17408
    s_waitcnt lgkmcnt(9)
    v_mfma_f32_16x16x32_bf16 v[12:15], v[24:27], v[40:43], v[12:15]
    s_waitcnt lgkmcnt(6)
    v_mfma_f32_16x16x32_bf16 v[12:15], v[28:31], v[44:47], v[12:15]
    s_waitcnt lgkmcnt(3)
    v_mfma_f32_16x16x32_bf16 v[12:15], v[16:19], v[32:35], v[12:15]
    s_waitcnt lgkmcnt(0)
    v_mfma_f32_16x16x32_bf16 v[12:15], v[20:23], v[36:39], v[12:15]
    v_subrev_u32 v150, 8192, v150
    v_subrev_u32 v151, 8192, v151
    s_nop 7
    v_cvt_pk_bf16_f32 v82, v12, v13
    v_cvt_pk_bf16_f32 v83, v14, v15
    ds_write_b64 v55, v[82:83]
    s_branch L_ke_15
L_k1_14:
    ds_read_b128 v[32:35], v150 offset:0
    ds_read_b64_tr_b16 v[16:17], v54 offset:0
    ds_read_b64_tr_b16 v[18:19], v54 offset:32
    ds_read_b128 v[36:39], v151 offset:0
    ds_read_b64_tr_b16 v[20:21], v54 offset:256
    ds_read_b64_tr_b16 v[22:23], v54 offset:288
    ds_read_b128 v[40:43], v150 offset:8192
    ds_read_b64_tr_b16 v[24:25], v54 offset:512
    ds_read_b64_tr_b16 v[26:27], v54 offset:544
    ds_read_b128 v[44:47], v151 offset:8192
    ds_read_b64_tr_b16 v[28:29], v54 offset:768
    ds_read_b64_tr_b16 v[30:31], v54 offset:800
    s_waitcnt lgkmcnt(9)
    v_mfma_f32_16x16x32_bf16 v[12:15], v[16:19], v[32:35], 0
    ds_read_b128 v[32:35], v150 offset:16384
    ds_read_b64_tr_b16 v[16:17], v54 offset:1024
    ds_read_b64_tr_b16 v[18:19], v54 offset:1056
    s_waitcnt lgkmcnt(9)
    v_mfma_f32_16x16x32_bf16 v[12:15], v[20:23], v[36:39], v[12:15]
    ds_read_b128 v[36:39], v151 offset:16384
    ds_read_b64_tr_b16 v[20:21], v54 offset:1280
    ds_read_b64_tr_b16 v[22:23], v54 offset:1312
    s_waitcnt lgkmcnt(9)
    v_mfma_f32_16x16x32_bf16 v[12:15], v[24:27], v[40:43], v[12:15]
    ds_read_b128 v[40:43], v150 offset:24576
    ds_read_b64_tr_b16 v[24:25], v54 offset:1536
    ds_read_b64_tr_b16 v[26:27], v54 offset:1568
    s_waitcnt lgkmcnt(9)
    v_mfma_f32_16x16x32_bf16 v[12:15], v[28:31], v[44:47], v[12:15]
    ds_read_b128 v[44:47], v151 offset:24576
    ds_read_b64_tr_b16 v[28:29], v54 offset:1792
    ds_read_b64_tr_b16 v[30:31], v54 offset:1824
    s_waitcnt lgkmcnt(9)
    v_mfma_f32_16x16x32_bf16 v[12:15], v[16:19], v[32:35], v[12:15]
    ds_read_b128 v[32:35], v150 offset:32768
    ds_read_b64_tr_b16 v[16:17], v54 offset:2048
    ds_read_b64_tr_b16 v[18:19], v54 offset:2080
    s_waitcnt lgkmcnt(9)
    v_mfma_f32_16x16x32_bf16 v[12:15], v[20:23], v[36:39], v[12:15]
    ds_read_b128 v[36:39], v151 offset:32768
    ds_read_b64_tr_b16 v[20:21], v54 offset:2304
    ds_read_b64_tr_b16 v[22:23], v54 offset:2336
    s_waitcnt lgkmcnt(9)
    v_mfma_f32_16x16x32_bf16 v[12:15], v[24:27], v[40:43], v[12:15]
    ds_read_b128 v[40:43], v150 offset:40960
    ds_read_b64_tr_b16 v[24:25], v54 offset:2560
    ds_read_b64_tr_b16 v[26:27], v54 offset:2592
    s_waitcnt lgkmcnt(9)
    v_mfma_f32_16x16x32_bf16 v[12:15], v[28:31], v[44:47], v[12:15]
    ds_read_b128 v[44:47], v151 offset:40960
    ds_read_b64_tr_b16 v[28:29], v54 offset:2816
    ds_read_b64_tr_b16 v[30:31], v54 offset:2848
    s_waitcnt lgkmcnt(9)
    v_mfma_f32_16x16x32_bf16 v[12:15], v[16:19], v[32:35], v[12:15]
    ds_read_b128 v[32:35], v150 offset:49152
    ds_read_b64_tr_b16 v[16:17], v54 offset:3072
    ds_read_b64_tr_b16 v[18:19], v54 offset:3104
    s_waitcnt lgkmcnt(9)
    v_mfma_f32_16x16x32_bf16 v[12:15], v[20:23], v[36:39], v[12:15]
    ds_read_b128 v[36:39], v151 offset:49152
    ds_read_b64_tr_b16 v[20:21], v54 offset:3328
    ds_read_b64_tr_b16 v[22:23], v54 offset:3360
    s_waitcnt lgkmcnt(9)
    v_mfma_f32_16x16x32_bf16 v[12:15], v[24:27], v[40:43], v[12:15]
    ds_read_b128 v[40:43], v150 offset:57344
    ds_read_b64_tr_b16 v[24:25], v54 offset:3584
    ds_read_b64_tr_b16 v[26:27], v54 offset:3616
    s_waitcnt lgkmcnt(9)
    v_mfma_f32_16x16x32_bf16 v[12:15], v[28:31], v[44:47], v[12:15]
    ds_read_b128 v[44:47], v151 offset:57344
    ds_read_b64_tr_b16 v[28:29], v54 offset:3840
    ds_read_b64_tr_b16 v[30:31], v54 offset:3872
    s_waitcnt lgkmcnt(9)
    v_mfma_f32_16x16x32_bf16 v[12:15], v[16:19], v[32:35], v[12:15]
    v_add_u32 v150, 8192, v150
    v_add_u32 v151, 8192, v151
    ds_read_b128 v[32:35], v150 offset:57344
    ds_read_b64_tr_b16 v[16:17], v54 offset:4096
    ds_read_b64_tr_b16 v[18:19], v54 offset:4128
    s_waitcnt lgkmcnt(9)
    v_mfma_f32_16x16x32_bf16 v[12:15], v[20:23], v[36:39], v[12:15]
    ds_read_b128 v[36:39], v151 offset:57344
    ds_read_b64_tr_b16 v[20:21], v54 offset:4352
    ds_read_b64_tr_b16 v[22:23], v54 offset:4384
    s_waitcnt lgkmcnt(9)
    v_mfma_f32_16x16x32_bf16 v[12:15], v[24:27], v[40:43], v[12:15]
    s_waitcnt lgkmcnt(6)
    v_mfma_f32_16x16x32_bf16 v[12:15], v[28:31], v[44:47], v[12:15]
    s_waitcnt lgkmcnt(3)
    v_mfma_f32_16x16x32_bf16 v[12:15], v[16:19], v[32:35], v[12:15]
    s_waitcnt lgkmcnt(0)
    v_mfma_f32_16x16x32_bf16 v[12:15], v[20:23], v[36:39], v[12:15]
    v_subrev_u32 v150, 8192, v150
    v_subrev_u32 v151, 8192, v151
    s_nop 7
    v_cvt_pk_bf16_f32 v82, v12, v13
    v_cmp_eq_u32 vcc, 0, v160
    s_nop 0
    s_and_saveexec_b64 s[76:77], vcc
    ds_write_b32 v55, v82
    s_mov_b64 exec, s[76:77]
L_ke_15:
    s_waitcnt lgkmcnt(0)
    s_barrier
    s_cmp_lg_u32 s33, 0
    s_cbranch_scc1 L_nopub_16
    v_lshlrev_b32 v72, 4, v156
    s_mul_i32 s36, s34, 4736
    s_add_u32 s36, s36, 0
    v_add_u32 v73, 156672, v72
    ds_read_b128 v[16:19], v73 offset:0
    ds_read_b128 v[20:23], v73 offset:1024
    ds_read_b128 v[24:27], v73 offset:2048
    s_waitcnt lgkmcnt(0)
    buffer_store_dwordx4 v[16:19], v72, s[52:55], s36 offen sc1
    buffer_store_dwordx4 v[20:23], v72, s[52:55], s36 offen offset:1024 sc1
    v_cmp_gt_u32 vcc, 16, v156
    s_nop 0
    s_and_saveexec_b64 s[76:77], vcc
    buffer_store_dwordx4 v[24:27], v72, s[52:55], s36 offen offset:2048 sc1
    s_mov_b64 exec, s[76:77]
    v_mov_b32 v155, 0
    buffer_load_dword v154, v155, s[68:71], 0 offen sc1
    s_mov_b32 s87, 0
L_nopub_16:
    s_cmp_eq_u32 s40, 0
    s_cbranch_scc0 L_p1f1_17
    s_barrier
    ds_read_b128 v[12:15], v150 offset:0
    ds_read_b128 v[16:19], v151 offset:0
    ds_read_b128 v[20:23], v150 offset:8192
    ds_read_b64_tr_b16 v[24:25], v148 offset:0
    ds_read_b64_tr_b16 v[26:27], v148 offset:144
    ds_read_b64_tr_b16 v[28:29], v148 offset:32
    ds_read_b64_tr_b16 v[30:31], v148 offset:176
    ds_read_b64_tr_b16 v[32:33], v148 offset:64
    ds_read_b64_tr_b16 v[34:35], v148 offset:208
    ds_read_b64_tr_b16 v[36:37], v148 offset:4608
    ds_read_b64_tr_b16 v[38:39], v148 offset:4752
    ds_read_b64_tr_b16 v[40:41], v148 offset:4640
    ds_read_b64_tr_b16 v[42:43], v148 offset:4784
    ds_read_b64_tr_b16 v[44:45], v148 offset:4672
    ds_read_b64_tr_b16 v[46:47], v148 offset:4816
    ds_read_b64_tr_b16 v[48:49], v148 offset:9216
    ds_read_b64_tr_b16 v[50:51], v148 offset:9360
    ds_read_b64_tr_b16 v[52:53], v148 offset:9248
    ds_read_b64_tr_b16 v[54:55], v148 offset:9392
    ds_read_b64_tr_b16 v[56:57], v148 offset:9280
    ds_read_b64_tr_b16 v[58:59], v148 offset:9424
    s_waitcnt lgkmcnt(12)
    v_mfma_f32_16x16x32_bf16 v[0:3], v[24:27], v[12:15], 0
    v_mfma_f32_16x16x32_bf16 v[4:7], v[28:31], v[12:15], 0
    v_mfma_f32_16x16x32_bf16 v[8:11], v[32:35], v[12:15], 0
    ds_read_b128 v[12:15], v151 offset:8192
    ds_read_b64_tr_b16 v[60:61], v148 offset:13824
    ds_read_b64_tr_b16 v[62:63], v148 offset:13968
    ds_read_b64_tr_b16 v[64:65], v148 offset:13856
    ds_read_b64_tr_b16 v[66:67], v148 offset:14000
    ds_read_b64_tr_b16 v[68:69], v148 offset:13888
    ds_read_b64_tr_b16 v[70:71], v148 offset:14032
    s_waitcnt lgkmcnt(13)
    v_mfma_f32_16x16x32_bf16 v[0:3], v[36:39], v[16:19], v[0:3]
    v_mfma_f32_16x16x32_bf16 v[4:7], v[40:43], v[16:19], v[4:7]
    v_mfma_f32_16x16x32_bf16 v[8:11], v[44:47], v[16:19], v[8:11]
    ds_read_b128 v[16:19], v150 offset:16384
    ds_read_b64_tr_b16 v[24:25], v148 offset:18432
    ds_read_b64_tr_b16 v[26:27], v148 offset:18576
    ds_read_b64_tr_b16 v[28:29], v148 offset:18464
    ds_read_b64_tr_b16 v[30:31], v148 offset:18608
    ds_read_b64_tr_b16 v[32:33], v148 offset:18496
    ds_read_b64_tr_b16 v[34:35], v148 offset:18640
    s_waitcnt lgkmcnt(14)
    v_mfma_f32_16x16x32_bf16 v[0:3], v[48:51], v[20:23], v[0:3]
    v_mfma_f32_16x16x32_bf16 v[4:7], v[52:55], v[20:23], v[4:7]
    v_mfma_f32_16x16x32_bf16 v[8:11], v[56:59], v[20:23], v[8:11]
    ds_read_b128 v[20:23], v151 offset:16384
    ds_read_b64_tr_b16 v[36:37], v148 offset:23040
    ds_read_b64_tr_b16 v[38:39], v148 offset:23184
    ds_read_b64_tr_b16 v[40:41], v148 offset:23072
    ds_read_b64_tr_b16 v[42:43], v148 offset:23216
    ds_read_b64_tr_b16 v[44:45], v148 offset:23104
    ds_read_b64_tr_b16 v[46:47], v148 offset:23248
    s_waitcnt lgkmcnt(14)
    v_mfma_f32_16x16x32_bf16 v[0:3], v[60:63], v[12:15], v[0:3]
    v_mfma_f32_16x16x32_bf16 v[4:7], v[64:67], v[12:15], v[4:7]
    v_mfma_f32_16x16x32_bf16 v[8:11], v[68:71], v[12:15], v[8:11]
    ds_read_b128 v[12:15], v150 offset:24576
    ds_read_b64_tr_b16 v[48:49], v148 offset:27648
    ds_read_b64_tr_b16 v[50:51], v148 offset:27792
    ds_read_b64_tr_b16 v[52:53], v148 offset:27680
    ds_read_b64_tr_b16 v[54:55], v148 offset:27824
    ds_read_b64_tr_b16 v[56:57], v148 offset:27712
    ds_read_b64_tr_b16 v[58:59], v148 offset:27856
    s_waitcnt lgkmcnt(14)
    v_mfma_f32_16x16x32_bf16 v[0:3], v[24:27], v[16:19], v[0:3]
    v_mfma_f32_16x16x32_bf16 v[4:7], v[28:31], v[16:19], v[4:7]
    v_mfma_f32_16x16x32_bf16 v[8:11], v[32:35], v[16:19], v[8:11]
    s_cmp_lg_u32 s33, 0
    s_cbranch_scc1 L_noflag_19
    s_cmp_lg_u32 s87, 0
    s_cbranch_scc1 L_noflag_19
    s_getreg_b32 s36, hwreg(HW_REG_IB_STS, 0, 4)
    s_cmp_lg_u32 s36, 0
    s_cbranch_scc1 L_noflag_19
    s_waitcnt vmcnt(0)
    v_readfirstlane_b32 s81, v154
    s_nop 0
    s_cmp_ge_u32 s81, 32
    s_cbranch_scc1 L_initok_21
    v_mov_b32 v152, 0
    s_mov_b32 s80, 0
L_initp_20:
    buffer_load_dword v153, v152, s[68:71], 0 offen sc1
    s_waitcnt vmcnt(0)
    v_readfirstlane_b32 s81, v153
    s_nop 0
    s_cmp_ge_u32 s81, 32
    s_cbranch_scc1 L_initok_21
    s_sleep 4
    s_add_u32 s80, s80, 1
    s_cmp_lt_u32 s80, 0x40000
    s_cbranch_scc1 L_initp_20
L_initok_21:
    s_add_u32 s36, s34, 0
    s_lshr_b32 s37, s36, 4
    s_lshl_b32 s37, s37, 7
    s_and_b32 s36, s36, 15
    s_add_u32 s36, s36, s37
    s_add_u32 s36, s36, 197888
    v_lshlrev_b32 v152, 10, v156
    v_add_u32 v152, s36, v152
    v_mov_b32 v153, 1
    v_cmp_gt_u32 vcc, 32, v156
    s_nop 0
    s_and_saveexec_b64 s[76:77], vcc
    buffer_store_byte v153, v152, s[52:55], 0 offen sc1
    s_mov_b64 exec, s[76:77]
    s_mov_b32 s87, 1
L_noflag_19:
    ds_read_b128 v[16:19], v151 offset:24576
    ds_read_b64_tr_b16 v[60:61], v148 offset:32256
    ds_read_b64_tr_b16 v[62:63], v148 offset:32400
    ds_read_b64_tr_b16 v[64:65], v148 offset:32288
    ds_read_b64_tr_b16 v[66:67], v148 offset:32432
    ds_read_b64_tr_b16 v[68:69], v148 offset:32320
    ds_read_b64_tr_b16 v[70:71], v148 offset:32464
    s_waitcnt lgkmcnt(14)
    v_mfma_f32_16x16x32_bf16 v[0:3], v[36:39], v[20:23], v[0:3]
    v_mfma_f32_16x16x32_bf16 v[4:7], v[40:43], v[20:23], v[4:7]
    v_mfma_f32_16x16x32_bf16 v[8:11], v[44:47], v[20:23], v[8:11]
    ds_read_b128 v[20:23], v150 offset:32768
    ds_read_b64_tr_b16 v[24:25], v148 offset:36864
    ds_read_b64_tr_b16 v[26:27], v148 offset:37008
    ds_read_b64_tr_b16 v[28:29], v148 offset:36896
    ds_read_b64_tr_b16 v[30:31], v148 offset:37040
    ds_read_b64_tr_b16 v[32:33], v148 offset:36928
    ds_read_b64_tr_b16 v[34:35], v148 offset:37072
    s_waitcnt lgkmcnt(14)
    v_mfma_f32_16x16x32_bf16 v[0:3], v[48:51], v[12:15], v[0:3]
    v_mfma_f32_16x16x32_bf16 v[4:7], v[52:55], v[12:15], v[4:7]
    v_mfma_f32_16x16x32_bf16 v[8:11], v[56:59], v[12:15], v[8:11]
    ds_read_b128 v[12:15], v151 offset:32768
    ds_read_b64_tr_b16 v[36:37], v149 offset:0
    ds_read_b64_tr_b16 v[38:39], v149 offset:144
    ds_read_b64_tr_b16 v[40:41], v149 offset:32
    ds_read_b64_tr_b16 v[42:43], v149 offset:176
    ds_read_b64_tr_b16 v[44:45], v149 offset:64
    ds_read_b64_tr_b16 v[46:47], v149 offset:208
    s_waitcnt lgkmcnt(14)
    v_mfma_f32_16x16x32_bf16 v[0:3], v[60:63], v[16:19], v[0:3]
    v_mfma_f32_16x16x32_bf16 v[4:7], v[64:67], v[16:19], v[4:7]
    v_mfma_f32_16x16x32_bf16 v[8:11], v[68:71], v[16:19], v[8:11]
    ds_read_b128 v[16:19], v150 offset:40960
    ds_read_b64_tr_b16 v[48:49], v149 offset:4608
    ds_read_b64_tr_b16 v[50:51], v149 offset:4752
    ds_read_b64_tr_b16 v[52:53], v149 offset:4640
    ds_read_b64_tr_b16 v[54:55], v149 offset:4784
    ds_read_b64_tr_b16 v[56:57], v149 offset:4672
    ds_read_b64_tr_b16 v[58:59], v149 offset:4816
    s_waitcnt lgkmcnt(14)
    v_mfma_f32_16x16x32_bf16 v[0:3], v[24:27], v[20:23], v[0:3]
    v_mfma_f32_16x16x32_bf16 v[4:7], v[28:31], v[20:23], v[4:7]
    v_mfma_f32_16x16x32_bf16 v[8:11], v[32:35], v[20:23], v[8:11]
    s_cmp_lg_u32 s33, 0
    s_cbranch_scc1 L_noflag_22
    s_cmp_lg_u32 s87, 0
    s_cbranch_scc1 L_noflag_22
    s_getreg_b32 s36, hwreg(HW_REG_IB_STS, 0, 4)
    s_cmp_lg_u32 s36, 0
    s_cbranch_scc1 L_noflag_22
    s_waitcnt vmcnt(0)
    v_readfirstlane_b32 s81, v154
    s_nop 0
    s_cmp_ge_u32 s81, 32
    s_cbranch_scc1 L_initok_24
    v_mov_b32 v152, 0
    s_mov_b32 s80, 0
L_initp_23:
    buffer_load_dword v153, v152, s[68:71], 0 offen sc1
    s_waitcnt vmcnt(0)
    v_readfirstlane_b32 s81, v153
    s_nop 0
    s_cmp_ge_u32 s81, 32
    s_cbranch_scc1 L_initok_24
    s_sleep 4
    s_add_u32 s80, s80, 1
    s_cmp_lt_u32 s80, 0x40000
    s_cbranch_scc1 L_initp_23
L_initok_24:
    s_add_u32 s36, s34, 0
    s_lshr_b32 s37, s36, 4
    s_lshl_b32 s37, s37, 7
    s_and_b32 s36, s36, 15
    s_add_u32 s36, s36, s37
    s_add_u32 s36, s36, 197888
    v_lshlrev_b32 v152, 10, v156
    v_add_u32 v152, s36, v152
    v_mov_b32 v153, 1
    v_cmp_gt_u32 vcc, 32, v156
    s_nop 0
    s_and_saveexec_b64 s[76:77], vcc
    buffer_store_byte v153, v152, s[52:55], 0 offen sc1
    s_mov_b64 exec, s[76:77]
    s_mov_b32 s87, 1
L_noflag_22:
    ds_read_b128 v[20:23], v151 offset:40960
    ds_read_b64_tr_b16 v[60:61], v149 offset:9216
    ds_read_b64_tr_b16 v[62:63], v149 offset:9360
    ds_read_b64_tr_b16 v[64:65], v149 offset:9248
    ds_read_b64_tr_b16 v[66:67], v149 offset:9392
    ds_read_b64_tr_b16 v[68:69], v149 offset:9280
    ds_read_b64_tr_b16 v[70:71], v149 offset:9424
    s_waitcnt lgkmcnt(14)
    v_mfma_f32_16x16x32_bf16 v[0:3], v[36:39], v[12:15], v[0:3]
    v_mfma_f32_16x16x32_bf16 v[4:7], v[40:43], v[12:15], v[4:7]
    v_mfma_f32_16x16x32_bf16 v[8:11], v[44:47], v[12:15], v[8:11]
    ds_read_b128 v[12:15], v150 offset:49152
    s_waitcnt lgkmcnt(8)
    v_mfma_f32_16x16x32_bf16 v[0:3], v[48:51], v[16:19], v[0:3]
    v_mfma_f32_16x16x32_bf16 v[4:7], v[52:55], v[16:19], v[4:7]
    v_mfma_f32_16x16x32_bf16 v[8:11], v[56:59], v[16:19], v[8:11]
    ds_read_b128 v[16:19], v151 offset:49152
    s_waitcnt lgkmcnt(2)
    v_mfma_f32_16x16x32_bf16 v[0:3], v[60:63], v[20:23], v[0:3]
    v_mfma_f32_16x16x32_bf16 v[4:7], v[64:67], v[20:23], v[4:7]
    v_mfma_f32_16x16x32_bf16 v[8:11], v[68:71], v[20:23], v[8:11]
    s_cmp_lg_u32 s33, 0
    s_cbranch_scc1 L_noflag_25
    s_cmp_lg_u32 s87, 0
    s_cbranch_scc1 L_noflag_25
    s_getreg_b32 s36, hwreg(HW_REG_IB_STS, 0, 4)
    s_cmp_lg_u32 s36, 0
    s_cbranch_scc1 L_noflag_25
    s_waitcnt vmcnt(0)
    v_readfirstlane_b32 s81, v154
    s_nop 0
    s_cmp_ge_u32 s81, 32
    s_cbranch_scc1 L_initok_27
    v_mov_b32 v152, 0
    s_mov_b32 s80, 0
L_initp_26:
    buffer_load_dword v153, v152, s[68:71], 0 offen sc1
    s_waitcnt vmcnt(0)
    v_readfirstlane_b32 s81, v153
    s_nop 0
    s_cmp_ge_u32 s81, 32
    s_cbranch_scc1 L_initok_27
    s_sleep 4
    s_add_u32 s80, s80, 1
    s_cmp_lt_u32 s80, 0x40000
    s_cbranch_scc1 L_initp_26
L_initok_27:
    s_add_u32 s36, s34, 0
    s_lshr_b32 s37, s36, 4
    s_lshl_b32 s37, s37, 7
    s_and_b32 s36, s36, 15
    s_add_u32 s36, s36, s37
    s_add_u32 s36, s36, 197888
    v_lshlrev_b32 v152, 10, v156
    v_add_u32 v152, s36, v152
    v_mov_b32 v153, 1
    v_cmp_gt_u32 vcc, 32, v156
    s_nop 0
    s_and_saveexec_b64 s[76:77], vcc
    buffer_store_byte v153, v152, s[52:55], 0 offen sc1
    s_mov_b64 exec, s[76:77]
    s_mov_b32 s87, 1
L_noflag_25:
    s_barrier
    ds_read_b128 v[20:23], v150 offset:57344
    ds_read_b64_tr_b16 v[24:25], v149 offset:13824
    ds_read_b64_tr_b16 v[26:27], v149 offset:13968
    ds_read_b64_tr_b16 v[28:29], v149 offset:13856
    ds_read_b64_tr_b16 v[30:31], v149 offset:14000
    ds_read_b64_tr_b16 v[32:33], v149 offset:13888
    ds_read_b64_tr_b16 v[34:35], v149 offset:14032
    ds_read_b64_tr_b16 v[36:37], v149 offset:18432
    ds_read_b64_tr_b16 v[38:39], v149 offset:18576
    ds_read_b64_tr_b16 v[40:41], v149 offset:18464
    ds_read_b64_tr_b16 v[42:43], v149 offset:18608
    ds_read_b64_tr_b16 v[44:45], v149 offset:18496
    ds_read_b64_tr_b16 v[46:47], v149 offset:18640
    ds_read_b64_tr_b16 v[48:49], v149 offset:23040
    ds_read_b64_tr_b16 v[50:51], v149 offset:23184
    ds_read_b64_tr_b16 v[52:53], v149 offset:23072
    ds_read_b64_tr_b16 v[54:55], v149 offset:23216
    ds_read_b64_tr_b16 v[56:57], v149 offset:23104
    ds_read_b64_tr_b16 v[58:59], v149 offset:23248
    s_waitcnt lgkmcnt(12)
    v_mfma_f32_16x16x32_bf16 v[0:3], v[24:27], v[12:15], v[0:3]
    v_mfma_f32_16x16x32_bf16 v[4:7], v[28:31], v[12:15], v[4:7]
    v_mfma_f32_16x16x32_bf16 v[8:11], v[32:35], v[12:15], v[8:11]
    ds_read_b128 v[12:15], v151 offset:57344
    ds_read_b64_tr_b16 v[60:61], v149 offset:27648
    ds_read_b64_tr_b16 v[62:63], v149 offset:27792
    ds_read_b64_tr_b16 v[64:65], v149 offset:27680
    ds_read_b64_tr_b16 v[66:67], v149 offset:27824
    ds_read_b64_tr_b16 v[68:69], v149 offset:27712
    ds_read_b64_tr_b16 v[70:71], v149 offset:27856
    s_waitcnt lgkmcnt(13)
    v_mfma_f32_16x16x32_bf16 v[0:3], v[36:39], v[16:19], v[0:3]
    v_mfma_f32_16x16x32_bf16 v[4:7], v[40:43], v[16:19], v[4:7]
    v_mfma_f32_16x16x32_bf16 v[8:11], v[44:47], v[16:19], v[8:11]
    v_add_u32 v150, 8192, v150
    v_add_u32 v151, 8192, v151
    ds_read_b128 v[16:19], v150 offset:57344
    ds_read_b64_tr_b16 v[24:25], v149 offset:32256
    ds_read_b64_tr_b16 v[26:27], v149 offset:32400
    ds_read_b64_tr_b16 v[28:29], v149 offset:32288
    ds_read_b64_tr_b16 v[30:31], v149 offset:32432
    ds_read_b64_tr_b16 v[32:33], v149 offset:32320
    ds_read_b64_tr_b16 v[34:35], v149 offset:32464
    s_waitcnt lgkmcnt(14)
    v_mfma_f32_16x16x32_bf16 v[0:3], v[48:51], v[20:23], v[0:3]
    v_mfma_f32_16x16x32_bf16 v[4:7], v[52:55], v[20:23], v[4:7]
    v_mfma_f32_16x16x32_bf16 v[8:11], v[56:59], v[20:23], v[8:11]
    ds_read_b128 v[20:23], v151 offset:57344
    ds_read_b64_tr_b16 v[36:37], v149 offset:36864
    ds_read_b64_tr_b16 v[38:39], v149 offset:37008
    ds_read_b64_tr_b16 v[40:41], v149 offset:36896
    ds_read_b64_tr_b16 v[42:43], v149 offset:37040
    ds_read_b64_tr_b16 v[44:45], v149 offset:36928
    ds_read_b64_tr_b16 v[46:47], v149 offset:37072
    s_waitcnt lgkmcnt(14)
    v_mfma_f32_16x16x32_bf16 v[0:3], v[60:63], v[12:15], v[0:3]
    v_mfma_f32_16x16x32_bf16 v[4:7], v[64:67], v[12:15], v[4:7]
    v_mfma_f32_16x16x32_bf16 v[8:11], v[68:71], v[12:15], v[8:11]
    s_waitcnt lgkmcnt(7)
    v_mfma_f32_16x16x32_bf16 v[0:3], v[24:27], v[16:19], v[0:3]
    v_mfma_f32_16x16x32_bf16 v[4:7], v[28:31], v[16:19], v[4:7]
    v_mfma_f32_16x16x32_bf16 v[8:11], v[32:35], v[16:19], v[8:11]
    s_waitcnt lgkmcnt(0)
    v_mfma_f32_16x16x32_bf16 v[0:3], v[36:39], v[20:23], v[0:3]
    v_mfma_f32_16x16x32_bf16 v[4:7], v[40:43], v[20:23], v[4:7]
    v_mfma_f32_16x16x32_bf16 v[8:11], v[44:47], v[20:23], v[8:11]
    s_nop 7
    s_lshl_b32 s36, s39, 4
    v_add_u32 v80, s36, v159
    v_mul_u32_u24 v80, 144, v80
    v_lshl_add_u32 v80, v160, 3, v80
    s_mul_i32 s36, s40, 96
    s_add_u32 s36, s36, 73728
    v_add_u32 v80, s36, v80
    s_mov_b32 s36, 0x3eae1a93
    v_mul_f32 v72, s36, v0
    v_mul_f32 v73, s36, v1
    v_mul_f32 v74, s36, v2
    v_mul_f32 v75, s36, v3
    v_cvt_pk_bf16_f32 v16, v72, v73
    v_cvt_pk_bf16_f32 v17, v74, v75
    ds_write_b64 v80, v[16:17] offset:0
    v_mul_f32 v72, s36, v4
    v_mul_f32 v73, s36, v5
    v_mul_f32 v74, s36, v6
    v_mul_f32 v75, s36, v7
    v_cvt_pk_bf16_f32 v18, v72, v73
    v_cvt_pk_bf16_f32 v19, v74, v75
    ds_write_b64 v80, v[18:19] offset:32
    v_mul_f32 v72, s36, v8
    v_mul_f32 v73, s36, v9
    v_mul_f32 v74, s36, v10
    v_mul_f32 v75, s36, v11
    v_cvt_pk_bf16_f32 v20, v72, v73
    v_cvt_pk_bf16_f32 v21, v74, v75
    ds_write_b64 v80, v[20:21] offset:64
    s_cmp_lg_u32 s33, 0
    s_cbranch_scc1 L_noflag_28
    s_cmp_lg_u32 s87, 0
    s_cbranch_scc1 L_noflag_28
    s_waitcnt vmcnt(0)
    v_readfirstlane_b32 s81, v154
    s_nop 0
    s_cmp_ge_u32 s81, 32
    s_cbranch_scc1 L_initok_30
    v_mov_b32 v152, 0
    s_mov_b32 s80, 0
L_initp_29:
    buffer_load_dword v153, v152, s[68:71], 0 offen sc1
    s_waitcnt vmcnt(0)
    v_readfirstlane_b32 s81, v153
    s_nop 0
    s_cmp_ge_u32 s81, 32
    s_cbranch_scc1 L_initok_30
    s_sleep 4
    s_add_u32 s80, s80, 1
    s_cmp_lt_u32 s80, 0x40000
    s_cbranch_scc1 L_initp_29
L_initok_30:
    s_add_u32 s36, s34, 0
    s_lshr_b32 s37, s36, 4
    s_lshl_b32 s37, s37, 7
    s_and_b32 s36, s36, 15
    s_add_u32 s36, s36, s37
    s_add_u32 s36, s36, 197888
    v_lshlrev_b32 v152, 10, v156
    v_add_u32 v152, s36, v152
    v_mov_b32 v153, 1
    v_cmp_gt_u32 vcc, 32, v156
    s_nop 0
    s_and_saveexec_b64 s[76:77], vcc
    buffer_store_byte v153, v152, s[52:55], 0 offen sc1
    s_mov_b64 exec, s[76:77]
    s_mov_b32 s87, 1
L_noflag_28:
    s_branch L_p1e_18
L_p1f1_17:
    s_barrier
    ds_read_b128 v[12:15], v150 offset:0
    ds_read_b128 v[16:19], v151 offset:0
    ds_read_b128 v[20:23], v150 offset:8192
    ds_read_b64_tr_b16 v[24:25], v148 offset:0
    ds_read_b64_tr_b16 v[26:27], v148 offset:144
    ds_read_b64_tr_b16 v[28:29], v148 offset:32
    ds_read_b64_tr_b16 v[30:31], v148 offset:176
    ds_read_b64_tr_b16 v[32:33], v148 offset:4608
    ds_read_b64_tr_b16 v[34:35], v148 offset:4752
    ds_read_b64_tr_b16 v[36:37], v148 offset:4640
    ds_read_b64_tr_b16 v[38:39], v148 offset:4784
    ds_read_b64_tr_b16 v[40:41], v148 offset:9216
    ds_read_b64_tr_b16 v[42:43], v148 offset:9360
    ds_read_b64_tr_b16 v[44:45], v148 offset:9248
    ds_read_b64_tr_b16 v[46:47], v148 offset:9392
    s_waitcnt lgkmcnt(8)
    v_mfma_f32_16x16x32_bf16 v[0:3], v[24:27], v[12:15], 0
    v_mfma_f32_16x16x32_bf16 v[4:7], v[28:31], v[12:15], 0
    ds_read_b128 v[12:15], v151 offset:8192
    ds_read_b64_tr_b16 v[48:49], v148 offset:13824
    ds_read_b64_tr_b16 v[50:51], v148 offset:13968
    ds_read_b64_tr_b16 v[52:53], v148 offset:13856
    ds_read_b64_tr_b16 v[54:55], v148 offset:14000
    s_waitcnt lgkmcnt(9)
    v_mfma_f32_16x16x32_bf16 v[0:3], v[32:35], v[16:19], v[0:3]
    v_mfma_f32_16x16x32_bf16 v[4:7], v[36:39], v[16:19], v[4:7]
    ds_read_b128 v[16:19], v150 offset:16384
    ds_read_b64_tr_b16 v[24:25], v148 offset:18432
    ds_read_b64_tr_b16 v[26:27], v148 offset:18576
    ds_read_b64_tr_b16 v[28:29], v148 offset:18464
    ds_read_b64_tr_b16 v[30:31], v148 offset:18608
    s_waitcnt lgkmcnt(10)
    v_mfma_f32_16x16x32_bf16 v[0:3], v[40:43], v[20:23], v[0:3]
    v_mfma_f32_16x16x32_bf16 v[4:7], v[44:47], v[20:23], v[4:7]
    ds_read_b128 v[20:23], v151 offset:16384
    ds_read_b64_tr_b16 v[32:33], v148 offset:23040
    ds_read_b64_tr_b16 v[34:35], v148 offset:23184
    ds_read_b64_tr_b16 v[36:37], v148 offset:23072
    ds_read_b64_tr_b16 v[38:39], v148 offset:23216
    s_waitcnt lgkmcnt(10)
    v_mfma_f32_16x16x32_bf16 v[0:3], v[48:51], v[12:15], v[0:3]
    v_mfma_f32_16x16x32_bf16 v[4:7], v[52:55], v[12:15], v[4:7]
    ds_read_b128 v[12:15], v150 offset:24576
    ds_read_b64_tr_b16 v[40:41], v148 offset:27648
    ds_read_b64_tr_b16 v[42:43], v148 offset:27792
    ds_read_b64_tr_b16 v[44:45], v148 offset:27680
    ds_read_b64_tr_b16 v[46:47], v148 offset:27824
    s_waitcnt lgkmcnt(10)
    v_mfma_f32_16x16x32_bf16 v[0:3], v[24:27], v[16:19], v[0:3]
    v_mfma_f32_16x16x32_bf16 v[4:7], v[28:31], v[16:19], v[4:7]
    ds_read_b128 v[16:19], v151 offset:24576
    ds_read_b64_tr_b16 v[48:49], v148 offset:32256
    ds_read_b64_tr_b16 v[50:51], v148 offset:32400
    ds_read_b64_tr_b16 v[52:53], v148 offset:32288
    ds_read_b64_tr_b16 v[54:55], v148 offset:32432
    s_waitcnt lgkmcnt(10)
    v_mfma_f32_16x16x32_bf16 v[0:3], v[32:35], v[20:23], v[0:3]
    v_mfma_f32_16x16x32_bf16 v[4:7], v[36:39], v[20:23], v[4:7]
    ds_read_b128 v[20:23], v150 offset:32768
    ds_read_b64_tr_b16 v[24:25], v148 offset:36864
    ds_read_b64_tr_b16 v[26:27], v148 offset:37008
    ds_read_b64_tr_b16 v[28:29], v148 offset:36896
    ds_read_b64_tr_b16 v[30:31], v148 offset:37040
    s_waitcnt lgkmcnt(10)
    v_mfma_f32_16x16x32_bf16 v[0:3], v[40:43], v[12:15], v[0:3]
    v_mfma_f32_16x16x32_bf16 v[4:7], v[44:47], v[12:15], v[4:7]
    ds_read_b128 v[12:15], v151 offset:32768
    ds_read_b64_tr_b16 v[32:33], v149 offset:0
    ds_read_b64_tr_b16 v[34:35], v149 offset:144
    ds_read_b64_tr_b16 v[36:37], v149 offset:32
    ds_read_b64_tr_b16 v[38:39], v149 offset:176
    s_waitcnt lgkmcnt(10)
    v_mfma_f32_16x16x32_bf16 v[0:3], v[48:51], v[16:19], v[0:3]
    v_mfma_f32_16x16x32_bf16 v[4:7], v[52:55], v[16:19], v[4:7]
    ds_read_b128 v[16:19], v150 offset:40960
    ds_read_b64_tr_b16 v[40:41], v149 offset:4608
    ds_read_b64_tr_b16 v[42:43], v149 offset:4752
    ds_read_b64_tr_b16 v[44:45], v149 offset:4640
    ds_read_b64_tr_b16 v[46:47], v149 offset:4784
    s_waitcnt lgkmcnt(10)
    v_mfma_f32_16x16x32_bf16 v[0:3], v[24:27], v[20:23], v[0:3]
    v_mfma_f32_16x16x32_bf16 v[4:7], v[28:31], v[20:23], v[4:7]
    ds_read_b128 v[20:23], v151 offset:40960
    ds_read_b64_tr_b16 v[48:49], v149 offset:9216
    ds_read_b64_tr_b16 v[50:51], v149 offset:9360
    ds_read_b64_tr_b16 v[52:53], v149 offset:9248
    ds_read_b64_tr_b16 v[54:55], v149 offset:9392
    s_waitcnt lgkmcnt(10)
    v_mfma_f32_16x16x32_bf16 v[0:3], v[32:35], v[12:15], v[0:3]
    v_mfma_f32_16x16x32_bf16 v[4:7], v[36:39], v[12:15], v[4:7]
    ds_read_b128 v[12:15], v150 offset:49152
    s_waitcnt lgkmcnt(6)
    v_mfma_f32_16x16x32_bf16 v[0:3], v[40:43], v[16:19], v[0:3]
    v_mfma_f32_16x16x32_bf16 v[4:7], v[44:47], v[16:19], v[4:7]
    ds_read_b128 v[16:19], v151 offset:49152
    s_waitcnt lgkmcnt(2)
    v_mfma_f32_16x16x32_bf16 v[0:3], v[48:51], v[20:23], v[0:3]
    v_mfma_f32_16x16x32_bf16 v[4:7], v[52:55], v[20:23], v[4:7]
    s_barrier
    ds_read_b128 v[20:23], v150 offset:57344
    ds_read_b64_tr_b16 v[24:25], v149 offset:13824
    ds_read_b64_tr_b16 v[26:27], v149 offset:13968
    ds_read_b64_tr_b16 v[28:29], v149 offset:13856
    ds_read_b64_tr_b16 v[30:31], v149 offset:14000
    ds_read_b64_tr_b16 v[32:33], v149 offset:18432
    ds_read_b64_tr_b16 v[34:35], v149 offset:18576
    ds_read_b64_tr_b16 v[36:37], v149 offset:18464
    ds_read_b64_tr_b16 v[38:39], v149 offset:18608
    ds_read_b64_tr_b16 v[40:41], v149 offset:23040
    ds_read_b64_tr_b16 v[42:43], v149 offset:23184
    ds_read_b64_tr_b16 v[44:45], v149 offset:23072
    ds_read_b64_tr_b16 v[46:47], v149 offset:23216
    s_waitcnt lgkmcnt(8)
    v_mfma_f32_16x16x32_bf16 v[0:3], v[24:27], v[12:15], v[0:3]
    v_mfma_f32_16x16x32_bf16 v[4:7], v[28:31], v[12:15], v[4:7]
    ds_read_b128 v[12:15], v151 offset:57344
    ds_read_b64_tr_b16 v[48:49], v149 offset:27648
    ds_read_b64_tr_b16 v[50:51], v149 offset:27792
    ds_read_b64_tr_b16 v[52:53], v149 offset:27680
    ds_read_b64_tr_b16 v[54:55], v149 offset:27824
    s_waitcnt lgkmcnt(9)
    v_mfma_f32_16x16x32_bf16 v[0:3], v[32:35], v[16:19], v[0:3]
    v_mfma_f32_16x16x32_bf16 v[4:7], v[36:39], v[16:19], v[4:7]
    v_add_u32 v150, 8192, v150
    v_add_u32 v151, 8192, v151
    ds_read_b128 v[16:19], v150 offset:57344
    ds_read_b64_tr_b16 v[24:25], v149 offset:32256
    ds_read_b64_tr_b16 v[26:27], v149 offset:32400
    ds_read_b64_tr_b16 v[28:29], v149 offset:32288
    ds_read_b64_tr_b16 v[30:31], v149 offset:32432
    s_waitcnt lgkmcnt(10)
    v_mfma_f32_16x16x32_bf16 v[0:3], v[40:43], v[20:23], v[0:3]
    v_mfma_f32_16x16x32_bf16 v[4:7], v[44:47], v[20:23], v[4:7]
    ds_read_b128 v[20:23], v151 offset:57344
    ds_read_b64_tr_b16 v[32:33], v149 offset:36864
    ds_read_b64_tr_b16 v[34:35], v149 offset:37008
    ds_read_b64_tr_b16 v[36:37], v149 offset:36896
    ds_read_b64_tr_b16 v[38:39], v149 offset:37040
    s_waitcnt lgkmcnt(10)
    v_mfma_f32_16x16x32_bf16 v[0:3], v[48:51], v[12:15], v[0:3]
    v_mfma_f32_16x16x32_bf16 v[4:7], v[52:55], v[12:15], v[4:7]
    s_waitcnt lgkmcnt(5)
    v_mfma_f32_16x16x32_bf16 v[0:3], v[24:27], v[16:19], v[0:3]
    v_mfma_f32_16x16x32_bf16 v[4:7], v[28:31], v[16:19], v[4:7]
    s_waitcnt lgkmcnt(0)
    v_mfma_f32_16x16x32_bf16 v[0:3], v[32:35], v[20:23], v[0:3]
    v_mfma_f32_16x16x32_bf16 v[4:7], v[36:39], v[20:23], v[4:7]
    s_nop 7
    s_lshl_b32 s36, s39, 4
    v_add_u32 v80, s36, v159
    v_mul_u32_u24 v80, 144, v80
    v_lshl_add_u32 v80, v160, 3, v80
    s_mul_i32 s36, s40, 96
    s_add_u32 s36, s36, 73728
    v_add_u32 v80, s36, v80
    s_mov_b32 s36, 0x3eae1a93
    v_mul_f32 v72, s36, v0
    v_mul_f32 v73, s36, v1
    v_mul_f32 v74, s36, v2
    v_mul_f32 v75, s36, v3
    v_cvt_pk_bf16_f32 v16, v72, v73
    v_cvt_pk_bf16_f32 v17, v74, v75
    ds_write_b64 v80, v[16:17] offset:0
    v_mul_f32 v72, s36, v4
    v_mul_f32 v73, s36, v5
    v_mul_f32 v74, s36, v6
    v_mul_f32 v75, s36, v7
    v_cvt_pk_bf16_f32 v18, v72, v73
    v_cvt_pk_bf16_f32 v19, v74, v75
    v_cmp_gt_u32 vcc, 2, v160
    s_nop 0
    s_and_saveexec_b64 s[76:77], vcc
    ds_write_b64 v80, v[18:19] offset:32
    s_mov_b64 exec, s[76:77]
L_p1e_18:
    s_waitcnt lgkmcnt(0)
    s_barrier
    s_mul_i32 s36, s35, 144
    s_mul_i32 s37, s40, 96
    s_add_u32 s36, s36, s37
    s_lshl_b32 s37, s39, 4
    v_add_u32 v72, s37, v159
    v_lshlrev_b32 v72, 7, v72
    v_lshrrev_b32 v73, 1, v159
    v_lshlrev_b32 v74, 3, v160
    v_add_u32 v74, s36, v74
    v_lshrrev_b32 v75, 7, v74
    v_lshl_add_u32 v75, v75, 13, v72
    v_bfe_u32 v76, v74, 4, 3
    v_xor_b32 v76, v76, v73
    v_lshl_add_u32 v75, v76, 4, v75
    v_and_b32 v74, 8, v74
    v_add_u32 v75, v75, v74
    ds_read_b64 v[162:163], v75
    v_lshlrev_b32 v74, 3, v160
    v_add_u32 v74, s36, v74
    v_add_u32 v74, 32, v74
    v_lshrrev_b32 v75, 7, v74
    v_lshl_add_u32 v75, v75, 13, v72
    v_bfe_u32 v76, v74, 4, 3
    v_xor_b32 v76, v76, v73
    v_lshl_add_u32 v75, v76, 4, v75
    v_and_b32 v74, 8, v74
    v_add_u32 v75, v75, v74
    ds_read_b64 v[164:165], v75
    v_lshlrev_b32 v74, 3, v160
    v_add_u32 v74, s36, v74
    v_add_u32 v74, 64, v74
    v_lshrrev_b32 v75, 7, v74
    v_lshl_add_u32 v75, v75, 13, v72
    v_bfe_u32 v76, v74, 4, 3
    v_xor_b32 v76, v76, v73
    v_lshl_add_u32 v75, v76, 4, v75
    v_and_b32 v74, 8, v74
    v_add_u32 v75, v75, v74
    ds_read_b64 v[166:167], v75
    s_branch L_dj_7
L_dv_5:
    s_mov_b32 s56, s10
    s_and_b32 s57, s11, 0xffff
    s_mov_b32 s58, 20736
    s_mov_b32 s59, 0x20000
    s_lshl_b32 s36, s33, 6
    s_add_u32 s36, s36, 0
    v_add_u32 v72, s36, v156
    v_mul_u32_u24 v72, 12, v72
    buffer_load_dwordx3 v[56:58], v72, s[56:59], 0 offen
    s_lshl_b32 s36, s33, 6
    s_add_u32 s36, s36, 512
    v_add_u32 v72, s36, v156
    v_mul_u32_u24 v72, 12, v72
    buffer_load_dwordx3 v[60:62], v72, s[56:59], 0 offen
    s_lshl_b32 s36, s33, 6
    s_add_u32 s36, s36, 1024
    v_add_u32 v72, s36, v156
    v_mul_u32_u24 v72, 12, v72
    buffer_load_dwordx3 v[64:66], v72, s[56:59], 0 offen
    s_cmp_ge_u32 s33, 3
    s_cbranch_scc1 L_elskip_31
    s_lshl_b32 s36, s33, 6
    s_add_u32 s36, s36, 1536
    v_add_u32 v72, s36, v156
    v_mul_u32_u24 v72, 12, v72
    buffer_load_dwordx3 v[68:70], v72, s[56:59], 0 offen
L_elskip_31:
    s_lshl_b32 s36, s39, 4
    v_add_u32 v72, s36, v159
    v_lshlrev_b32 v72, 7, v72
    v_lshrrev_b32 v73, 1, v159
    v_xor_b32 v73, v73, v160
    v_lshl_add_u32 v150, v73, 4, v72
    v_xor_b32 v151, 64, v150
    v_bfe_u32 v72, v156, 2, 2
    v_lshlrev_b32 v72, 1, v72
    v_lshl_add_u32 v72, v160, 3, v72
    v_mul_u32_u24 v72, 144, v72
    v_and_b32 v73, 3, v156
    v_lshl_add_u32 v72, v73, 3, v72
    s_mul_i32 s36, s40, 96
    s_add_u32 s36, s36, 73728
    v_add_u32 v148, s36, v72
    v_add_u32 v149, 41472, v148
    v_bfe_u32 v72, v156, 2, 2
    v_lshl_add_u32 v72, v160, 3, v72
    v_and_b32 v73, 1, v160
    v_lshl_add_u32 v74, v73, 2, v72
    v_xor_b32 v73, 1, v73
    v_lshl_add_u32 v75, v73, 2, v72
    v_and_b32 v73, 3, v156
    v_lshlrev_b32 v73, 3, v73
    v_lshl_add_u32 v52, v74, 5, v73
    v_lshl_add_u32 v53, v75, 5, v73
    v_add_u32 v52, 129024, v52
    v_add_u32 v53, 129024, v53
    v_lshlrev_b32 v54, 3, v72
    v_add_u32 v54, 147456, v54
    s_mul_i32 s38, s39, 608
    s_add_u32 s38, s38, 156672
    v_bfe_u32 v72, v159, 2, 1
    v_mul_u32_u24 v72, 304, v72
    v_lshrrev_b32 v73, 3, v159
    v_and_b32 v74, 3, v159
    v_lshl_add_u32 v73, v73, 2, v74
    v_lshl_add_u32 v72, v73, 1, v72
    v_add_u32 v55, s38, v72
    s_cmp_eq_u32 s40, 0
    s_cbranch_scc0 L_vae_32
    v_and_b32 v73, 1, v160
    v_lshrrev_b32 v74, 1, v160
    v_lshl_add_u32 v73, v73, 1, v74
    v_lshl_add_u32 v55, v73, 6, v55
L_vae_32:
    s_lshl_b32 s36, s33, 6
    s_add_u32 s36, s36, 0
    v_add_u32 v76, s36, v156
    v_mul_u32_u24 v77, 21846, v76
    v_lshrrev_b32 v77, 16, v77
    v_mul_u32_u24 v78, 3, v77
    v_sub_u32 v78, v76, v78
    v_lshrrev_b32 v79, 1, v77
    v_and_b32 v79, 4, v79
    v_xor_b32 v79, v77, v79
    v_lshlrev_b32 v79, 5, v79
    v_mul_u32_u24 v80, 12, v78
    v_add_u32 v79, v79, v80
    v_add_u32 v32, 129024, v79
    v_lshlrev_b32 v80, 3, v77
    v_add_u32 v80, 147456, v80
    v_add_u32 v81, 8, v32
    v_cmp_eq_u32 vcc, 2, v78
    s_nop 1
    v_cndmask_b32 v33, v81, v80, vcc
    s_lshl_b32 s36, s33, 6
    s_add_u32 s36, s36, 512
    v_add_u32 v76, s36, v156
    v_mul_u32_u24 v77, 21846, v76
    v_lshrrev_b32 v77, 16, v77
    v_mul_u32_u24 v78, 3, v77
    v_sub_u32 v78, v76, v78
    v_lshrrev_b32 v79, 1, v77
    v_and_b32 v79, 4, v79
    v_xor_b32 v79, v77, v79
    v_lshlrev_b32 v79, 5, v79
    v_mul_u32_u24 v80, 12, v78
    v_add_u32 v79, v79, v80
    v_add_u32 v34, 129024, v79
    v_lshlrev_b32 v80, 3, v77
    v_add_u32 v80, 147456, v80
    v_add_u32 v81, 8, v34
    v_cmp_eq_u32 vcc, 2, v78
    s_nop 1
    v_cndmask_b32 v35, v81, v80, vcc
    s_lshl_b32 s36, s33, 6
    s_add_u32 s36, s36, 1024
    v_add_u32 v76, s36, v156
    v_mul_u32_u24 v77, 21846, v76
    v_lshrrev_b32 v77, 16, v77
    v_mul_u32_u24 v78, 3, v77
    v_sub_u32 v78, v76, v78
    v_lshrrev_b32 v79, 1, v77
    v_and_b32 v79, 4, v79
    v_xor_b32 v79, v77, v79
    v_lshlrev_b32 v79, 5, v79
    v_mul_u32_u24 v80, 12, v78
    v_add_u32 v79, v79, v80
    v_add_u32 v36, 129024, v79
    v_lshlrev_b32 v80, 3, v77
    v_add_u32 v80, 147456, v80
    v_add_u32 v81, 8, v36
    v_cmp_eq_u32 vcc, 2, v78
    s_nop 1
    v_cndmask_b32 v37, v81, v80, vcc
    s_lshl_b32 s36, s33, 6
    s_add_u32 s36, s36, 1536
    v_add_u32 v76, s36, v156
    v_mul_u32_u24 v77, 21846, v76
    v_lshrrev_b32 v77, 16, v77
    v_mul_u32_u24 v78, 3, v77
    v_sub_u32 v78, v76, v78
    v_lshrrev_b32 v79, 1, v77
    v_and_b32 v79, 4, v79
    v_xor_b32 v79, v77, v79
    v_lshlrev_b32 v79, 5, v79
    v_mul_u32_u24 v80, 12, v78
    v_add_u32 v79, v79, v80
    v_add_u32 v38, 129024, v79
    v_lshlrev_b32 v80, 3, v77
    v_add_u32 v80, 147456, v80
    v_add_u32 v81, 8, v38
    v_cmp_eq_u32 vcc, 2, v78
    s_nop 1
    v_cndmask_b32 v39, v81, v80, vcc
    s_waitcnt vmcnt(0)
    ds_write2_b32 v32, v56, v57 offset0:0 offset1:1
    ds_write_b32 v33, v58
    ds_write2_b32 v34, v60, v61 offset0:0 offset1:1
    ds_write_b32 v35, v62
    ds_write2_b32 v36, v64, v65 offset0:0 offset1:1
    ds_write_b32 v37, v66
    s_cmp_ge_u32 s33, 3
    s_cbranch_scc1 L_ewskip_33
    ds_write2_b32 v38, v68, v69 offset0:0 offset1:1
    ds_write_b32 v39, v70
L_ewskip_33:
    s_waitcnt lgkmcnt(0)
    s_barrier
    s_cmp_eq_u32 s40, 0
    s_cbranch_scc0 L_v1_34
    ds_read_b128 v[32:35], v150 offset:0
    ds_read_b64_tr_b16 v[16:17], v52 offset:0
    ds_read_b64_tr_b16 v[18:19], v53 offset:0
    ds_read_b128 v[36:39], v151 offset:0
    ds_read_b64_tr_b16 v[20:21], v52 offset:1024
    ds_read_b64_tr_b16 v[22:23], v53 offset:1024
    ds_read_b128 v[40:43], v150 offset:8192
    ds_read_b64_tr_b16 v[24:25], v52 offset:2048
    ds_read_b64_tr_b16 v[26:27], v53 offset:2048
    ds_read_b128 v[44:47], v151 offset:8192
    ds_read_b64_tr_b16 v[28:29], v52 offset:3072
    ds_read_b64_tr_b16 v[30:31], v53 offset:3072
    s_waitcnt lgkmcnt(9)
    v_mfma_f32_16x16x32_bf16 v[12:15], v[16:19], v[32:35], 0
    ds_read_b128 v[32:35], v150 offset:16384
    ds_read_b64_tr_b16 v[16:17], v52 offset:4096
    ds_read_b64_tr_b16 v[18:19], v53 offset:4096
    s_waitcnt lgkmcnt(9)
    v_mfma_f32_16x16x32_bf16 v[12:15], v[20:23], v[36:39], v[12:15]
    ds_read_b128 v[36:39], v151 offset:16384
    ds_read_b64_tr_b16 v[20:21], v52 offset:5120
    ds_read_b64_tr_b16 v[22:23], v53 offset:5120
    s_waitcnt lgkmcnt(9)
    v_mfma_f32_16x16x32_bf16 v[12:15], v[24:27], v[40:43], v[12:15]
    ds_read_b128 v[40:43], v150 offset:24576
    ds_read_b64_tr_b16 v[24:25], v52 offset:6144
    ds_read_b64_tr_b16 v[26:27], v53 offset:6144
    s_waitcnt lgkmcnt(9)
    v_mfma_f32_16x16x32_bf16 v[12:15], v[28:31], v[44:47], v[12:15]
    ds_read_b128 v[44:47], v151 offset:24576
    ds_read_b64_tr_b16 v[28:29], v52 offset:7168
    ds_read_b64_tr_b16 v[30:31], v53 offset:7168
    s_waitcnt lgkmcnt(9)
    v_mfma_f32_16x16x32_bf16 v[12:15], v[16:19], v[32:35], v[12:15]
    ds_read_b128 v[32:35], v150 offset:32768
    ds_read_b64_tr_b16 v[16:17], v52 offset:8192
    ds_read_b64_tr_b16 v[18:19], v53 offset:8192
    s_waitcnt lgkmcnt(9)
    v_mfma_f32_16x16x32_bf16 v[12:15], v[20:23], v[36:39], v[12:15]
    ds_read_b128 v[36:39], v151 offset:32768
    ds_read_b64_tr_b16 v[20:21], v52 offset:9216
    ds_read_b64_tr_b16 v[22:23], v53 offset:9216
    s_waitcnt lgkmcnt(9)
    v_mfma_f32_16x16x32_bf16 v[12:15], v[24:27], v[40:43], v[12:15]
    ds_read_b128 v[40:43], v150 offset:40960
    ds_read_b64_tr_b16 v[24:25], v52 offset:10240
    ds_read_b64_tr_b16 v[26:27], v53 offset:10240
    s_waitcnt lgkmcnt(9)
    v_mfma_f32_16x16x32_bf16 v[12:15], v[28:31], v[44:47], v[12:15]
    ds_read_b128 v[44:47], v151 offset:40960
    ds_read_b64_tr_b16 v[28:29], v52 offset:11264
    ds_read_b64_tr_b16 v[30:31], v53 offset:11264
    s_waitcnt lgkmcnt(9)
    v_mfma_f32_16x16x32_bf16 v[12:15], v[16:19], v[32:35], v[12:15]
    ds_read_b128 v[32:35], v150 offset:49152
    ds_read_b64_tr_b16 v[16:17], v52 offset:12288
    ds_read_b64_tr_b16 v[18:19], v53 offset:12288
    s_waitcnt lgkmcnt(9)
    v_mfma_f32_16x16x32_bf16 v[12:15], v[20:23], v[36:39], v[12:15]
    ds_read_b128 v[36:39], v151 offset:49152
    ds_read_b64_tr_b16 v[20:21], v52 offset:13312
    ds_read_b64_tr_b16 v[22:23], v53 offset:13312
    s_waitcnt lgkmcnt(9)
    v_mfma_f32_16x16x32_bf16 v[12:15], v[24:27], v[40:43], v[12:15]
    ds_read_b128 v[40:43], v150 offset:57344
    ds_read_b64_tr_b16 v[24:25], v52 offset:14336
    ds_read_b64_tr_b16 v[26:27], v53 offset:14336
    s_waitcnt lgkmcnt(9)
    v_mfma_f32_16x16x32_bf16 v[12:15], v[28:31], v[44:47], v[12:15]
    ds_read_b128 v[44:47], v151 offset:57344
    ds_read_b64_tr_b16 v[28:29], v52 offset:15360
    ds_read_b64_tr_b16 v[30:31], v53 offset:15360
    s_waitcnt lgkmcnt(9)
    v_mfma_f32_16x16x32_bf16 v[12:15], v[16:19], v[32:35], v[12:15]
    v_add_u32 v150, 8192, v150
    v_add_u32 v151, 8192, v151
    ds_read_b128 v[32:35], v150 offset:57344
    ds_read_b64_tr_b16 v[16:17], v52 offset:16384
    ds_read_b64_tr_b16 v[18:19], v53 offset:16384
    s_waitcnt lgkmcnt(9)
    v_mfma_f32_16x16x32_bf16 v[12:15], v[20:23], v[36:39], v[12:15]
    ds_read_b128 v[36:39], v151 offset:57344
    ds_read_b64_tr_b16 v[20:21], v52 offset:17408
    ds_read_b64_tr_b16 v[22:23], v53 offset:17408
    s_waitcnt lgkmcnt(9)
    v_mfma_f32_16x16x32_bf16 v[12:15], v[24:27], v[40:43], v[12:15]
    s_waitcnt lgkmcnt(6)
    v_mfma_f32_16x16x32_bf16 v[12:15], v[28:31], v[44:47], v[12:15]
    s_waitcnt lgkmcnt(3)
    v_mfma_f32_16x16x32_bf16 v[12:15], v[16:19], v[32:35], v[12:15]
    s_waitcnt lgkmcnt(0)
    v_mfma_f32_16x16x32_bf16 v[12:15], v[20:23], v[36:39], v[12:15]
    v_subrev_u32 v150, 8192, v150
    v_subrev_u32 v151, 8192, v151
    s_nop 7
    v_cvt_pk_bf16_f32 v82, v12, v13
    v_cvt_pk_bf16_f32 v83, v14, v15
    ds_write_b16 v55, v82
    ds_write_b16_d16_hi v55, v82 offset:16
    ds_write_b16 v55, v83 offset:32
    ds_write_b16_d16_hi v55, v83 offset:48
    s_branch L_ve_35
L_v1_34:
    ds_read_b128 v[32:35], v150 offset:0
    ds_read_b64_tr_b16 v[16:17], v54 offset:0
    ds_read_b64_tr_b16 v[18:19], v54 offset:32
    ds_read_b128 v[36:39], v151 offset:0
    ds_read_b64_tr_b16 v[20:21], v54 offset:256
    ds_read_b64_tr_b16 v[22:23], v54 offset:288
    ds_read_b128 v[40:43], v150 offset:8192
    ds_read_b64_tr_b16 v[24:25], v54 offset:512
    ds_read_b64_tr_b16 v[26:27], v54 offset:544
    ds_read_b128 v[44:47], v151 offset:8192
    ds_read_b64_tr_b16 v[28:29], v54 offset:768
    ds_read_b64_tr_b16 v[30:31], v54 offset:800
    s_waitcnt lgkmcnt(9)
    v_mfma_f32_16x16x32_bf16 v[12:15], v[16:19], v[32:35], 0
    ds_read_b128 v[32:35], v150 offset:16384
    ds_read_b64_tr_b16 v[16:17], v54 offset:1024
    ds_read_b64_tr_b16 v[18:19], v54 offset:1056
    s_waitcnt lgkmcnt(9)
    v_mfma_f32_16x16x32_bf16 v[12:15], v[20:23], v[36:39], v[12:15]
    ds_read_b128 v[36:39], v151 offset:16384
    ds_read_b64_tr_b16 v[20:21], v54 offset:1280
    ds_read_b64_tr_b16 v[22:23], v54 offset:1312
    s_waitcnt lgkmcnt(9)
    v_mfma_f32_16x16x32_bf16 v[12:15], v[24:27], v[40:43], v[12:15]
    ds_read_b128 v[40:43], v150 offset:24576
    ds_read_b64_tr_b16 v[24:25], v54 offset:1536
    ds_read_b64_tr_b16 v[26:27], v54 offset:1568
    s_waitcnt lgkmcnt(9)
    v_mfma_f32_16x16x32_bf16 v[12:15], v[28:31], v[44:47], v[12:15]
    ds_read_b128 v[44:47], v151 offset:24576
    ds_read_b64_tr_b16 v[28:29], v54 offset:1792
    ds_read_b64_tr_b16 v[30:31], v54 offset:1824
    s_waitcnt lgkmcnt(9)
    v_mfma_f32_16x16x32_bf16 v[12:15], v[16:19], v[32:35], v[12:15]
    ds_read_b128 v[32:35], v150 offset:32768
    ds_read_b64_tr_b16 v[16:17], v54 offset:2048
    ds_read_b64_tr_b16 v[18:19], v54 offset:2080
    s_waitcnt lgkmcnt(9)
    v_mfma_f32_16x16x32_bf16 v[12:15], v[20:23], v[36:39], v[12:15]
    ds_read_b128 v[36:39], v151 offset:32768
    ds_read_b64_tr_b16 v[20:21], v54 offset:2304
    ds_read_b64_tr_b16 v[22:23], v54 offset:2336
    s_waitcnt lgkmcnt(9)
    v_mfma_f32_16x16x32_bf16 v[12:15], v[24:27], v[40:43], v[12:15]
    ds_read_b128 v[40:43], v150 offset:40960
    ds_read_b64_tr_b16 v[24:25], v54 offset:2560
    ds_read_b64_tr_b16 v[26:27], v54 offset:2592
    s_waitcnt lgkmcnt(9)
    v_mfma_f32_16x16x32_bf16 v[12:15], v[28:31], v[44:47], v[12:15]
    ds_read_b128 v[44:47], v151 offset:40960
    ds_read_b64_tr_b16 v[28:29], v54 offset:2816
    ds_read_b64_tr_b16 v[30:31], v54 offset:2848
    s_waitcnt lgkmcnt(9)
    v_mfma_f32_16x16x32_bf16 v[12:15], v[16:19], v[32:35], v[12:15]
    ds_read_b128 v[32:35], v150 offset:49152
    ds_read_b64_tr_b16 v[16:17], v54 offset:3072
    ds_read_b64_tr_b16 v[18:19], v54 offset:3104
    s_waitcnt lgkmcnt(9)
    v_mfma_f32_16x16x32_bf16 v[12:15], v[20:23], v[36:39], v[12:15]
    ds_read_b128 v[36:39], v151 offset:49152
    ds_read_b64_tr_b16 v[20:21], v54 offset:3328
    ds_read_b64_tr_b16 v[22:23], v54 offset:3360
    s_waitcnt lgkmcnt(9)
    v_mfma_f32_16x16x32_bf16 v[12:15], v[24:27], v[40:43], v[12:15]
    ds_read_b128 v[40:43], v150 offset:57344
    ds_read_b64_tr_b16 v[24:25], v54 offset:3584
    ds_read_b64_tr_b16 v[26:27], v54 offset:3616
    s_waitcnt lgkmcnt(9)
    v_mfma_f32_16x16x32_bf16 v[12:15], v[28:31], v[44:47], v[12:15]
    ds_read_b128 v[44:47], v151 offset:57344
    ds_read_b64_tr_b16 v[28:29], v54 offset:3840
    ds_read_b64_tr_b16 v[30:31], v54 offset:3872
    s_waitcnt lgkmcnt(9)
    v_mfma_f32_16x16x32_bf16 v[12:15], v[16:19], v[32:35], v[12:15]
    v_add_u32 v150, 8192, v150
    v_add_u32 v151, 8192, v151
    ds_read_b128 v[32:35], v150 offset:57344
    ds_read_b64_tr_b16 v[16:17], v54 offset:4096
    ds_read_b64_tr_b16 v[18:19], v54 offset:4128
    s_waitcnt lgkmcnt(9)
    v_mfma_f32_16x16x32_bf16 v[12:15], v[20:23], v[36:39], v[12:15]
    ds_read_b128 v[36:39], v151 offset:57344
    ds_read_b64_tr_b16 v[20:21], v54 offset:4352
    ds_read_b64_tr_b16 v[22:23], v54 offset:4384
    s_waitcnt lgkmcnt(9)
    v_mfma_f32_16x16x32_bf16 v[12:15], v[24:27], v[40:43], v[12:15]
    s_waitcnt lgkmcnt(6)
    v_mfma_f32_16x16x32_bf16 v[12:15], v[28:31], v[44:47], v[12:15]
    s_waitcnt lgkmcnt(3)
    v_mfma_f32_16x16x32_bf16 v[12:15], v[16:19], v[32:35], v[12:15]
    s_waitcnt lgkmcnt(0)
    v_mfma_f32_16x16x32_bf16 v[12:15], v[20:23], v[36:39], v[12:15]
    v_subrev_u32 v150, 8192, v150
    v_subrev_u32 v151, 8192, v151
    s_nop 7
    v_cvt_pk_bf16_f32 v82, v12, v13
    v_mov_b32 v83, 0x3f80
    v_cmp_eq_u32 vcc, 0, v160
    s_nop 0
    s_and_saveexec_b64 s[76:77], vcc
    ds_write_b16 v55, v82 offset:256
    ds_write_b16_d16_hi v55, v82 offset:272
    ds_write_b16 v55, v83 offset:288
    s_mov_b64 exec, s[76:77]
L_ve_35:
    s_waitcnt lgkmcnt(0)
    s_barrier
    s_cmp_lg_u32 s33, 0
    s_cbranch_scc1 L_nopub_36
    v_lshlrev_b32 v72, 4, v156
    s_mul_i32 s36, s34, 4736
    s_add_u32 s36, s36, 2304
    v_add_u32 v73, 156672, v72
    ds_read_b128 v[16:19], v73 offset:0
    ds_read_b128 v[20:23], v73 offset:1024
    ds_read_b128 v[24:27], v73 offset:2048
    s_waitcnt lgkmcnt(0)
    buffer_store_dwordx4 v[16:19], v72, s[52:55], s36 offen sc1
    buffer_store_dwordx4 v[20:23], v72, s[52:55], s36 offen offset:1024 sc1
    v_cmp_gt_u32 vcc, 24, v156
    s_nop 0
    s_and_saveexec_b64 s[76:77], vcc
    buffer_store_dwordx4 v[24:27], v72, s[52:55], s36 offen offset:2048 sc1
    s_mov_b64 exec, s[76:77]
    v_mov_b32 v155, 0
    buffer_load_dword v154, v155, s[68:71], 0 offen sc1
    s_mov_b32 s87, 0
L_nopub_36:
    s_cmp_eq_u32 s40, 0
    s_cbranch_scc0 L_p1f1_37
    s_barrier
    ds_read_b128 v[12:15], v150 offset:0
    ds_read_b128 v[16:19], v151 offset:0
    ds_read_b128 v[20:23], v150 offset:8192
    ds_read_b64_tr_b16 v[24:25], v148 offset:0
    ds_read_b64_tr_b16 v[26:27], v148 offset:144
    ds_read_b64_tr_b16 v[28:29], v148 offset:32
    ds_read_b64_tr_b16 v[30:31], v148 offset:176
    ds_read_b64_tr_b16 v[32:33], v148 offset:64
    ds_read_b64_tr_b16 v[34:35], v148 offset:208
    ds_read_b64_tr_b16 v[36:37], v148 offset:4608
    ds_read_b64_tr_b16 v[38:39], v148 offset:4752
    ds_read_b64_tr_b16 v[40:41], v148 offset:4640
    ds_read_b64_tr_b16 v[42:43], v148 offset:4784
    ds_read_b64_tr_b16 v[44:45], v148 offset:4672
    ds_read_b64_tr_b16 v[46:47], v148 offset:4816
    ds_read_b64_tr_b16 v[48:49], v148 offset:9216
    ds_read_b64_tr_b16 v[50:51], v148 offset:9360
    ds_read_b64_tr_b16 v[52:53], v148 offset:9248
    ds_read_b64_tr_b16 v[54:55], v148 offset:9392
    ds_read_b64_tr_b16 v[56:57], v148 offset:9280
    ds_read_b64_tr_b16 v[58:59], v148 offset:9424
    s_waitcnt lgkmcnt(12)
    v_mfma_f32_16x16x32_bf16 v[0:3], v[24:27], v[12:15], 0
    v_mfma_f32_16x16x32_bf16 v[4:7], v[28:31], v[12:15], 0
    v_mfma_f32_16x16x32_bf16 v[8:11], v[32:35], v[12:15], 0
    ds_read_b128 v[12:15], v151 offset:8192
    ds_read_b64_tr_b16 v[60:61], v148 offset:13824
    ds_read_b64_tr_b16 v[62:63], v148 offset:13968
    ds_read_b64_tr_b16 v[64:65], v148 offset:13856
    ds_read_b64_tr_b16 v[66:67], v148 offset:14000
    ds_read_b64_tr_b16 v[68:69], v148 offset:13888
    ds_read_b64_tr_b16 v[70:71], v148 offset:14032
    s_waitcnt lgkmcnt(13)
    v_mfma_f32_16x16x32_bf16 v[0:3], v[36:39], v[16:19], v[0:3]
    v_mfma_f32_16x16x32_bf16 v[4:7], v[40:43], v[16:19], v[4:7]
    v_mfma_f32_16x16x32_bf16 v[8:11], v[44:47], v[16:19], v[8:11]
    ds_read_b128 v[16:19], v150 offset:16384
    ds_read_b64_tr_b16 v[24:25], v148 offset:18432
    ds_read_b64_tr_b16 v[26:27], v148 offset:18576
    ds_read_b64_tr_b16 v[28:29], v148 offset:18464
    ds_read_b64_tr_b16 v[30:31], v148 offset:18608
    ds_read_b64_tr_b16 v[32:33], v148 offset:18496
    ds_read_b64_tr_b16 v[34:35], v148 offset:18640
    s_waitcnt lgkmcnt(14)
    v_mfma_f32_16x16x32_bf16 v[0:3], v[48:51], v[20:23], v[0:3]
    v_mfma_f32_16x16x32_bf16 v[4:7], v[52:55], v[20:23], v[4:7]
    v_mfma_f32_16x16x32_bf16 v[8:11], v[56:59], v[20:23], v[8:11]
    ds_read_b128 v[20:23], v151 offset:16384
    ds_read_b64_tr_b16 v[36:37], v148 offset:23040
    ds_read_b64_tr_b16 v[38:39], v148 offset:23184
    ds_read_b64_tr_b16 v[40:41], v148 offset:23072
    ds_read_b64_tr_b16 v[42:43], v148 offset:23216
    ds_read_b64_tr_b16 v[44:45], v148 offset:23104
    ds_read_b64_tr_b16 v[46:47], v148 offset:23248
    s_waitcnt lgkmcnt(14)
    v_mfma_f32_16x16x32_bf16 v[0:3], v[60:63], v[12:15], v[0:3]
    v_mfma_f32_16x16x32_bf16 v[4:7], v[64:67], v[12:15], v[4:7]
    v_mfma_f32_16x16x32_bf16 v[8:11], v[68:71], v[12:15], v[8:11]
    ds_read_b128 v[12:15], v150 offset:24576
    ds_read_b64_tr_b16 v[48:49], v148 offset:27648
    ds_read_b64_tr_b16 v[50:51], v148 offset:27792
    ds_read_b64_tr_b16 v[52:53], v148 offset:27680
    ds_read_b64_tr_b16 v[54:55], v148 offset:27824
    ds_read_b64_tr_b16 v[56:57], v148 offset:27712
    ds_read_b64_tr_b16 v[58:59], v148 offset:27856
    s_waitcnt lgkmcnt(14)
    v_mfma_f32_16x16x32_bf16 v[0:3], v[24:27], v[16:19], v[0:3]
    v_mfma_f32_16x16x32_bf16 v[4:7], v[28:31], v[16:19], v[4:7]
    v_mfma_f32_16x16x32_bf16 v[8:11], v[32:35], v[16:19], v[8:11]
    s_cmp_lg_u32 s33, 0
    s_cbranch_scc1 L_noflag_39
    s_cmp_lg_u32 s87, 0
    s_cbranch_scc1 L_noflag_39
    s_getreg_b32 s36, hwreg(HW_REG_IB_STS, 0, 4)
    s_cmp_lg_u32 s36, 0
    s_cbranch_scc1 L_noflag_39
    s_waitcnt vmcnt(0)
    v_readfirstlane_b32 s81, v154
    s_nop 0
    s_cmp_ge_u32 s81, 32
    s_cbranch_scc1 L_initok_41
    v_mov_b32 v152, 0
    s_mov_b32 s80, 0
L_initp_40:
    buffer_load_dword v153, v152, s[68:71], 0 offen sc1
    s_waitcnt vmcnt(0)
    v_readfirstlane_b32 s81, v153
    s_nop 0
    s_cmp_ge_u32 s81, 32
    s_cbranch_scc1 L_initok_41
    s_sleep 4
    s_add_u32 s80, s80, 1
    s_cmp_lt_u32 s80, 0x40000
    s_cbranch_scc1 L_initp_40
L_initok_41:
    s_add_u32 s36, s34, 32
    s_lshr_b32 s37, s36, 4
    s_lshl_b32 s37, s37, 7
    s_and_b32 s36, s36, 15
    s_add_u32 s36, s36, s37
    s_add_u32 s36, s36, 197888
    v_lshlrev_b32 v152, 10, v156
    v_add_u32 v152, s36, v152
    v_mov_b32 v153, 1
    v_cmp_gt_u32 vcc, 32, v156
    s_nop 0
    s_and_saveexec_b64 s[76:77], vcc
    buffer_store_byte v153, v152, s[52:55], 0 offen sc1
    s_mov_b64 exec, s[76:77]
    s_mov_b32 s87, 1
L_noflag_39:
    ds_read_b128 v[16:19], v151 offset:24576
    ds_read_b64_tr_b16 v[60:61], v148 offset:32256
    ds_read_b64_tr_b16 v[62:63], v148 offset:32400
    ds_read_b64_tr_b16 v[64:65], v148 offset:32288
    ds_read_b64_tr_b16 v[66:67], v148 offset:32432
    ds_read_b64_tr_b16 v[68:69], v148 offset:32320
    ds_read_b64_tr_b16 v[70:71], v148 offset:32464
    s_waitcnt lgkmcnt(14)
    v_mfma_f32_16x16x32_bf16 v[0:3], v[36:39], v[20:23], v[0:3]
    v_mfma_f32_16x16x32_bf16 v[4:7], v[40:43], v[20:23], v[4:7]
    v_mfma_f32_16x16x32_bf16 v[8:11], v[44:47], v[20:23], v[8:11]
    ds_read_b128 v[20:23], v150 offset:32768
    ds_read_b64_tr_b16 v[24:25], v148 offset:36864
    ds_read_b64_tr_b16 v[26:27], v148 offset:37008
    ds_read_b64_tr_b16 v[28:29], v148 offset:36896
    ds_read_b64_tr_b16 v[30:31], v148 offset:37040
    ds_read_b64_tr_b16 v[32:33], v148 offset:36928
    ds_read_b64_tr_b16 v[34:35], v148 offset:37072
    s_waitcnt lgkmcnt(14)
    v_mfma_f32_16x16x32_bf16 v[0:3], v[48:51], v[12:15], v[0:3]
    v_mfma_f32_16x16x32_bf16 v[4:7], v[52:55], v[12:15], v[4:7]
    v_mfma_f32_16x16x32_bf16 v[8:11], v[56:59], v[12:15], v[8:11]
    ds_read_b128 v[12:15], v151 offset:32768
    ds_read_b64_tr_b16 v[36:37], v149 offset:0
    ds_read_b64_tr_b16 v[38:39], v149 offset:144
    ds_read_b64_tr_b16 v[40:41], v149 offset:32
    ds_read_b64_tr_b16 v[42:43], v149 offset:176
    ds_read_b64_tr_b16 v[44:45], v149 offset:64
    ds_read_b64_tr_b16 v[46:47], v149 offset:208
    s_waitcnt lgkmcnt(14)
    v_mfma_f32_16x16x32_bf16 v[0:3], v[60:63], v[16:19], v[0:3]
    v_mfma_f32_16x16x32_bf16 v[4:7], v[64:67], v[16:19], v[4:7]
    v_mfma_f32_16x16x32_bf16 v[8:11], v[68:71], v[16:19], v[8:11]
    ds_read_b128 v[16:19], v150 offset:40960
    ds_read_b64_tr_b16 v[48:49], v149 offset:4608
    ds_read_b64_tr_b16 v[50:51], v149 offset:4752
    ds_read_b64_tr_b16 v[52:53], v149 offset:4640
    ds_read_b64_tr_b16 v[54:55], v149 offset:4784
    ds_read_b64_tr_b16 v[56:57], v149 offset:4672
    ds_read_b64_tr_b16 v[58:59], v149 offset:4816
    s_waitcnt lgkmcnt(14)
    v_mfma_f32_16x16x32_bf16 v[0:3], v[24:27], v[20:23], v[0:3]
    v_mfma_f32_16x16x32_bf16 v[4:7], v[28:31], v[20:23], v[4:7]
    v_mfma_f32_16x16x32_bf16 v[8:11], v[32:35], v[20:23], v[8:11]
    s_cmp_lg_u32 s33, 0
    s_cbranch_scc1 L_noflag_42
    s_cmp_lg_u32 s87, 0
    s_cbranch_scc1 L_noflag_42
    s_getreg_b32 s36, hwreg(HW_REG_IB_STS, 0, 4)
    s_cmp_lg_u32 s36, 0
    s_cbranch_scc1 L_noflag_42
    s_waitcnt vmcnt(0)
    v_readfirstlane_b32 s81, v154
    s_nop 0
    s_cmp_ge_u32 s81, 32
    s_cbranch_scc1 L_initok_44
    v_mov_b32 v152, 0
    s_mov_b32 s80, 0
L_initp_43:
    buffer_load_dword v153, v152, s[68:71], 0 offen sc1
    s_waitcnt vmcnt(0)
    v_readfirstlane_b32 s81, v153
    s_nop 0
    s_cmp_ge_u32 s81, 32
    s_cbranch_scc1 L_initok_44
    s_sleep 4
    s_add_u32 s80, s80, 1
    s_cmp_lt_u32 s80, 0x40000
    s_cbranch_scc1 L_initp_43
L_initok_44:
    s_add_u32 s36, s34, 32
    s_lshr_b32 s37, s36, 4
    s_lshl_b32 s37, s37, 7
    s_and_b32 s36, s36, 15
    s_add_u32 s36, s36, s37
    s_add_u32 s36, s36, 197888
    v_lshlrev_b32 v152, 10, v156
    v_add_u32 v152, s36, v152
    v_mov_b32 v153, 1
    v_cmp_gt_u32 vcc, 32, v156
    s_nop 0
    s_and_saveexec_b64 s[76:77], vcc
    buffer_store_byte v153, v152, s[52:55], 0 offen sc1
    s_mov_b64 exec, s[76:77]
    s_mov_b32 s87, 1
L_noflag_42:
    ds_read_b128 v[20:23], v151 offset:40960
    ds_read_b64_tr_b16 v[60:61], v149 offset:9216
    ds_read_b64_tr_b16 v[62:63], v149 offset:9360
    ds_read_b64_tr_b16 v[64:65], v149 offset:9248
    ds_read_b64_tr_b16 v[66:67], v149 offset:9392
    ds_read_b64_tr_b16 v[68:69], v149 offset:9280
    ds_read_b64_tr_b16 v[70:71], v149 offset:9424
    s_waitcnt lgkmcnt(14)
    v_mfma_f32_16x16x32_bf16 v[0:3], v[36:39], v[12:15], v[0:3]
    v_mfma_f32_16x16x32_bf16 v[4:7], v[40:43], v[12:15], v[4:7]
    v_mfma_f32_16x16x32_bf16 v[8:11], v[44:47], v[12:15], v[8:11]
    ds_read_b128 v[12:15], v150 offset:49152
    s_waitcnt lgkmcnt(8)
    v_mfma_f32_16x16x32_bf16 v[0:3], v[48:51], v[16:19], v[0:3]
    v_mfma_f32_16x16x32_bf16 v[4:7], v[52:55], v[16:19], v[4:7]
    v_mfma_f32_16x16x32_bf16 v[8:11], v[56:59], v[16:19], v[8:11]
    ds_read_b128 v[16:19], v151 offset:49152
    s_waitcnt lgkmcnt(2)
    v_mfma_f32_16x16x32_bf16 v[0:3], v[60:63], v[20:23], v[0:3]
    v_mfma_f32_16x16x32_bf16 v[4:7], v[64:67], v[20:23], v[4:7]
    v_mfma_f32_16x16x32_bf16 v[8:11], v[68:71], v[20:23], v[8:11]
    s_cmp_lg_u32 s33, 0
    s_cbranch_scc1 L_noflag_45
    s_cmp_lg_u32 s87, 0
    s_cbranch_scc1 L_noflag_45
    s_getreg_b32 s36, hwreg(HW_REG_IB_STS, 0, 4)
    s_cmp_lg_u32 s36, 0
    s_cbranch_scc1 L_noflag_45
    s_waitcnt vmcnt(0)
    v_readfirstlane_b32 s81, v154
    s_nop 0
    s_cmp_ge_u32 s81, 32
    s_cbranch_scc1 L_initok_47
    v_mov_b32 v152, 0
    s_mov_b32 s80, 0
L_initp_46:
    buffer_load_dword v153, v152, s[68:71], 0 offen sc1
    s_waitcnt vmcnt(0)
    v_readfirstlane_b32 s81, v153
    s_nop 0
    s_cmp_ge_u32 s81, 32
    s_cbranch_scc1 L_initok_47
    s_sleep 4
    s_add_u32 s80, s80, 1
    s_cmp_lt_u32 s80, 0x40000
    s_cbranch_scc1 L_initp_46
L_initok_47:
    s_add_u32 s36, s34, 32
    s_lshr_b32 s37, s36, 4
    s_lshl_b32 s37, s37, 7
    s_and_b32 s36, s36, 15
    s_add_u32 s36, s36, s37
    s_add_u32 s36, s36, 197888
    v_lshlrev_b32 v152, 10, v156
    v_add_u32 v152, s36, v152
    v_mov_b32 v153, 1
    v_cmp_gt_u32 vcc, 32, v156
    s_nop 0
    s_and_saveexec_b64 s[76:77], vcc
    buffer_store_byte v153, v152, s[52:55], 0 offen sc1
    s_mov_b64 exec, s[76:77]
    s_mov_b32 s87, 1
L_noflag_45:
    s_barrier
    ds_read_b128 v[20:23], v150 offset:57344
    ds_read_b64_tr_b16 v[24:25], v149 offset:13824
    ds_read_b64_tr_b16 v[26:27], v149 offset:13968
    ds_read_b64_tr_b16 v[28:29], v149 offset:13856
    ds_read_b64_tr_b16 v[30:31], v149 offset:14000
    ds_read_b64_tr_b16 v[32:33], v149 offset:13888
    ds_read_b64_tr_b16 v[34:35], v149 offset:14032
    ds_read_b64_tr_b16 v[36:37], v149 offset:18432
    ds_read_b64_tr_b16 v[38:39], v149 offset:18576
    ds_read_b64_tr_b16 v[40:41], v149 offset:18464
    ds_read_b64_tr_b16 v[42:43], v149 offset:18608
    ds_read_b64_tr_b16 v[44:45], v149 offset:18496
    ds_read_b64_tr_b16 v[46:47], v149 offset:18640
    ds_read_b64_tr_b16 v[48:49], v149 offset:23040
    ds_read_b64_tr_b16 v[50:51], v149 offset:23184
    ds_read_b64_tr_b16 v[52:53], v149 offset:23072
    ds_read_b64_tr_b16 v[54:55], v149 offset:23216
    ds_read_b64_tr_b16 v[56:57], v149 offset:23104
    ds_read_b64_tr_b16 v[58:59], v149 offset:23248
    s_waitcnt lgkmcnt(12)
    v_mfma_f32_16x16x32_bf16 v[0:3], v[24:27], v[12:15], v[0:3]
    v_mfma_f32_16x16x32_bf16 v[4:7], v[28:31], v[12:15], v[4:7]
    v_mfma_f32_16x16x32_bf16 v[8:11], v[32:35], v[12:15], v[8:11]
    ds_read_b128 v[12:15], v151 offset:57344
    ds_read_b64_tr_b16 v[60:61], v149 offset:27648
    ds_read_b64_tr_b16 v[62:63], v149 offset:27792
    ds_read_b64_tr_b16 v[64:65], v149 offset:27680
    ds_read_b64_tr_b16 v[66:67], v149 offset:27824
    ds_read_b64_tr_b16 v[68:69], v149 offset:27712
    ds_read_b64_tr_b16 v[70:71], v149 offset:27856
    s_waitcnt lgkmcnt(13)
    v_mfma_f32_16x16x32_bf16 v[0:3], v[36:39], v[16:19], v[0:3]
    v_mfma_f32_16x16x32_bf16 v[4:7], v[40:43], v[16:19], v[4:7]
    v_mfma_f32_16x16x32_bf16 v[8:11], v[44:47], v[16:19], v[8:11]
    v_add_u32 v150, 8192, v150
    v_add_u32 v151, 8192, v151
    ds_read_b128 v[16:19], v150 offset:57344
    ds_read_b64_tr_b16 v[24:25], v149 offset:32256
    ds_read_b64_tr_b16 v[26:27], v149 offset:32400
    ds_read_b64_tr_b16 v[28:29], v149 offset:32288
    ds_read_b64_tr_b16 v[30:31], v149 offset:32432
    ds_read_b64_tr_b16 v[32:33], v149 offset:32320
    ds_read_b64_tr_b16 v[34:35], v149 offset:32464
    s_waitcnt lgkmcnt(14)
    v_mfma_f32_16x16x32_bf16 v[0:3], v[48:51], v[20:23], v[0:3]
    v_mfma_f32_16x16x32_bf16 v[4:7], v[52:55], v[20:23], v[4:7]
    v_mfma_f32_16x16x32_bf16 v[8:11], v[56:59], v[20:23], v[8:11]
    ds_read_b128 v[20:23], v151 offset:57344
    ds_read_b64_tr_b16 v[36:37], v149 offset:36864
    ds_read_b64_tr_b16 v[38:39], v149 offset:37008
    ds_read_b64_tr_b16 v[40:41], v149 offset:36896
    ds_read_b64_tr_b16 v[42:43], v149 offset:37040
    ds_read_b64_tr_b16 v[44:45], v149 offset:36928
    ds_read_b64_tr_b16 v[46:47], v149 offset:37072
    s_waitcnt lgkmcnt(14)
    v_mfma_f32_16x16x32_bf16 v[0:3], v[60:63], v[12:15], v[0:3]
    v_mfma_f32_16x16x32_bf16 v[4:7], v[64:67], v[12:15], v[4:7]
    v_mfma_f32_16x16x32_bf16 v[8:11], v[68:71], v[12:15], v[8:11]
    s_waitcnt lgkmcnt(7)
    v_mfma_f32_16x16x32_bf16 v[0:3], v[24:27], v[16:19], v[0:3]
    v_mfma_f32_16x16x32_bf16 v[4:7], v[28:31], v[16:19], v[4:7]
    v_mfma_f32_16x16x32_bf16 v[8:11], v[32:35], v[16:19], v[8:11]
    s_waitcnt lgkmcnt(0)
    v_mfma_f32_16x16x32_bf16 v[0:3], v[36:39], v[20:23], v[0:3]
    v_mfma_f32_16x16x32_bf16 v[4:7], v[40:43], v[20:23], v[4:7]
    v_mfma_f32_16x16x32_bf16 v[8:11], v[44:47], v[20:23], v[8:11]
    s_nop 7
    s_lshl_b32 s36, s39, 4
    v_add_u32 v80, s36, v159
    v_mul_u32_u24 v80, 144, v80
    v_lshl_add_u32 v80, v160, 3, v80
    s_mul_i32 s36, s40, 96
    s_add_u32 s36, s36, 73728
    v_add_u32 v80, s36, v80
    s_mov_b32 s36, 0x3eae1a93
    v_mul_f32 v72, s36, v0
    v_mul_f32 v73, s36, v1
    v_mul_f32 v74, s36, v2
    v_mul_f32 v75, s36, v3
    v_cvt_pk_bf16_f32 v16, v72, v73
    v_cvt_pk_bf16_f32 v17, v74, v75
    ds_write_b64 v80, v[16:17] offset:0
    v_mul_f32 v72, s36, v4
    v_mul_f32 v73, s36, v5
    v_mul_f32 v74, s36, v6
    v_mul_f32 v75, s36, v7
    v_cvt_pk_bf16_f32 v18, v72, v73
    v_cvt_pk_bf16_f32 v19, v74, v75
    ds_write_b64 v80, v[18:19] offset:32
    v_mul_f32 v72, s36, v8
    v_mul_f32 v73, s36, v9
    v_mul_f32 v74, s36, v10
    v_mul_f32 v75, s36, v11
    v_cvt_pk_bf16_f32 v20, v72, v73
    v_cvt_pk_bf16_f32 v21, v74, v75
    ds_write_b64 v80, v[20:21] offset:64
    s_cmp_lg_u32 s33, 0
    s_cbranch_scc1 L_noflag_48
    s_cmp_lg_u32 s87, 0
    s_cbranch_scc1 L_noflag_48
    s_waitcnt vmcnt(0)
    v_readfirstlane_b32 s81, v154
    s_nop 0
    s_cmp_ge_u32 s81, 32
    s_cbranch_scc1 L_initok_50
    v_mov_b32 v152, 0
    s_mov_b32 s80, 0
L_initp_49:
    buffer_load_dword v153, v152, s[68:71], 0 offen sc1
    s_waitcnt vmcnt(0)
    v_readfirstlane_b32 s81, v153
    s_nop 0
    s_cmp_ge_u32 s81, 32
    s_cbranch_scc1 L_initok_50
    s_sleep 4
    s_add_u32 s80, s80, 1
    s_cmp_lt_u32 s80, 0x40000
    s_cbranch_scc1 L_initp_49
L_initok_50:
    s_add_u32 s36, s34, 32
    s_lshr_b32 s37, s36, 4
    s_lshl_b32 s37, s37, 7
    s_and_b32 s36, s36, 15
    s_add_u32 s36, s36, s37
    s_add_u32 s36, s36, 197888
    v_lshlrev_b32 v152, 10, v156
    v_add_u32 v152, s36, v152
    v_mov_b32 v153, 1
    v_cmp_gt_u32 vcc, 32, v156
    s_nop 0
    s_and_saveexec_b64 s[76:77], vcc
    buffer_store_byte v153, v152, s[52:55], 0 offen sc1
    s_mov_b64 exec, s[76:77]
    s_mov_b32 s87, 1
L_noflag_48:
    s_branch L_p1e_38
L_p1f1_37:
    s_barrier
    ds_read_b128 v[12:15], v150 offset:0
    ds_read_b128 v[16:19], v151 offset:0
    ds_read_b128 v[20:23], v150 offset:8192
    ds_read_b64_tr_b16 v[24:25], v148 offset:0
    ds_read_b64_tr_b16 v[26:27], v148 offset:144
    ds_read_b64_tr_b16 v[28:29], v148 offset:32
    ds_read_b64_tr_b16 v[30:31], v148 offset:176
    ds_read_b64_tr_b16 v[32:33], v148 offset:4608
    ds_read_b64_tr_b16 v[34:35], v148 offset:4752
    ds_read_b64_tr_b16 v[36:37], v148 offset:4640
    ds_read_b64_tr_b16 v[38:39], v148 offset:4784
    ds_read_b64_tr_b16 v[40:41], v148 offset:9216
    ds_read_b64_tr_b16 v[42:43], v148 offset:9360
    ds_read_b64_tr_b16 v[44:45], v148 offset:9248
    ds_read_b64_tr_b16 v[46:47], v148 offset:9392
    s_waitcnt lgkmcnt(8)
    v_mfma_f32_16x16x32_bf16 v[0:3], v[24:27], v[12:15], 0
    v_mfma_f32_16x16x32_bf16 v[4:7], v[28:31], v[12:15], 0
    ds_read_b128 v[12:15], v151 offset:8192
    ds_read_b64_tr_b16 v[48:49], v148 offset:13824
    ds_read_b64_tr_b16 v[50:51], v148 offset:13968
    ds_read_b64_tr_b16 v[52:53], v148 offset:13856
    ds_read_b64_tr_b16 v[54:55], v148 offset:14000
    s_waitcnt lgkmcnt(9)
    v_mfma_f32_16x16x32_bf16 v[0:3], v[32:35], v[16:19], v[0:3]
    v_mfma_f32_16x16x32_bf16 v[4:7], v[36:39], v[16:19], v[4:7]
    ds_read_b128 v[16:19], v150 offset:16384
    ds_read_b64_tr_b16 v[24:25], v148 offset:18432
    ds_read_b64_tr_b16 v[26:27], v148 offset:18576
    ds_read_b64_tr_b16 v[28:29], v148 offset:18464
    ds_read_b64_tr_b16 v[30:31], v148 offset:18608
    s_waitcnt lgkmcnt(10)
    v_mfma_f32_16x16x32_bf16 v[0:3], v[40:43], v[20:23], v[0:3]
    v_mfma_f32_16x16x32_bf16 v[4:7], v[44:47], v[20:23], v[4:7]
    ds_read_b128 v[20:23], v151 offset:16384
    ds_read_b64_tr_b16 v[32:33], v148 offset:23040
    ds_read_b64_tr_b16 v[34:35], v148 offset:23184
    ds_read_b64_tr_b16 v[36:37], v148 offset:23072
    ds_read_b64_tr_b16 v[38:39], v148 offset:23216
    s_waitcnt lgkmcnt(10)
    v_mfma_f32_16x16x32_bf16 v[0:3], v[48:51], v[12:15], v[0:3]
    v_mfma_f32_16x16x32_bf16 v[4:7], v[52:55], v[12:15], v[4:7]
    ds_read_b128 v[12:15], v150 offset:24576
    ds_read_b64_tr_b16 v[40:41], v148 offset:27648
    ds_read_b64_tr_b16 v[42:43], v148 offset:27792
    ds_read_b64_tr_b16 v[44:45], v148 offset:27680
    ds_read_b64_tr_b16 v[46:47], v148 offset:27824
    s_waitcnt lgkmcnt(10)
    v_mfma_f32_16x16x32_bf16 v[0:3], v[24:27], v[16:19], v[0:3]
    v_mfma_f32_16x16x32_bf16 v[4:7], v[28:31], v[16:19], v[4:7]
    ds_read_b128 v[16:19], v151 offset:24576
    ds_read_b64_tr_b16 v[48:49], v148 offset:32256
    ds_read_b64_tr_b16 v[50:51], v148 offset:32400
    ds_read_b64_tr_b16 v[52:53], v148 offset:32288
    ds_read_b64_tr_b16 v[54:55], v148 offset:32432
    s_waitcnt lgkmcnt(10)
    v_mfma_f32_16x16x32_bf16 v[0:3], v[32:35], v[20:23], v[0:3]
    v_mfma_f32_16x16x32_bf16 v[4:7], v[36:39], v[20:23], v[4:7]
    ds_read_b128 v[20:23], v150 offset:32768
    ds_read_b64_tr_b16 v[24:25], v148 offset:36864
    ds_read_b64_tr_b16 v[26:27], v148 offset:37008
    ds_read_b64_tr_b16 v[28:29], v148 offset:36896
    ds_read_b64_tr_b16 v[30:31], v148 offset:37040
    s_waitcnt lgkmcnt(10)
    v_mfma_f32_16x16x32_bf16 v[0:3], v[40:43], v[12:15], v[0:3]
    v_mfma_f32_16x16x32_bf16 v[4:7], v[44:47], v[12:15], v[4:7]
    ds_read_b128 v[12:15], v151 offset:32768
    ds_read_b64_tr_b16 v[32:33], v149 offset:0
    ds_read_b64_tr_b16 v[34:35], v149 offset:144
    ds_read_b64_tr_b16 v[36:37], v149 offset:32
    ds_read_b64_tr_b16 v[38:39], v149 offset:176
    s_waitcnt lgkmcnt(10)
    v_mfma_f32_16x16x32_bf16 v[0:3], v[48:51], v[16:19], v[0:3]
    v_mfma_f32_16x16x32_bf16 v[4:7], v[52:55], v[16:19], v[4:7]
    ds_read_b128 v[16:19], v150 offset:40960
    ds_read_b64_tr_b16 v[40:41], v149 offset:4608
    ds_read_b64_tr_b16 v[42:43], v149 offset:4752
    ds_read_b64_tr_b16 v[44:45], v149 offset:4640
    ds_read_b64_tr_b16 v[46:47], v149 offset:4784
    s_waitcnt lgkmcnt(10)
    v_mfma_f32_16x16x32_bf16 v[0:3], v[24:27], v[20:23], v[0:3]
    v_mfma_f32_16x16x32_bf16 v[4:7], v[28:31], v[20:23], v[4:7]
    ds_read_b128 v[20:23], v151 offset:40960
    ds_read_b64_tr_b16 v[48:49], v149 offset:9216
    ds_read_b64_tr_b16 v[50:51], v149 offset:9360
    ds_read_b64_tr_b16 v[52:53], v149 offset:9248
    ds_read_b64_tr_b16 v[54:55], v149 offset:9392
    s_waitcnt lgkmcnt(10)
    v_mfma_f32_16x16x32_bf16 v[0:3], v[32:35], v[12:15], v[0:3]
    v_mfma_f32_16x16x32_bf16 v[4:7], v[36:39], v[12:15], v[4:7]
    ds_read_b128 v[12:15], v150 offset:49152
    s_waitcnt lgkmcnt(6)
    v_mfma_f32_16x16x32_bf16 v[0:3], v[40:43], v[16:19], v[0:3]
    v_mfma_f32_16x16x32_bf16 v[4:7], v[44:47], v[16:19], v[4:7]
    ds_read_b128 v[16:19], v151 offset:49152
    s_waitcnt lgkmcnt(2)
    v_mfma_f32_16x16x32_bf16 v[0:3], v[48:51], v[20:23], v[0:3]
    v_mfma_f32_16x16x32_bf16 v[4:7], v[52:55], v[20:23], v[4:7]
    s_barrier
    ds_read_b128 v[20:23], v150 offset:57344
    ds_read_b64_tr_b16 v[24:25], v149 offset:13824
    ds_read_b64_tr_b16 v[26:27], v149 offset:13968
    ds_read_b64_tr_b16 v[28:29], v149 offset:13856
    ds_read_b64_tr_b16 v[30:31], v149 offset:14000
    ds_read_b64_tr_b16 v[32:33], v149 offset:18432
    ds_read_b64_tr_b16 v[34:35], v149 offset:18576
    ds_read_b64_tr_b16 v[36:37], v149 offset:18464
    ds_read_b64_tr_b16 v[38:39], v149 offset:18608
    ds_read_b64_tr_b16 v[40:41], v149 offset:23040
    ds_read_b64_tr_b16 v[42:43], v149 offset:23184
    ds_read_b64_tr_b16 v[44:45], v149 offset:23072
    ds_read_b64_tr_b16 v[46:47], v149 offset:23216
    s_waitcnt lgkmcnt(8)
    v_mfma_f32_16x16x32_bf16 v[0:3], v[24:27], v[12:15], v[0:3]
    v_mfma_f32_16x16x32_bf16 v[4:7], v[28:31], v[12:15], v[4:7]
    ds_read_b128 v[12:15], v151 offset:57344
    ds_read_b64_tr_b16 v[48:49], v149 offset:27648
    ds_read_b64_tr_b16 v[50:51], v149 offset:27792
    ds_read_b64_tr_b16 v[52:53], v149 offset:27680
    ds_read_b64_tr_b16 v[54:55], v149 offset:27824
    s_waitcnt lgkmcnt(9)
    v_mfma_f32_16x16x32_bf16 v[0:3], v[32:35], v[16:19], v[0:3]
    v_mfma_f32_16x16x32_bf16 v[4:7], v[36:39], v[16:19], v[4:7]
    v_add_u32 v150, 8192, v150
    v_add_u32 v151, 8192, v151
    ds_read_b128 v[16:19], v150 offset:57344
    ds_read_b64_tr_b16 v[24:25], v149 offset:32256
    ds_read_b64_tr_b16 v[26:27], v149 offset:32400
    ds_read_b64_tr_b16 v[28:29], v149 offset:32288
    ds_read_b64_tr_b16 v[30:31], v149 offset:32432
    s_waitcnt lgkmcnt(10)
    v_mfma_f32_16x16x32_bf16 v[0:3], v[40:43], v[20:23], v[0:3]
    v_mfma_f32_16x16x32_bf16 v[4:7], v[44:47], v[20:23], v[4:7]
    ds_read_b128 v[20:23], v151 offset:57344
    ds_read_b64_tr_b16 v[32:33], v149 offset:36864
    ds_read_b64_tr_b16 v[34:35], v149 offset:37008
    ds_read_b64_tr_b16 v[36:37], v149 offset:36896
    ds_read_b64_tr_b16 v[38:39], v149 offset:37040
    s_waitcnt lgkmcnt(10)
    v_mfma_f32_16x16x32_bf16 v[0:3], v[48:51], v[12:15], v[0:3]
    v_mfma_f32_16x16x32_bf16 v[4:7], v[52:55], v[12:15], v[4:7]
    s_waitcnt lgkmcnt(5)
    v_mfma_f32_16x16x32_bf16 v[0:3], v[24:27], v[16:19], v[0:3]
    v_mfma_f32_16x16x32_bf16 v[4:7], v[28:31], v[16:19], v[4:7]
    s_waitcnt lgkmcnt(0)
    v_mfma_f32_16x16x32_bf16 v[0:3], v[32:35], v[20:23], v[0:3]
    v_mfma_f32_16x16x32_bf16 v[4:7], v[36:39], v[20:23], v[4:7]
    s_nop 7
    s_lshl_b32 s36, s39, 4
    v_add_u32 v80, s36, v159
    v_mul_u32_u24 v80, 144, v80
    v_lshl_add_u32 v80, v160, 3, v80
    s_mul_i32 s36, s40, 96
    s_add_u32 s36, s36, 73728
    v_add_u32 v80, s36, v80
    s_mov_b32 s36, 0x3eae1a93
    v_mul_f32 v72, s36, v0
    v_mul_f32 v73, s36, v1
    v_mul_f32 v74, s36, v2
    v_mul_f32 v75, s36, v3
    v_cvt_pk_bf16_f32 v16, v72, v73
    v_cvt_pk_bf16_f32 v17, v74, v75
    ds_write_b64 v80, v[16:17] offset:0
    v_mul_f32 v72, s36, v4
    v_mul_f32 v73, s36, v5
    v_mul_f32 v74, s36, v6
    v_mul_f32 v75, s36, v7
    v_cvt_pk_bf16_f32 v18, v72, v73
    v_cvt_pk_bf16_f32 v19, v74, v75
    v_cmp_gt_u32 vcc, 2, v160
    s_nop 0
    s_and_saveexec_b64 s[76:77], vcc
    ds_write_b64 v80, v[18:19] offset:32
    s_mov_b64 exec, s[76:77]
L_p1e_38:
    s_waitcnt lgkmcnt(0)
    s_barrier
    s_mul_i32 s36, s35, 144
    s_mul_i32 s37, s40, 96
    s_add_u32 s36, s36, s37
    s_lshl_b32 s37, s39, 4
    v_add_u32 v72, s37, v159
    v_lshlrev_b32 v72, 7, v72
    v_lshrrev_b32 v73, 1, v159
    v_lshlrev_b32 v74, 3, v160
    v_add_u32 v74, s36, v74
    v_lshrrev_b32 v75, 7, v74
    v_lshl_add_u32 v75, v75, 13, v72
    v_bfe_u32 v76, v74, 4, 3
    v_xor_b32 v76, v76, v73
    v_lshl_add_u32 v75, v76, 4, v75
    v_and_b32 v74, 8, v74
    v_add_u32 v75, v75, v74
    ds_read_b64 v[162:163], v75
    v_lshlrev_b32 v74, 3, v160
    v_add_u32 v74, s36, v74
    v_add_u32 v74, 32, v74
    v_lshrrev_b32 v75, 7, v74
    v_lshl_add_u32 v75, v75, 13, v72
    v_bfe_u32 v76, v74, 4, 3
    v_xor_b32 v76, v76, v73
    v_lshl_add_u32 v75, v76, 4, v75
    v_and_b32 v74, 8, v74
    v_add_u32 v75, v75, v74
    ds_read_b64 v[164:165], v75
    v_lshlrev_b32 v74, 3, v160
    v_add_u32 v74, s36, v74
    v_add_u32 v74, 64, v74
    v_lshrrev_b32 v75, 7, v74
    v_lshl_add_u32 v75, v75, 13, v72
    v_bfe_u32 v76, v74, 4, 3
    v_xor_b32 v76, v76, v73
    v_lshl_add_u32 v75, v76, 4, v75
    v_and_b32 v74, 8, v74
    v_add_u32 v75, v75, v74
    ds_read_b64 v[166:167], v75
    s_branch L_dj_7
L_dg_6:
    s_mov_b32 s56, s24
    s_and_b32 s57, s25, 0xffff
    s_mov_b32 s58, 1152
    s_mov_b32 s59, 0x20000
    s_mov_b32 s72, s16
    s_and_b32 s73, s17, 0xffff
    s_mov_b32 s74, 1152
    s_mov_b32 s75, 0x20000
    s_lshl_b32 s36, s33, 6
    s_add_u32 s36, s36, 0
    v_add_u32 v72, s36, v156
    v_lshlrev_b32 v72, 1, v72
    buffer_load_ushort v56, v72, s[56:59], 0 offen
    buffer_load_ushort v57, v72, s[72:75], 0 offen
    s_cmp_lg_u32 s33, 0
    s_cbranch_scc1 L_elskip_51
    s_lshl_b32 s36, s33, 6
    s_add_u32 s36, s36, 512
    v_add_u32 v72, s36, v156
    v_lshlrev_b32 v72, 1, v72
    buffer_load_ushort v60, v72, s[56:59], 0 offen
    buffer_load_ushort v61, v72, s[72:75], 0 offen
L_elskip_51:
    s_lshl_b32 s36, s39, 4
    v_add_u32 v72, s36, v159
    v_lshlrev_b32 v72, 7, v72
    v_lshrrev_b32 v73, 1, v159
    v_xor_b32 v73, v73, v160
    v_lshl_add_u32 v150, v73, 4, v72
    v_xor_b32 v151, 64, v150
    v_bfe_u32 v72, v156, 2, 2
    v_lshlrev_b32 v72, 1, v72
    v_lshl_add_u32 v72, v160, 3, v72
    v_mul_u32_u24 v72, 144, v72
    v_and_b32 v73, 3, v156
    v_lshl_add_u32 v72, v73, 3, v72
    s_mul_i32 s36, s40, 96
    s_add_u32 s36, s36, 73728
    v_add_u32 v148, s36, v72
    v_add_u32 v149, 41472, v148
    v_bfe_u32 v72, v156, 2, 2
    v_lshl_add_u32 v72, v160, 3, v72
    v_and_b32 v73, 1, v160
    v_lshl_add_u32 v74, v73, 2, v72
    v_xor_b32 v73, 1, v73
    v_lshl_add_u32 v75, v73, 2, v72
    v_and_b32 v73, 3, v156
    v_lshlrev_b32 v73, 3, v73
    v_lshl_add_u32 v52, v74, 5, v73
    v_lshl_add_u32 v53, v75, 5, v73
    v_add_u32 v52, 129024, v52
    v_add_u32 v53, 129024, v53
    v_lshlrev_b32 v54, 3, v72
    v_add_u32 v54, 147456, v54
    s_lshl_b32 s36, s33, 6
    s_add_u32 s36, s36, 0
    v_add_u32 v76, s36, v156
    v_lshlrev_b32 v76, 3, v76
    v_add_u32 v32, 147456, v76
    s_lshl_b32 s36, s33, 6
    s_add_u32 s36, s36, 512
    v_add_u32 v76, s36, v156
    v_lshlrev_b32 v76, 3, v76
    v_add_u32 v33, 147456, v76
    s_waitcnt vmcnt(0)
    v_lshl_or_b32 v56, v57, 16, v56
    ds_write_b32 v32, v56
    s_cmp_lg_u32 s33, 0
    s_cbranch_scc1 L_ewskip_52
    v_lshl_or_b32 v60, v61, 16, v60
    ds_write_b32 v33, v60
L_ewskip_52:
    s_waitcnt lgkmcnt(0)
    s_barrier
    s_cmp_eq_u32 s40, 0
    s_cbranch_scc1 L_ge_53
    ds_read_b128 v[32:35], v150 offset:0
    ds_read_b64_tr_b16 v[16:17], v54 offset:0
    ds_read_b64_tr_b16 v[18:19], v54 offset:32
    ds_read_b128 v[36:39], v151 offset:0
    ds_read_b64_tr_b16 v[20:21], v54 offset:256
    ds_read_b64_tr_b16 v[22:23], v54 offset:288
    ds_read_b128 v[40:43], v150 offset:8192
    ds_read_b64_tr_b16 v[24:25], v54 offset:512
    ds_read_b64_tr_b16 v[26:27], v54 offset:544
    ds_read_b128 v[44:47], v151 offset:8192
    ds_read_b64_tr_b16 v[28:29], v54 offset:768
    ds_read_b64_tr_b16 v[30:31], v54 offset:800
    s_waitcnt lgkmcnt(9)
    v_mfma_f32_16x16x32_bf16 v[12:15], v[16:19], v[32:35], 0
    ds_read_b128 v[32:35], v150 offset:16384
    ds_read_b64_tr_b16 v[16:17], v54 offset:1024
    ds_read_b64_tr_b16 v[18:19], v54 offset:1056
    s_waitcnt lgkmcnt(9)
    v_mfma_f32_16x16x32_bf16 v[12:15], v[20:23], v[36:39], v[12:15]
    ds_read_b128 v[36:39], v151 offset:16384
    ds_read_b64_tr_b16 v[20:21], v54 offset:1280
    ds_read_b64_tr_b16 v[22:23], v54 offset:1312
    s_waitcnt lgkmcnt(9)
    v_mfma_f32_16x16x32_bf16 v[12:15], v[24:27], v[40:43], v[12:15]
    ds_read_b128 v[40:43], v150 offset:24576
    ds_read_b64_tr_b16 v[24:25], v54 offset:1536
    ds_read_b64_tr_b16 v[26:27], v54 offset:1568
    s_waitcnt lgkmcnt(9)
    v_mfma_f32_16x16x32_bf16 v[12:15], v[28:31], v[44:47], v[12:15]
    ds_read_b128 v[44:47], v151 offset:24576
    ds_read_b64_tr_b16 v[28:29], v54 offset:1792
    ds_read_b64_tr_b16 v[30:31], v54 offset:1824
    s_waitcnt lgkmcnt(9)
    v_mfma_f32_16x16x32_bf16 v[12:15], v[16:19], v[32:35], v[12:15]
    ds_read_b128 v[32:35], v150 offset:32768
    ds_read_b64_tr_b16 v[16:17], v54 offset:2048
    ds_read_b64_tr_b16 v[18:19], v54 offset:2080
    s_waitcnt lgkmcnt(9)
    v_mfma_f32_16x16x32_bf16 v[12:15], v[20:23], v[36:39], v[12:15]
    ds_read_b128 v[36:39], v151 offset:32768
    ds_read_b64_tr_b16 v[20:21], v54 offset:2304
    ds_read_b64_tr_b16 v[22:23], v54 offset:2336
    s_waitcnt lgkmcnt(9)
    v_mfma_f32_16x16x32_bf16 v[12:15], v[24:27], v[40:43], v[12:15]
    ds_read_b128 v[40:43], v150 offset:40960
    ds_read_b64_tr_b16 v[24:25], v54 offset:2560
    ds_read_b64_tr_b16 v[26:27], v54 offset:2592
    s_waitcnt lgkmcnt(9)
    v_mfma_f32_16x16x32_bf16 v[12:15], v[28:31], v[44:47], v[12:15]
    ds_read_b128 v[44:47], v151 offset:40960
    ds_read_b64_tr_b16 v[28:29], v54 offset:2816
    ds_read_b64_tr_b16 v[30:31], v54 offset:2848
    s_waitcnt lgkmcnt(9)
    v_mfma_f32_16x16x32_bf16 v[12:15], v[16:19], v[32:35], v[12:15]
    ds_read_b128 v[32:35], v150 offset:49152
    ds_read_b64_tr_b16 v[16:17], v54 offset:3072
    ds_read_b64_tr_b16 v[18:19], v54 offset:3104
    s_waitcnt lgkmcnt(9)
    v_mfma_f32_16x16x32_bf16 v[12:15], v[20:23], v[36:39], v[12:15]
    ds_read_b128 v[36:39], v151 offset:49152
    ds_read_b64_tr_b16 v[20:21], v54 offset:3328
    ds_read_b64_tr_b16 v[22:23], v54 offset:3360
    s_waitcnt lgkmcnt(9)
    v_mfma_f32_16x16x32_bf16 v[12:15], v[24:27], v[40:43], v[12:15]
    ds_read_b128 v[40:43], v150 offset:57344
    ds_read_b64_tr_b16 v[24:25], v54 offset:3584
    ds_read_b64_tr_b16 v[26:27], v54 offset:3616
    s_waitcnt lgkmcnt(9)
    v_mfma_f32_16x16x32_bf16 v[12:15], v[28:31], v[44:47], v[12:15]
    ds_read_b128 v[44:47], v151 offset:57344
    ds_read_b64_tr_b16 v[28:29], v54 offset:3840
    ds_read_b64_tr_b16 v[30:31], v54 offset:3872
    s_waitcnt lgkmcnt(9)
    v_mfma_f32_16x16x32_bf16 v[12:15], v[16:19], v[32:35], v[12:15]
    v_add_u32 v150, 8192, v150
    v_add_u32 v151, 8192, v151
    ds_read_b128 v[32:35], v150 offset:57344
    ds_read_b64_tr_b16 v[16:17], v54 offset:4096
    ds_read_b64_tr_b16 v[18:19], v54 offset:4128
    s_waitcnt lgkmcnt(9)
    v_mfma_f32_16x16x32_bf16 v[12:15], v[20:23], v[36:39], v[12:15]
    ds_read_b128 v[36:39], v151 offset:57344
    ds_read_b64_tr_b16 v[20:21], v54 offset:4352
    ds_read_b64_tr_b16 v[22:23], v54 offset:4384
    s_waitcnt lgkmcnt(9)
    v_mfma_f32_16x16x32_bf16 v[12:15], v[24:27], v[40:43], v[12:15]
    s_waitcnt lgkmcnt(6)
    v_mfma_f32_16x16x32_bf16 v[12:15], v[28:31], v[44:47], v[12:15]
    s_waitcnt lgkmcnt(3)
    v_mfma_f32_16x16x32_bf16 v[12:15], v[16:19], v[32:35], v[12:15]
    s_waitcnt lgkmcnt(0)
    v_mfma_f32_16x16x32_bf16 v[12:15], v[20:23], v[36:39], v[12:15]
    v_subrev_u32 v150, 8192, v150
    v_subrev_u32 v151, 8192, v151
    s_nop 7
    v_cvt_pk_bf16_f32 v72, v12, v12
    v_and_b32 v72, 0xffff0000, v72
    v_mul_f32 v72, 0xbfb8aa3b, v72
    v_exp_f32 v72, v72
    s_nop 0
    v_add_f32 v72, 1.0, v72
    v_rcp_f32 v72, v72
    s_nop 0
    v_cvt_pk_bf16_f32 v72, v72, v72
    v_and_b32 v72, 0xffff0000, v72
    s_lshl_b32 s36, s39, 4
    v_add_u32 v73, s36, v159
    v_lshlrev_b32 v74, 2, v73
    v_add_u32 v74, 156672, v74
    v_cvt_pk_bf16_f32 v75, v13, v13
    v_and_b32 v75, 0xffff, v75
    v_xor_b32 v76, 0x8000, v75
    v_xor_b32 v77, 0xffff, v75
    v_cmp_lt_u32 vcc, 0x7fff, v75
    s_nop 1
    v_cndmask_b32 v75, v76, v77, vcc
    v_add_u32 v76, s41, v73
    v_sub_u32 v76, 0xffff, v76
    v_lshl_or_b32 v75, v75, 16, v76
    v_mov_b32 v76, v75
    s_nop 1
    v_max_u32_dpp v76, v76, v76 row_ror:1 row_mask:0xf bank_mask:0xf
    s_nop 1
    v_max_u32_dpp v76, v76, v76 row_ror:2 row_mask:0xf bank_mask:0xf
    s_nop 1
    v_max_u32_dpp v76, v76, v76 row_ror:4 row_mask:0xf bank_mask:0xf
    s_nop 1
    v_max_u32_dpp v76, v76, v76 row_ror:8 row_mask:0xf bank_mask:0xf
    v_cmp_eq_u32 vcc, v75, v76
    v_mov_b32 v77, 0
    s_nop 0
    v_cndmask_b32 v75, v75, v77, vcc
    s_nop 1
    v_max_u32_dpp v75, v75, v75 row_ror:1 row_mask:0xf bank_mask:0xf
    s_nop 1
    v_max_u32_dpp v75, v75, v75 row_ror:2 row_mask:0xf bank_mask:0xf
    s_nop 1
    v_max_u32_dpp v75, v75, v75 row_ror:4 row_mask:0xf bank_mask:0xf
    s_nop 1
    v_max_u32_dpp v75, v75, v75 row_ror:8 row_mask:0xf bank_mask:0xf
    s_lshl_b32 s36, s39, 3
    s_add_u32 s36, s36, 156928
    v_mov_b32 v77, s36
    v_cmp_eq_u32 vcc, 0, v160
    s_nop 0
    s_and_saveexec_b64 s[76:77], vcc
    ds_write_b32 v74, v72
    v_cmp_eq_u32 vcc, 0, v156
    s_nop 0
    s_and_b64 exec, exec, vcc
    ds_write2_b32 v77, v76, v75 offset0:0 offset1:1
    s_mov_b64 exec, s[76:77]
L_ge_53:
    s_waitcnt lgkmcnt(0)
    s_barrier
    s_cmp_lg_u32 s33, 0
    s_cbranch_scc1 L_nopub_54
    v_lshlrev_b32 v72, 4, v156
    v_lshlrev_b32 v73, 2, v156
    v_add_u32 v74, 156672, v73
    ds_read_b32 v16, v74
    ds_read_b32 v17, v74 offset:256
    v_mov_b32 v20, 0
    v_mov_b32 v21, 0
    v_mov_b32 v22, 0
    v_mov_b32 v23, 0
    s_waitcnt lgkmcnt(0)
    s_lshl_b32 s36, s41, 2
    s_add_u32 s36, s36, 151808
    buffer_store_dword v16, v73, s[52:55], s36 offen sc1
    s_mul_i32 s36, s34, 1152
    s_add_u32 s36, s36, 161024
    buffer_store_dwordx4 v[20:23], v72, s[52:55], s36 offen sc1
    v_cmp_gt_u32 vcc, 8, v156
    s_nop 0
    s_and_saveexec_b64 s[76:77], vcc
    buffer_store_dwordx4 v[20:23], v72, s[52:55], s36 offen offset:1024 sc1
    s_lshl_b32 s36, s34, 5
    s_add_u32 s36, s36, 160000
    buffer_store_dword v17, v73, s[52:55], s36 offen sc1
    s_mov_b64 exec, s[76:77]
    v_mov_b32 v155, 0
    buffer_load_dword v154, v155, s[68:71], 0 offen sc1
    s_mov_b32 s87, 0
L_nopub_54:
    s_cmp_eq_u32 s40, 0
    s_cbranch_scc0 L_p1f1_55
    s_barrier
    ds_read_b128 v[12:15], v150 offset:0
    ds_read_b128 v[16:19], v151 offset:0
    ds_read_b128 v[20:23], v150 offset:8192
    ds_read_b64_tr_b16 v[24:25], v148 offset:0
    ds_read_b64_tr_b16 v[26:27], v148 offset:144
    ds_read_b64_tr_b16 v[28:29], v148 offset:32
    ds_read_b64_tr_b16 v[30:31], v148 offset:176
    ds_read_b64_tr_b16 v[32:33], v148 offset:64
    ds_read_b64_tr_b16 v[34:35], v148 offset:208
    ds_read_b64_tr_b16 v[36:37], v148 offset:4608
    ds_read_b64_tr_b16 v[38:39], v148 offset:4752
    ds_read_b64_tr_b16 v[40:41], v148 offset:4640
    ds_read_b64_tr_b16 v[42:43], v148 offset:4784
    ds_read_b64_tr_b16 v[44:45], v148 offset:4672
    ds_read_b64_tr_b16 v[46:47], v148 offset:4816
    ds_read_b64_tr_b16 v[48:49], v148 offset:9216
    ds_read_b64_tr_b16 v[50:51], v148 offset:9360
    ds_read_b64_tr_b16 v[52:53], v148 offset:9248
    ds_read_b64_tr_b16 v[54:55], v148 offset:9392
    ds_read_b64_tr_b16 v[56:57], v148 offset:9280
    ds_read_b64_tr_b16 v[58:59], v148 offset:9424
    s_waitcnt lgkmcnt(12)
    v_mfma_f32_16x16x32_bf16 v[0:3], v[24:27], v[12:15], 0
    v_mfma_f32_16x16x32_bf16 v[4:7], v[28:31], v[12:15], 0
    v_mfma_f32_16x16x32_bf16 v[8:11], v[32:35], v[12:15], 0
    ds_read_b128 v[12:15], v151 offset:8192
    ds_read_b64_tr_b16 v[60:61], v148 offset:13824
    ds_read_b64_tr_b16 v[62:63], v148 offset:13968
    ds_read_b64_tr_b16 v[64:65], v148 offset:13856
    ds_read_b64_tr_b16 v[66:67], v148 offset:14000
    ds_read_b64_tr_b16 v[68:69], v148 offset:13888
    ds_read_b64_tr_b16 v[70:71], v148 offset:14032
    s_waitcnt lgkmcnt(13)
    v_mfma_f32_16x16x32_bf16 v[0:3], v[36:39], v[16:19], v[0:3]
    v_mfma_f32_16x16x32_bf16 v[4:7], v[40:43], v[16:19], v[4:7]
    v_mfma_f32_16x16x32_bf16 v[8:11], v[44:47], v[16:19], v[8:11]
    ds_read_b128 v[16:19], v150 offset:16384
    ds_read_b64_tr_b16 v[24:25], v148 offset:18432
    ds_read_b64_tr_b16 v[26:27], v148 offset:18576
    ds_read_b64_tr_b16 v[28:29], v148 offset:18464
    ds_read_b64_tr_b16 v[30:31], v148 offset:18608
    ds_read_b64_tr_b16 v[32:33], v148 offset:18496
    ds_read_b64_tr_b16 v[34:35], v148 offset:18640
    s_waitcnt lgkmcnt(14)
    v_mfma_f32_16x16x32_bf16 v[0:3], v[48:51], v[20:23], v[0:3]
    v_mfma_f32_16x16x32_bf16 v[4:7], v[52:55], v[20:23], v[4:7]
    v_mfma_f32_16x16x32_bf16 v[8:11], v[56:59], v[20:23], v[8:11]
    ds_read_b128 v[20:23], v151 offset:16384
    ds_read_b64_tr_b16 v[36:37], v148 offset:23040
    ds_read_b64_tr_b16 v[38:39], v148 offset:23184
    ds_read_b64_tr_b16 v[40:41], v148 offset:23072
    ds_read_b64_tr_b16 v[42:43], v148 offset:23216
    ds_read_b64_tr_b16 v[44:45], v148 offset:23104
    ds_read_b64_tr_b16 v[46:47], v148 offset:23248
    s_waitcnt lgkmcnt(14)
    v_mfma_f32_16x16x32_bf16 v[0:3], v[60:63], v[12:15], v[0:3]
    v_mfma_f32_16x16x32_bf16 v[4:7], v[64:67], v[12:15], v[4:7]
    v_mfma_f32_16x16x32_bf16 v[8:11], v[68:71], v[12:15], v[8:11]
    ds_read_b128 v[12:15], v150 offset:24576
    ds_read_b64_tr_b16 v[48:49], v148 offset:27648
    ds_read_b64_tr_b16 v[50:51], v148 offset:27792
    ds_read_b64_tr_b16 v[52:53], v148 offset:27680
    ds_read_b64_tr_b16 v[54:55], v148 offset:27824
    ds_read_b64_tr_b16 v[56:57], v148 offset:27712
    ds_read_b64_tr_b16 v[58:59], v148 offset:27856
    s_waitcnt lgkmcnt(14)
    v_mfma_f32_16x16x32_bf16 v[0:3], v[24:27], v[16:19], v[0:3]
    v_mfma_f32_16x16x32_bf16 v[4:7], v[28:31], v[16:19], v[4:7]
    v_mfma_f32_16x16x32_bf16 v[8:11], v[32:35], v[16:19], v[8:11]
    s_cmp_lg_u32 s33, 0
    s_cbranch_scc1 L_noflag_57
    s_cmp_lg_u32 s87, 0
    s_cbranch_scc1 L_noflag_57
    s_getreg_b32 s36, hwreg(HW_REG_IB_STS, 0, 4)
    s_cmp_lg_u32 s36, 0
    s_cbranch_scc1 L_noflag_57
    s_waitcnt vmcnt(0)
    v_readfirstlane_b32 s81, v154
    s_nop 0
    s_cmp_ge_u32 s81, 32
    s_cbranch_scc1 L_initok_59
    v_mov_b32 v152, 0
    s_mov_b32 s80, 0
L_initp_58:
    buffer_load_dword v153, v152, s[68:71], 0 offen sc1
    s_waitcnt vmcnt(0)
    v_readfirstlane_b32 s81, v153
    s_nop 0
    s_cmp_ge_u32 s81, 32
    s_cbranch_scc1 L_initok_59
    s_sleep 4
    s_add_u32 s80, s80, 1
    s_cmp_lt_u32 s80, 0x40000
    s_cbranch_scc1 L_initp_58
L_initok_59:
    s_add_u32 s36, s34, 64
    s_lshr_b32 s37, s36, 4
    s_lshl_b32 s37, s37, 7
    s_and_b32 s36, s36, 15
    s_add_u32 s36, s36, s37
    s_add_u32 s36, s36, 197888
    v_lshlrev_b32 v152, 10, v156
    v_add_u32 v152, s36, v152
    v_mov_b32 v153, 1
    v_cmp_gt_u32 vcc, 32, v156
    s_nop 0
    s_and_saveexec_b64 s[76:77], vcc
    buffer_store_byte v153, v152, s[52:55], 0 offen sc1
    s_mov_b64 exec, s[76:77]
    s_mov_b32 s87, 1
L_noflag_57:
    ds_read_b128 v[16:19], v151 offset:24576
    ds_read_b64_tr_b16 v[60:61], v148 offset:32256
    ds_read_b64_tr_b16 v[62:63], v148 offset:32400
    ds_read_b64_tr_b16 v[64:65], v148 offset:32288
    ds_read_b64_tr_b16 v[66:67], v148 offset:32432
    ds_read_b64_tr_b16 v[68:69], v148 offset:32320
    ds_read_b64_tr_b16 v[70:71], v148 offset:32464
    s_waitcnt lgkmcnt(14)
    v_mfma_f32_16x16x32_bf16 v[0:3], v[36:39], v[20:23], v[0:3]
    v_mfma_f32_16x16x32_bf16 v[4:7], v[40:43], v[20:23], v[4:7]
    v_mfma_f32_16x16x32_bf16 v[8:11], v[44:47], v[20:23], v[8:11]
    ds_read_b128 v[20:23], v150 offset:32768
    ds_read_b64_tr_b16 v[24:25], v148 offset:36864
    ds_read_b64_tr_b16 v[26:27], v148 offset:37008
    ds_read_b64_tr_b16 v[28:29], v148 offset:36896
    ds_read_b64_tr_b16 v[30:31], v148 offset:37040
    ds_read_b64_tr_b16 v[32:33], v148 offset:36928
    ds_read_b64_tr_b16 v[34:35], v148 offset:37072
    s_waitcnt lgkmcnt(14)
    v_mfma_f32_16x16x32_bf16 v[0:3], v[48:51], v[12:15], v[0:3]
    v_mfma_f32_16x16x32_bf16 v[4:7], v[52:55], v[12:15], v[4:7]
    v_mfma_f32_16x16x32_bf16 v[8:11], v[56:59], v[12:15], v[8:11]
    ds_read_b128 v[12:15], v151 offset:32768
    ds_read_b64_tr_b16 v[36:37], v149 offset:0
    ds_read_b64_tr_b16 v[38:39], v149 offset:144
    ds_read_b64_tr_b16 v[40:41], v149 offset:32
    ds_read_b64_tr_b16 v[42:43], v149 offset:176
    ds_read_b64_tr_b16 v[44:45], v149 offset:64
    ds_read_b64_tr_b16 v[46:47], v149 offset:208
    s_waitcnt lgkmcnt(14)
    v_mfma_f32_16x16x32_bf16 v[0:3], v[60:63], v[16:19], v[0:3]
    v_mfma_f32_16x16x32_bf16 v[4:7], v[64:67], v[16:19], v[4:7]
    v_mfma_f32_16x16x32_bf16 v[8:11], v[68:71], v[16:19], v[8:11]
    ds_read_b128 v[16:19], v150 offset:40960
    ds_read_b64_tr_b16 v[48:49], v149 offset:4608
    ds_read_b64_tr_b16 v[50:51], v149 offset:4752
    ds_read_b64_tr_b16 v[52:53], v149 offset:4640
    ds_read_b64_tr_b16 v[54:55], v149 offset:4784
    ds_read_b64_tr_b16 v[56:57], v149 offset:4672
    ds_read_b64_tr_b16 v[58:59], v149 offset:4816
    s_waitcnt lgkmcnt(14)
    v_mfma_f32_16x16x32_bf16 v[0:3], v[24:27], v[20:23], v[0:3]
    v_mfma_f32_16x16x32_bf16 v[4:7], v[28:31], v[20:23], v[4:7]
    v_mfma_f32_16x16x32_bf16 v[8:11], v[32:35], v[20:23], v[8:11]
    s_cmp_lg_u32 s33, 0
    s_cbranch_scc1 L_noflag_60
    s_cmp_lg_u32 s87, 0
    s_cbranch_scc1 L_noflag_60
    s_getreg_b32 s36, hwreg(HW_REG_IB_STS, 0, 4)
    s_cmp_lg_u32 s36, 0
    s_cbranch_scc1 L_noflag_60
    s_waitcnt vmcnt(0)
    v_readfirstlane_b32 s81, v154
    s_nop 0
    s_cmp_ge_u32 s81, 32
    s_cbranch_scc1 L_initok_62
    v_mov_b32 v152, 0
    s_mov_b32 s80, 0
L_initp_61:
    buffer_load_dword v153, v152, s[68:71], 0 offen sc1
    s_waitcnt vmcnt(0)
    v_readfirstlane_b32 s81, v153
    s_nop 0
    s_cmp_ge_u32 s81, 32
    s_cbranch_scc1 L_initok_62
    s_sleep 4
    s_add_u32 s80, s80, 1
    s_cmp_lt_u32 s80, 0x40000
    s_cbranch_scc1 L_initp_61
L_initok_62:
    s_add_u32 s36, s34, 64
    s_lshr_b32 s37, s36, 4
    s_lshl_b32 s37, s37, 7
    s_and_b32 s36, s36, 15
    s_add_u32 s36, s36, s37
    s_add_u32 s36, s36, 197888
    v_lshlrev_b32 v152, 10, v156
    v_add_u32 v152, s36, v152
    v_mov_b32 v153, 1
    v_cmp_gt_u32 vcc, 32, v156
    s_nop 0
    s_and_saveexec_b64 s[76:77], vcc
    buffer_store_byte v153, v152, s[52:55], 0 offen sc1
    s_mov_b64 exec, s[76:77]
    s_mov_b32 s87, 1
L_noflag_60:
    ds_read_b128 v[20:23], v151 offset:40960
    ds_read_b64_tr_b16 v[60:61], v149 offset:9216
    ds_read_b64_tr_b16 v[62:63], v149 offset:9360
    ds_read_b64_tr_b16 v[64:65], v149 offset:9248
    ds_read_b64_tr_b16 v[66:67], v149 offset:9392
    ds_read_b64_tr_b16 v[68:69], v149 offset:9280
    ds_read_b64_tr_b16 v[70:71], v149 offset:9424
    s_waitcnt lgkmcnt(14)
    v_mfma_f32_16x16x32_bf16 v[0:3], v[36:39], v[12:15], v[0:3]
    v_mfma_f32_16x16x32_bf16 v[4:7], v[40:43], v[12:15], v[4:7]
    v_mfma_f32_16x16x32_bf16 v[8:11], v[44:47], v[12:15], v[8:11]
    ds_read_b128 v[12:15], v150 offset:49152
    s_waitcnt lgkmcnt(8)
    v_mfma_f32_16x16x32_bf16 v[0:3], v[48:51], v[16:19], v[0:3]
    v_mfma_f32_16x16x32_bf16 v[4:7], v[52:55], v[16:19], v[4:7]
    v_mfma_f32_16x16x32_bf16 v[8:11], v[56:59], v[16:19], v[8:11]
    ds_read_b128 v[16:19], v151 offset:49152
    s_waitcnt lgkmcnt(2)
    v_mfma_f32_16x16x32_bf16 v[0:3], v[60:63], v[20:23], v[0:3]
    v_mfma_f32_16x16x32_bf16 v[4:7], v[64:67], v[20:23], v[4:7]
    v_mfma_f32_16x16x32_bf16 v[8:11], v[68:71], v[20:23], v[8:11]
    s_cmp_lg_u32 s33, 0
    s_cbranch_scc1 L_noflag_63
    s_cmp_lg_u32 s87, 0
    s_cbranch_scc1 L_noflag_63
    s_getreg_b32 s36, hwreg(HW_REG_IB_STS, 0, 4)
    s_cmp_lg_u32 s36, 0
    s_cbranch_scc1 L_noflag_63
    s_waitcnt vmcnt(0)
    v_readfirstlane_b32 s81, v154
    s_nop 0
    s_cmp_ge_u32 s81, 32
    s_cbranch_scc1 L_initok_65
    v_mov_b32 v152, 0
    s_mov_b32 s80, 0
L_initp_64:
    buffer_load_dword v153, v152, s[68:71], 0 offen sc1
    s_waitcnt vmcnt(0)
    v_readfirstlane_b32 s81, v153
    s_nop 0
    s_cmp_ge_u32 s81, 32
    s_cbranch_scc1 L_initok_65
    s_sleep 4
    s_add_u32 s80, s80, 1
    s_cmp_lt_u32 s80, 0x40000
    s_cbranch_scc1 L_initp_64
L_initok_65:
    s_add_u32 s36, s34, 64
    s_lshr_b32 s37, s36, 4
    s_lshl_b32 s37, s37, 7
    s_and_b32 s36, s36, 15
    s_add_u32 s36, s36, s37
    s_add_u32 s36, s36, 197888
    v_lshlrev_b32 v152, 10, v156
    v_add_u32 v152, s36, v152
    v_mov_b32 v153, 1
    v_cmp_gt_u32 vcc, 32, v156
    s_nop 0
    s_and_saveexec_b64 s[76:77], vcc
    buffer_store_byte v153, v152, s[52:55], 0 offen sc1
    s_mov_b64 exec, s[76:77]
    s_mov_b32 s87, 1
L_noflag_63:
    s_barrier
    ds_read_b128 v[20:23], v150 offset:57344
    ds_read_b64_tr_b16 v[24:25], v149 offset:13824
    ds_read_b64_tr_b16 v[26:27], v149 offset:13968
    ds_read_b64_tr_b16 v[28:29], v149 offset:13856
    ds_read_b64_tr_b16 v[30:31], v149 offset:14000
    ds_read_b64_tr_b16 v[32:33], v149 offset:13888
    ds_read_b64_tr_b16 v[34:35], v149 offset:14032
    ds_read_b64_tr_b16 v[36:37], v149 offset:18432
    ds_read_b64_tr_b16 v[38:39], v149 offset:18576
    ds_read_b64_tr_b16 v[40:41], v149 offset:18464
    ds_read_b64_tr_b16 v[42:43], v149 offset:18608
    ds_read_b64_tr_b16 v[44:45], v149 offset:18496
    ds_read_b64_tr_b16 v[46:47], v149 offset:18640
    ds_read_b64_tr_b16 v[48:49], v149 offset:23040
    ds_read_b64_tr_b16 v[50:51], v149 offset:23184
    ds_read_b64_tr_b16 v[52:53], v149 offset:23072
    ds_read_b64_tr_b16 v[54:55], v149 offset:23216
    ds_read_b64_tr_b16 v[56:57], v149 offset:23104
    ds_read_b64_tr_b16 v[58:59], v149 offset:23248
    s_waitcnt lgkmcnt(12)
    v_mfma_f32_16x16x32_bf16 v[0:3], v[24:27], v[12:15], v[0:3]
    v_mfma_f32_16x16x32_bf16 v[4:7], v[28:31], v[12:15], v[4:7]
    v_mfma_f32_16x16x32_bf16 v[8:11], v[32:35], v[12:15], v[8:11]
    ds_read_b128 v[12:15], v151 offset:57344
    ds_read_b64_tr_b16 v[60:61], v149 offset:27648
    ds_read_b64_tr_b16 v[62:63], v149 offset:27792
    ds_read_b64_tr_b16 v[64:65], v149 offset:27680
    ds_read_b64_tr_b16 v[66:67], v149 offset:27824
    ds_read_b64_tr_b16 v[68:69], v149 offset:27712
    ds_read_b64_tr_b16 v[70:71], v149 offset:27856
    s_waitcnt lgkmcnt(13)
    v_mfma_f32_16x16x32_bf16 v[0:3], v[36:39], v[16:19], v[0:3]
    v_mfma_f32_16x16x32_bf16 v[4:7], v[40:43], v[16:19], v[4:7]
    v_mfma_f32_16x16x32_bf16 v[8:11], v[44:47], v[16:19], v[8:11]
    v_add_u32 v150, 8192, v150
    v_add_u32 v151, 8192, v151
    ds_read_b128 v[16:19], v150 offset:57344
    ds_read_b64_tr_b16 v[24:25], v149 offset:32256
    ds_read_b64_tr_b16 v[26:27], v149 offset:32400
    ds_read_b64_tr_b16 v[28:29], v149 offset:32288
    ds_read_b64_tr_b16 v[30:31], v149 offset:32432
    ds_read_b64_tr_b16 v[32:33], v149 offset:32320
    ds_read_b64_tr_b16 v[34:35], v149 offset:32464
    s_waitcnt lgkmcnt(14)
    v_mfma_f32_16x16x32_bf16 v[0:3], v[48:51], v[20:23], v[0:3]
    v_mfma_f32_16x16x32_bf16 v[4:7], v[52:55], v[20:23], v[4:7]
    v_mfma_f32_16x16x32_bf16 v[8:11], v[56:59], v[20:23], v[8:11]
    ds_read_b128 v[20:23], v151 offset:57344
    ds_read_b64_tr_b16 v[36:37], v149 offset:36864
    ds_read_b64_tr_b16 v[38:39], v149 offset:37008
    ds_read_b64_tr_b16 v[40:41], v149 offset:36896
    ds_read_b64_tr_b16 v[42:43], v149 offset:37040
    ds_read_b64_tr_b16 v[44:45], v149 offset:36928
    ds_read_b64_tr_b16 v[46:47], v149 offset:37072
    s_waitcnt lgkmcnt(14)
    v_mfma_f32_16x16x32_bf16 v[0:3], v[60:63], v[12:15], v[0:3]
    v_mfma_f32_16x16x32_bf16 v[4:7], v[64:67], v[12:15], v[4:7]
    v_mfma_f32_16x16x32_bf16 v[8:11], v[68:71], v[12:15], v[8:11]
    s_waitcnt lgkmcnt(7)
    v_mfma_f32_16x16x32_bf16 v[0:3], v[24:27], v[16:19], v[0:3]
    v_mfma_f32_16x16x32_bf16 v[4:7], v[28:31], v[16:19], v[4:7]
    v_mfma_f32_16x16x32_bf16 v[8:11], v[32:35], v[16:19], v[8:11]
    s_waitcnt lgkmcnt(0)
    v_mfma_f32_16x16x32_bf16 v[0:3], v[36:39], v[20:23], v[0:3]
    v_mfma_f32_16x16x32_bf16 v[4:7], v[40:43], v[20:23], v[4:7]
    v_mfma_f32_16x16x32_bf16 v[8:11], v[44:47], v[20:23], v[8:11]
    s_nop 7
    s_lshl_b32 s36, s39, 4
    v_add_u32 v80, s36, v159
    v_mul_u32_u24 v80, 144, v80
    v_lshl_add_u32 v80, v160, 3, v80
    s_mul_i32 s36, s40, 96
    s_add_u32 s36, s36, 73728
    v_add_u32 v80, s36, v80
    s_mov_b32 s36, 0x3eae1a93
    v_mul_f32 v72, s36, v0
    v_mul_f32 v73, s36, v1
    v_mul_f32 v74, s36, v2
    v_mul_f32 v75, s36, v3
    v_cvt_pk_bf16_f32 v16, v72, v73
    v_cvt_pk_bf16_f32 v17, v74, v75
    ds_write_b64 v80, v[16:17] offset:0
    v_mul_f32 v72, s36, v4
    v_mul_f32 v73, s36, v5
    v_mul_f32 v74, s36, v6
    v_mul_f32 v75, s36, v7
    v_cvt_pk_bf16_f32 v18, v72, v73
    v_cvt_pk_bf16_f32 v19, v74, v75
    ds_write_b64 v80, v[18:19] offset:32
    v_mul_f32 v72, s36, v8
    v_mul_f32 v73, s36, v9
    v_mul_f32 v74, s36, v10
    v_mul_f32 v75, s36, v11
    v_cvt_pk_bf16_f32 v20, v72, v73
    v_cvt_pk_bf16_f32 v21, v74, v75
    ds_write_b64 v80, v[20:21] offset:64
    s_cmp_lg_u32 s33, 0
    s_cbranch_scc1 L_noflag_66
    s_cmp_lg_u32 s87, 0
    s_cbranch_scc1 L_noflag_66
    s_waitcnt vmcnt(0)
    v_readfirstlane_b32 s81, v154
    s_nop 0
    s_cmp_ge_u32 s81, 32
    s_cbranch_scc1 L_initok_68
    v_mov_b32 v152, 0
    s_mov_b32 s80, 0
L_initp_67:
    buffer_load_dword v153, v152, s[68:71], 0 offen sc1
    s_waitcnt vmcnt(0)
    v_readfirstlane_b32 s81, v153
    s_nop 0
    s_cmp_ge_u32 s81, 32
    s_cbranch_scc1 L_initok_68
    s_sleep 4
    s_add_u32 s80, s80, 1
    s_cmp_lt_u32 s80, 0x40000
    s_cbranch_scc1 L_initp_67
L_initok_68:
    s_add_u32 s36, s34, 64
    s_lshr_b32 s37, s36, 4
    s_lshl_b32 s37, s37, 7
    s_and_b32 s36, s36, 15
    s_add_u32 s36, s36, s37
    s_add_u32 s36, s36, 197888
    v_lshlrev_b32 v152, 10, v156
    v_add_u32 v152, s36, v152
    v_mov_b32 v153, 1
    v_cmp_gt_u32 vcc, 32, v156
    s_nop 0
    s_and_saveexec_b64 s[76:77], vcc
    buffer_store_byte v153, v152, s[52:55], 0 offen sc1
    s_mov_b64 exec, s[76:77]
    s_mov_b32 s87, 1
L_noflag_66:
    s_branch L_p1e_56
L_p1f1_55:
    s_barrier
    ds_read_b128 v[12:15], v150 offset:0
    ds_read_b128 v[16:19], v151 offset:0
    ds_read_b128 v[20:23], v150 offset:8192
    ds_read_b64_tr_b16 v[24:25], v148 offset:0
    ds_read_b64_tr_b16 v[26:27], v148 offset:144
    ds_read_b64_tr_b16 v[28:29], v148 offset:32
    ds_read_b64_tr_b16 v[30:31], v148 offset:176
    ds_read_b64_tr_b16 v[32:33], v148 offset:4608
    ds_read_b64_tr_b16 v[34:35], v148 offset:4752
    ds_read_b64_tr_b16 v[36:37], v148 offset:4640
    ds_read_b64_tr_b16 v[38:39], v148 offset:4784
    ds_read_b64_tr_b16 v[40:41], v148 offset:9216
    ds_read_b64_tr_b16 v[42:43], v148 offset:9360
    ds_read_b64_tr_b16 v[44:45], v148 offset:9248
    ds_read_b64_tr_b16 v[46:47], v148 offset:9392
    s_waitcnt lgkmcnt(8)
    v_mfma_f32_16x16x32_bf16 v[0:3], v[24:27], v[12:15], 0
    v_mfma_f32_16x16x32_bf16 v[4:7], v[28:31], v[12:15], 0
    ds_read_b128 v[12:15], v151 offset:8192
    ds_read_b64_tr_b16 v[48:49], v148 offset:13824
    ds_read_b64_tr_b16 v[50:51], v148 offset:13968
    ds_read_b64_tr_b16 v[52:53], v148 offset:13856
    ds_read_b64_tr_b16 v[54:55], v148 offset:14000
    s_waitcnt lgkmcnt(9)
    v_mfma_f32_16x16x32_bf16 v[0:3], v[32:35], v[16:19], v[0:3]
    v_mfma_f32_16x16x32_bf16 v[4:7], v[36:39], v[16:19], v[4:7]
    ds_read_b128 v[16:19], v150 offset:16384
    ds_read_b64_tr_b16 v[24:25], v148 offset:18432
    ds_read_b64_tr_b16 v[26:27], v148 offset:18576
    ds_read_b64_tr_b16 v[28:29], v148 offset:18464
    ds_read_b64_tr_b16 v[30:31], v148 offset:18608
    s_waitcnt lgkmcnt(10)
    v_mfma_f32_16x16x32_bf16 v[0:3], v[40:43], v[20:23], v[0:3]
    v_mfma_f32_16x16x32_bf16 v[4:7], v[44:47], v[20:23], v[4:7]
    ds_read_b128 v[20:23], v151 offset:16384
    ds_read_b64_tr_b16 v[32:33], v148 offset:23040
    ds_read_b64_tr_b16 v[34:35], v148 offset:23184
    ds_read_b64_tr_b16 v[36:37], v148 offset:23072
    ds_read_b64_tr_b16 v[38:39], v148 offset:23216
    s_waitcnt lgkmcnt(10)
    v_mfma_f32_16x16x32_bf16 v[0:3], v[48:51], v[12:15], v[0:3]
    v_mfma_f32_16x16x32_bf16 v[4:7], v[52:55], v[12:15], v[4:7]
    ds_read_b128 v[12:15], v150 offset:24576
    ds_read_b64_tr_b16 v[40:41], v148 offset:27648
    ds_read_b64_tr_b16 v[42:43], v148 offset:27792
    ds_read_b64_tr_b16 v[44:45], v148 offset:27680
    ds_read_b64_tr_b16 v[46:47], v148 offset:27824
    s_waitcnt lgkmcnt(10)
    v_mfma_f32_16x16x32_bf16 v[0:3], v[24:27], v[16:19], v[0:3]
    v_mfma_f32_16x16x32_bf16 v[4:7], v[28:31], v[16:19], v[4:7]
    ds_read_b128 v[16:19], v151 offset:24576
    ds_read_b64_tr_b16 v[48:49], v148 offset:32256
    ds_read_b64_tr_b16 v[50:51], v148 offset:32400
    ds_read_b64_tr_b16 v[52:53], v148 offset:32288
    ds_read_b64_tr_b16 v[54:55], v148 offset:32432
    s_waitcnt lgkmcnt(10)
    v_mfma_f32_16x16x32_bf16 v[0:3], v[32:35], v[20:23], v[0:3]
    v_mfma_f32_16x16x32_bf16 v[4:7], v[36:39], v[20:23], v[4:7]
    ds_read_b128 v[20:23], v150 offset:32768
    ds_read_b64_tr_b16 v[24:25], v148 offset:36864
    ds_read_b64_tr_b16 v[26:27], v148 offset:37008
    ds_read_b64_tr_b16 v[28:29], v148 offset:36896
    ds_read_b64_tr_b16 v[30:31], v148 offset:37040
    s_waitcnt lgkmcnt(10)
    v_mfma_f32_16x16x32_bf16 v[0:3], v[40:43], v[12:15], v[0:3]
    v_mfma_f32_16x16x32_bf16 v[4:7], v[44:47], v[12:15], v[4:7]
    ds_read_b128 v[12:15], v151 offset:32768
    ds_read_b64_tr_b16 v[32:33], v149 offset:0
    ds_read_b64_tr_b16 v[34:35], v149 offset:144
    ds_read_b64_tr_b16 v[36:37], v149 offset:32
    ds_read_b64_tr_b16 v[38:39], v149 offset:176
    s_waitcnt lgkmcnt(10)
    v_mfma_f32_16x16x32_bf16 v[0:3], v[48:51], v[16:19], v[0:3]
    v_mfma_f32_16x16x32_bf16 v[4:7], v[52:55], v[16:19], v[4:7]
    ds_read_b128 v[16:19], v150 offset:40960
    ds_read_b64_tr_b16 v[40:41], v149 offset:4608
    ds_read_b64_tr_b16 v[42:43], v149 offset:4752
    ds_read_b64_tr_b16 v[44:45], v149 offset:4640
    ds_read_b64_tr_b16 v[46:47], v149 offset:4784
    s_waitcnt lgkmcnt(10)
    v_mfma_f32_16x16x32_bf16 v[0:3], v[24:27], v[20:23], v[0:3]
    v_mfma_f32_16x16x32_bf16 v[4:7], v[28:31], v[20:23], v[4:7]
    ds_read_b128 v[20:23], v151 offset:40960
    ds_read_b64_tr_b16 v[48:49], v149 offset:9216
    ds_read_b64_tr_b16 v[50:51], v149 offset:9360
    ds_read_b64_tr_b16 v[52:53], v149 offset:9248
    ds_read_b64_tr_b16 v[54:55], v149 offset:9392
    s_waitcnt lgkmcnt(10)
    v_mfma_f32_16x16x32_bf16 v[0:3], v[32:35], v[12:15], v[0:3]
    v_mfma_f32_16x16x32_bf16 v[4:7], v[36:39], v[12:15], v[4:7]
    ds_read_b128 v[12:15], v150 offset:49152
    s_waitcnt lgkmcnt(6)
    v_mfma_f32_16x16x32_bf16 v[0:3], v[40:43], v[16:19], v[0:3]
    v_mfma_f32_16x16x32_bf16 v[4:7], v[44:47], v[16:19], v[4:7]
    ds_read_b128 v[16:19], v151 offset:49152
    s_waitcnt lgkmcnt(2)
    v_mfma_f32_16x16x32_bf16 v[0:3], v[48:51], v[20:23], v[0:3]
    v_mfma_f32_16x16x32_bf16 v[4:7], v[52:55], v[20:23], v[4:7]
    s_barrier
    ds_read_b128 v[20:23], v150 offset:57344
    ds_read_b64_tr_b16 v[24:25], v149 offset:13824
    ds_read_b64_tr_b16 v[26:27], v149 offset:13968
    ds_read_b64_tr_b16 v[28:29], v149 offset:13856
    ds_read_b64_tr_b16 v[30:31], v149 offset:14000
    ds_read_b64_tr_b16 v[32:33], v149 offset:18432
    ds_read_b64_tr_b16 v[34:35], v149 offset:18576
    ds_read_b64_tr_b16 v[36:37], v149 offset:18464
    ds_read_b64_tr_b16 v[38:39], v149 offset:18608
    ds_read_b64_tr_b16 v[40:41], v149 offset:23040
    ds_read_b64_tr_b16 v[42:43], v149 offset:23184
    ds_read_b64_tr_b16 v[44:45], v149 offset:23072
    ds_read_b64_tr_b16 v[46:47], v149 offset:23216
    s_waitcnt lgkmcnt(8)
    v_mfma_f32_16x16x32_bf16 v[0:3], v[24:27], v[12:15], v[0:3]
    v_mfma_f32_16x16x32_bf16 v[4:7], v[28:31], v[12:15], v[4:7]
    ds_read_b128 v[12:15], v151 offset:57344
    ds_read_b64_tr_b16 v[48:49], v149 offset:27648
    ds_read_b64_tr_b16 v[50:51], v149 offset:27792
    ds_read_b64_tr_b16 v[52:53], v149 offset:27680
    ds_read_b64_tr_b16 v[54:55], v149 offset:27824
    s_waitcnt lgkmcnt(9)
    v_mfma_f32_16x16x32_bf16 v[0:3], v[32:35], v[16:19], v[0:3]
    v_mfma_f32_16x16x32_bf16 v[4:7], v[36:39], v[16:19], v[4:7]
    v_add_u32 v150, 8192, v150
    v_add_u32 v151, 8192, v151
    ds_read_b128 v[16:19], v150 offset:57344
    ds_read_b64_tr_b16 v[24:25], v149 offset:32256
    ds_read_b64_tr_b16 v[26:27], v149 offset:32400
    ds_read_b64_tr_b16 v[28:29], v149 offset:32288
    ds_read_b64_tr_b16 v[30:31], v149 offset:32432
    s_waitcnt lgkmcnt(10)
    v_mfma_f32_16x16x32_bf16 v[0:3], v[40:43], v[20:23], v[0:3]
    v_mfma_f32_16x16x32_bf16 v[4:7], v[44:47], v[20:23], v[4:7]
    ds_read_b128 v[20:23], v151 offset:57344
    ds_read_b64_tr_b16 v[32:33], v149 offset:36864
    ds_read_b64_tr_b16 v[34:35], v149 offset:37008
    ds_read_b64_tr_b16 v[36:37], v149 offset:36896
    ds_read_b64_tr_b16 v[38:39], v149 offset:37040
    s_waitcnt lgkmcnt(10)
    v_mfma_f32_16x16x32_bf16 v[0:3], v[48:51], v[12:15], v[0:3]
    v_mfma_f32_16x16x32_bf16 v[4:7], v[52:55], v[12:15], v[4:7]
    s_waitcnt lgkmcnt(5)
    v_mfma_f32_16x16x32_bf16 v[0:3], v[24:27], v[16:19], v[0:3]
    v_mfma_f32_16x16x32_bf16 v[4:7], v[28:31], v[16:19], v[4:7]
    s_waitcnt lgkmcnt(0)
    v_mfma_f32_16x16x32_bf16 v[0:3], v[32:35], v[20:23], v[0:3]
    v_mfma_f32_16x16x32_bf16 v[4:7], v[36:39], v[20:23], v[4:7]
    s_nop 7
    s_lshl_b32 s36, s39, 4
    v_add_u32 v80, s36, v159
    v_mul_u32_u24 v80, 144, v80
    v_lshl_add_u32 v80, v160, 3, v80
    s_mul_i32 s36, s40, 96
    s_add_u32 s36, s36, 73728
    v_add_u32 v80, s36, v80
    s_mov_b32 s36, 0x3eae1a93
    v_mul_f32 v72, s36, v0
    v_mul_f32 v73, s36, v1
    v_mul_f32 v74, s36, v2
    v_mul_f32 v75, s36, v3
    v_cvt_pk_bf16_f32 v16, v72, v73
    v_cvt_pk_bf16_f32 v17, v74, v75
    ds_write_b64 v80, v[16:17] offset:0
    v_mul_f32 v72, s36, v4
    v_mul_f32 v73, s36, v5
    v_mul_f32 v74, s36, v6
    v_mul_f32 v75, s36, v7
    v_cvt_pk_bf16_f32 v18, v72, v73
    v_cvt_pk_bf16_f32 v19, v74, v75
    v_cmp_gt_u32 vcc, 2, v160
    s_nop 0
    s_and_saveexec_b64 s[76:77], vcc
    ds_write_b64 v80, v[18:19] offset:32
    s_mov_b64 exec, s[76:77]
L_p1e_56:
    s_waitcnt lgkmcnt(0)
    s_barrier
    s_mul_i32 s36, s35, 144
    s_mul_i32 s37, s40, 96
    s_add_u32 s36, s36, s37
    s_lshl_b32 s37, s39, 4
    v_add_u32 v72, s37, v159
    v_lshlrev_b32 v72, 7, v72
    v_lshrrev_b32 v73, 1, v159
    v_lshlrev_b32 v74, 3, v160
    v_add_u32 v74, s36, v74
    v_lshrrev_b32 v75, 7, v74
    v_lshl_add_u32 v75, v75, 13, v72
    v_bfe_u32 v76, v74, 4, 3
    v_xor_b32 v76, v76, v73
    v_lshl_add_u32 v75, v76, 4, v75
    v_and_b32 v74, 8, v74
    v_add_u32 v75, v75, v74
    ds_read_b64 v[162:163], v75
    v_lshlrev_b32 v74, 3, v160
    v_add_u32 v74, s36, v74
    v_add_u32 v74, 32, v74
    v_lshrrev_b32 v75, 7, v74
    v_lshl_add_u32 v75, v75, 13, v72
    v_bfe_u32 v76, v74, 4, 3
    v_xor_b32 v76, v76, v73
    v_lshl_add_u32 v75, v76, 4, v75
    v_and_b32 v74, 8, v74
    v_add_u32 v75, v75, v74
    ds_read_b64 v[164:165], v75
    v_lshlrev_b32 v74, 3, v160
    v_add_u32 v74, s36, v74
    v_add_u32 v74, 64, v74
    v_lshrrev_b32 v75, 7, v74
    v_lshl_add_u32 v75, v75, 13, v72
    v_bfe_u32 v76, v74, 4, 3
    v_xor_b32 v76, v76, v73
    v_lshl_add_u32 v75, v76, 4, v75
    v_and_b32 v74, 8, v74
    v_add_u32 v75, v75, v74
    ds_read_b64 v[166:167], v75
L_dj_7:
    s_mul_i32 s36, s39, 36
    s_add_u32 s36, s36, 73728
    v_mul_u32_u24 v110, 144, v157
    v_add_u32 v110, s36, v110
    v_lshl_add_u32 v111, v158, 4, v110
    v_add_u32 v112, 4608, v111
    v_add_u32 v110, 32, v110
    v_mov_b32 v113, 196608
    v_cmp_eq_u32 vcc, 0, v158
    s_nop 1
    v_cndmask_b32 v110, v113, v110, vcc
    ds_read2_b32 v[72:73], v111 offset0:0 offset1:1
    ds_read2_b32 v[74:75], v111 offset0:2 offset1:3
    ds_read_b32 v76, v110 offset:0
    ds_read2_b32 v[80:81], v112 offset0:0 offset1:1
    ds_read2_b32 v[82:83], v112 offset0:2 offset1:3
    ds_read_b32 v84, v110 offset:4608
    s_waitcnt lgkmcnt(0)
    v_mov_b32 v77, 0
    v_mov_b32 v78, 0
    v_mov_b32 v79, v76
    v_mov_b32 v85, 0
    v_mov_b32 v86, 0
    v_mov_b32 v87, v84
    s_mul_i32 s36, s40, 18944
    v_lshlrev_b32 v104, 4, v156
    v_add_u32 v104, s36, v104
    s_add_u32 s37, s36, 2048
    v_lshlrev_b32 v105, 3, v157
    v_add_u32 v105, s37, v105
    v_mul_u32_u24 v112, 19, v158
    v_add_u32 v111, v157, v112
    s_add_u32 s37, s36, 2304
    v_lshlrev_b32 v106, 4, v111
    v_add_u32 v106, s37, v106
    v_mov_b32 v112, 3
    v_mov_b32 v113, 4
    v_cmp_lt_u32 vcc, 19, v157
    s_nop 1
    v_cndmask_b32 v112, v112, v113, vcc
    v_mov_b32 v113, 3
    v_cmp_lt_u32 vcc, 27, v157
    s_nop 1
    v_cndmask_b32 v112, v112, v113, vcc
    v_mul_u32_u24 v113, 19, v158
    v_add_u32 v112, v112, v113
    v_lshlrev_b32 v112, 4, v112
    v_add_u32 v112, 196608, v112
    v_cmp_lt_u32 vcc, 18, v157
    s_nop 1
    v_cndmask_b32 v106, v106, v112, vcc
    v_mov_b32 v112, 196608
    v_cmp_eq_u32 vcc, 1, v158
    s_nop 1
    v_cndmask_b32 v105, v105, v112, vcc
    s_waitcnt lgkmcnt(0)
    s_barrier
    v_dot2_f32_bf16 v118, v72, v72, 0
    v_dot2_f32_bf16 v118, v73, v73, v118
    v_dot2_f32_bf16 v118, v74, v74, v118
    v_dot2_f32_bf16 v118, v75, v75, v118
    v_dot2_f32_bf16 v118, v76, v76, v118
    v_dot2_f32_bf16 v119, v80, v80, 0
    v_dot2_f32_bf16 v119, v81, v81, v119
    v_dot2_f32_bf16 v119, v82, v82, v119
    v_dot2_f32_bf16 v119, v83, v83, v119
    v_dot2_f32_bf16 v119, v84, v84, v119
    s_nop 2
    v_mov_b32 v120, v118
    s_nop 1
    v_permlane32_swap_b32 v118, v120
    v_add_f32 v118, v118, v120
    v_mov_b32 v120, v119
    s_nop 1
    v_permlane32_swap_b32 v119, v120
    v_add_f32 v119, v119, v120
    v_max_f32 v118, v118, v119
    s_nop 1
    v_max_f32_dpp v118, v118, v118 row_ror:1 row_mask:0xf bank_mask:0xf
    s_nop 1
    v_max_f32_dpp v118, v118, v118 row_ror:2 row_mask:0xf bank_mask:0xf
    s_nop 1
    v_max_f32_dpp v118, v118, v118 row_ror:4 row_mask:0xf bank_mask:0xf
    s_nop 1
    v_max_f32_dpp v118, v118, v118 row_ror:8 row_mask:0xf bank_mask:0xf
    s_nop 0
    v_readlane_b32 s78, v118, 0
    v_readlane_b32 s36, v118, 16
    s_nop 0
    s_max_u32 s78, s78, s36
    s_lshl_b32 s36, s39, 4
    s_add_u32 s36, s36, s41
    v_add_u32 v161, s36, v159
    v_lshlrev_b32 v161, 2, v161
    v_add_u32 v161, 151808, v161
    v_lshlrev_b32 v110, 4, v156
    v_add_u32 v110, 82944, v110
    s_lshl_b32 s36, s33, 12
    v_add_u32 v144, s36, v110
    s_xor_b32 s36, s33, 4
    s_lshl_b32 s36, s36, 12
    v_add_u32 v145, s36, v110
    s_lshl_b32 s36, s40, 5
    v_add_u32 v110, s36, v157
    v_mul_u32_u24 v110, 144, v110
    s_mul_i32 s36, s39, 36
    s_add_u32 s36, s36, 115712
    v_add_u32 v110, s36, v110
    v_lshl_add_u32 v146, v158, 4, v110
    s_lshl_b32 s36, s33, 6
    v_add_u32 v110, s36, v156
    v_lshlrev_b32 v152, 4, v110
    v_add_u32 v152, 115712, v152
    v_mul_u32_u24 v111, 7282, v110
    v_lshrrev_b32 v111, 16, v111
    v_mul_u32_u24 v112, 9, v111
    v_sub_u32 v112, v110, v112
    v_mul_u32_u24 v111, 1152, v111
    v_lshl_add_u32 v153, v112, 4, v111
    s_mul_i32 s42, s41, 1152
    s_mul_i32 s36, s35, 144
    s_add_u32 s42, s42, s36
    s_add_u32 s43, s42, 233472
    s_barrier
    ds_read_b128 v[88:91], v104 offset:0
    ds_read_b64 v[92:93], v105 offset:0
    ds_read_b128 v[96:99], v106 offset:0
    s_waitcnt lgkmcnt(1)
    v_mfma_f32_32x32x16_bf16 v[0:15], v[88:91], v[72:75], 0
    v_mfma_f32_32x32x8bf16_1k v[0:15], v[92:93], v[76:77], v[0:15]
    s_nop 7
    s_nop 3
    v_mfma_f32_32x32x16_bf16 v[16:31], v[88:91], v[80:83], 0
    ds_read_b128 v[88:91], v104 offset:1024
    v_exp_f32 v0, v0
    v_exp_f32 v1, v1
    v_exp_f32 v2, v2
    v_exp_f32 v3, v3
    v_cvt_pk_bf16_f32 v32, v0, v1
    v_cvt_pk_bf16_f32 v33, v2, v3
    ds_read_b128 v[100:103], v106 offset:608
    v_exp_f32 v4, v4
    v_exp_f32 v5, v5
    v_exp_f32 v6, v6
    v_exp_f32 v7, v7
    v_cvt_pk_bf16_f32 v34, v4, v5
    v_cvt_pk_bf16_f32 v35, v6, v7
    v_mfma_f32_32x32x8bf16_1k v[16:31], v[92:93], v[84:85], v[16:31]
    v_exp_f32 v8, v8
    v_exp_f32 v9, v9
    v_exp_f32 v10, v10
    v_exp_f32 v11, v11
    v_mfma_f32_32x32x16_bf16 v[40:55], v[96:99], v[32:35], 0
    v_cvt_pk_bf16_f32 v36, v8, v9
    v_cvt_pk_bf16_f32 v37, v10, v11
    v_exp_f32 v12, v12
    v_exp_f32 v13, v13
    v_exp_f32 v14, v14
    v_exp_f32 v15, v15
    v_cvt_pk_bf16_f32 v38, v12, v13
    v_cvt_pk_bf16_f32 v39, v14, v15
    s_waitcnt lgkmcnt(0)
    v_mfma_f32_32x32x16_bf16 v[0:15], v[88:91], v[72:75], 0
    v_exp_f32 v16, v16
    v_exp_f32 v17, v17
    v_exp_f32 v18, v18
    v_exp_f32 v19, v19
    v_cvt_pk_bf16_f32 v32, v16, v17
    v_cvt_pk_bf16_f32 v33, v18, v19
    v_mfma_f32_32x32x16_bf16 v[40:55], v[100:103], v[36:39], v[40:55]
    v_exp_f32 v20, v20
    v_exp_f32 v21, v21
    v_exp_f32 v22, v22
    v_exp_f32 v23, v23
    v_cvt_pk_bf16_f32 v34, v20, v21
    v_cvt_pk_bf16_f32 v35, v22, v23
    v_mfma_f32_32x32x8bf16_1k v[0:15], v[92:93], v[78:79], v[0:15]
    v_exp_f32 v24, v24
    v_exp_f32 v25, v25
    v_exp_f32 v26, v26
    v_exp_f32 v27, v27
    v_mfma_f32_32x32x16_bf16 v[56:71], v[96:99], v[32:35], 0
    ds_read_b128 v[96:99], v106 offset:1216
    v_cvt_pk_bf16_f32 v36, v24, v25
    v_cvt_pk_bf16_f32 v37, v26, v27
    v_exp_f32 v28, v28
    v_exp_f32 v29, v29
    v_exp_f32 v30, v30
    v_exp_f32 v31, v31
    v_cvt_pk_bf16_f32 v38, v28, v29
    v_cvt_pk_bf16_f32 v39, v30, v31
    s_waitcnt lgkmcnt(0)
    v_mfma_f32_32x32x16_bf16 v[16:31], v[88:91], v[80:83], 0
    ds_read_b128 v[88:91], v104 offset:4736
    v_exp_f32 v0, v0
    v_exp_f32 v1, v1
    v_exp_f32 v2, v2
    v_exp_f32 v3, v3
    v_cvt_pk_bf16_f32 v32, v0, v1
    v_cvt_pk_bf16_f32 v33, v2, v3
    v_mfma_f32_32x32x16_bf16 v[56:71], v[100:103], v[36:39], v[56:71]
    ds_read_b128 v[100:103], v106 offset:1824
    v_exp_f32 v4, v4
    v_exp_f32 v5, v5
    v_exp_f32 v6, v6
    v_exp_f32 v7, v7
    v_cvt_pk_bf16_f32 v34, v4, v5
    v_cvt_pk_bf16_f32 v35, v6, v7
    v_mfma_f32_32x32x8bf16_1k v[16:31], v[92:93], v[86:87], v[16:31]
    ds_read_b64 v[92:93], v105 offset:4736
    v_exp_f32 v8, v8
    v_exp_f32 v9, v9
    v_exp_f32 v10, v10
    v_exp_f32 v11, v11
    v_mfma_f32_32x32x16_bf16 v[40:55], v[96:99], v[32:35], v[40:55]
    v_cvt_pk_bf16_f32 v36, v8, v9
    v_cvt_pk_bf16_f32 v37, v10, v11
    v_exp_f32 v12, v12
    v_exp_f32 v13, v13
    v_exp_f32 v14, v14
    v_exp_f32 v15, v15
    v_cvt_pk_bf16_f32 v38, v12, v13
    v_cvt_pk_bf16_f32 v39, v14, v15
    s_waitcnt lgkmcnt(0)
    v_mfma_f32_32x32x16_bf16 v[0:15], v[88:91], v[72:75], 0
    v_exp_f32 v16, v16
    v_exp_f32 v17, v17
    v_exp_f32 v18, v18
    v_exp_f32 v19, v19
    v_cvt_pk_bf16_f32 v32, v16, v17
    v_cvt_pk_bf16_f32 v33, v18, v19
    v_mfma_f32_32x32x16_bf16 v[40:55], v[100:103], v[36:39], v[40:55]
    v_exp_f32 v20, v20
    v_exp_f32 v21, v21
    v_exp_f32 v22, v22
    v_exp_f32 v23, v23
    v_cvt_pk_bf16_f32 v34, v20, v21
    v_cvt_pk_bf16_f32 v35, v22, v23
    v_mfma_f32_32x32x8bf16_1k v[0:15], v[92:93], v[76:77], v[0:15]
    v_exp_f32 v24, v24
    v_exp_f32 v25, v25
    v_exp_f32 v26, v26
    v_exp_f32 v27, v27
    v_mfma_f32_32x32x16_bf16 v[56:71], v[96:99], v[32:35], v[56:71]
    ds_read_b128 v[96:99], v106 offset:4736
    v_cvt_pk_bf16_f32 v36, v24, v25
    v_cvt_pk_bf16_f32 v37, v26, v27
    v_exp_f32 v28, v28
    v_exp_f32 v29, v29
    v_exp_f32 v30, v30
    v_exp_f32 v31, v31
    v_cvt_pk_bf16_f32 v38, v28, v29
    v_cvt_pk_bf16_f32 v39, v30, v31
    s_waitcnt lgkmcnt(0)
    v_mfma_f32_32x32x16_bf16 v[16:31], v[88:91], v[80:83], 0
    ds_read_b128 v[88:91], v104 offset:5760
    v_exp_f32 v0, v0
    v_exp_f32 v1, v1
    v_exp_f32 v2, v2
    v_exp_f32 v3, v3
    v_cvt_pk_bf16_f32 v32, v0, v1
    v_cvt_pk_bf16_f32 v33, v2, v3
    v_mfma_f32_32x32x16_bf16 v[56:71], v[100:103], v[36:39], v[56:71]
    ds_read_b128 v[100:103], v106 offset:5344
    v_exp_f32 v4, v4
    v_exp_f32 v5, v5
    v_exp_f32 v6, v6
    v_exp_f32 v7, v7
    v_cvt_pk_bf16_f32 v34, v4, v5
    v_cvt_pk_bf16_f32 v35, v6, v7
    v_mfma_f32_32x32x8bf16_1k v[16:31], v[92:93], v[84:85], v[16:31]
    v_exp_f32 v8, v8
    v_exp_f32 v9, v9
    v_exp_f32 v10, v10
    v_exp_f32 v11, v11
    v_mfma_f32_32x32x16_bf16 v[40:55], v[96:99], v[32:35], v[40:55]
    v_cvt_pk_bf16_f32 v36, v8, v9
    v_cvt_pk_bf16_f32 v37, v10, v11
    v_exp_f32 v12, v12
    v_exp_f32 v13, v13
    v_exp_f32 v14, v14
    v_exp_f32 v15, v15
    v_cvt_pk_bf16_f32 v38, v12, v13
    v_cvt_pk_bf16_f32 v39, v14, v15
    s_waitcnt lgkmcnt(0)
    v_mfma_f32_32x32x16_bf16 v[0:15], v[88:91], v[72:75], 0
    v_exp_f32 v16, v16
    v_exp_f32 v17, v17
    v_exp_f32 v18, v18
    v_exp_f32 v19, v19
    v_cvt_pk_bf16_f32 v32, v16, v17
    v_cvt_pk_bf16_f32 v33, v18, v19
    v_mfma_f32_32x32x16_bf16 v[40:55], v[100:103], v[36:39], v[40:55]
    v_exp_f32 v20, v20
    v_exp_f32 v21, v21
    v_exp_f32 v22, v22
    v_exp_f32 v23, v23
    v_cvt_pk_bf16_f32 v34, v20, v21
    v_cvt_pk_bf16_f32 v35, v22, v23
    v_mfma_f32_32x32x8bf16_1k v[0:15], v[92:93], v[78:79], v[0:15]
    v_exp_f32 v24, v24
    v_exp_f32 v25, v25
    v_exp_f32 v26, v26
    v_exp_f32 v27, v27
    v_mfma_f32_32x32x16_bf16 v[56:71], v[96:99], v[32:35], v[56:71]
    ds_read_b128 v[96:99], v106 offset:5952
    v_cvt_pk_bf16_f32 v36, v24, v25
    v_cvt_pk_bf16_f32 v37, v26, v27
    v_exp_f32 v28, v28
    v_exp_f32 v29, v29
    v_exp_f32 v30, v30
    v_exp_f32 v31, v31
    v_cvt_pk_bf16_f32 v38, v28, v29
    v_cvt_pk_bf16_f32 v39, v30, v31
    s_waitcnt lgkmcnt(0)
    v_mfma_f32_32x32x16_bf16 v[16:31], v[88:91], v[80:83], 0
    ds_read_b128 v[88:91], v104 offset:9472
    v_exp_f32 v0, v0
    v_exp_f32 v1, v1
    v_exp_f32 v2, v2
    v_exp_f32 v3, v3
    v_cvt_pk_bf16_f32 v32, v0, v1
    v_cvt_pk_bf16_f32 v33, v2, v3
    v_mfma_f32_32x32x16_bf16 v[56:71], v[100:103], v[36:39], v[56:71]
    ds_read_b128 v[100:103], v106 offset:6560
    v_exp_f32 v4, v4
    v_exp_f32 v5, v5
    v_exp_f32 v6, v6
    v_exp_f32 v7, v7
    v_cvt_pk_bf16_f32 v34, v4, v5
    v_cvt_pk_bf16_f32 v35, v6, v7
    v_mfma_f32_32x32x8bf16_1k v[16:31], v[92:93], v[86:87], v[16:31]
    ds_read_b64 v[92:93], v105 offset:9472
    v_exp_f32 v8, v8
    v_exp_f32 v9, v9
    v_exp_f32 v10, v10
    v_exp_f32 v11, v11
    v_mfma_f32_32x32x16_bf16 v[40:55], v[96:99], v[32:35], v[40:55]
    v_cvt_pk_bf16_f32 v36, v8, v9
    v_cvt_pk_bf16_f32 v37, v10, v11
    v_exp_f32 v12, v12
    v_exp_f32 v13, v13
    v_exp_f32 v14, v14
    v_exp_f32 v15, v15
    v_cvt_pk_bf16_f32 v38, v12, v13
    v_cvt_pk_bf16_f32 v39, v14, v15
    s_waitcnt lgkmcnt(0)
    v_mfma_f32_32x32x16_bf16 v[0:15], v[88:91], v[72:75], 0
    v_exp_f32 v16, v16
    v_exp_f32 v17, v17
    v_exp_f32 v18, v18
    v_exp_f32 v19, v19
    v_cvt_pk_bf16_f32 v32, v16, v17
    v_cvt_pk_bf16_f32 v33, v18, v19
    v_mfma_f32_32x32x16_bf16 v[40:55], v[100:103], v[36:39], v[40:55]
    v_exp_f32 v20, v20
    v_exp_f32 v21, v21
    v_exp_f32 v22, v22
    v_exp_f32 v23, v23
    v_cvt_pk_bf16_f32 v34, v20, v21
    v_cvt_pk_bf16_f32 v35, v22, v23
    v_mfma_f32_32x32x8bf16_1k v[0:15], v[92:93], v[76:77], v[0:15]
    v_exp_f32 v24, v24
    v_exp_f32 v25, v25
    v_exp_f32 v26, v26
    v_exp_f32 v27, v27
    v_mfma_f32_32x32x16_bf16 v[56:71], v[96:99], v[32:35], v[56:71]
    ds_read_b128 v[96:99], v106 offset:9472
    v_cvt_pk_bf16_f32 v36, v24, v25
    v_cvt_pk_bf16_f32 v37, v26, v27
    v_exp_f32 v28, v28
    v_exp_f32 v29, v29
    v_exp_f32 v30, v30
    v_exp_f32 v31, v31
    v_cvt_pk_bf16_f32 v38, v28, v29
    v_cvt_pk_bf16_f32 v39, v30, v31
    s_waitcnt lgkmcnt(0)
    v_mfma_f32_32x32x16_bf16 v[16:31], v[88:91], v[80:83], 0
    ds_read_b128 v[88:91], v104 offset:10496
    v_exp_f32 v0, v0
    v_exp_f32 v1, v1
    v_exp_f32 v2, v2
    v_exp_f32 v3, v3
    v_cvt_pk_bf16_f32 v32, v0, v1
    v_cvt_pk_bf16_f32 v33, v2, v3
    v_mfma_f32_32x32x16_bf16 v[56:71], v[100:103], v[36:39], v[56:71]
    ds_read_b128 v[100:103], v106 offset:10080
    v_exp_f32 v4, v4
    v_exp_f32 v5, v5
    v_exp_f32 v6, v6
    v_exp_f32 v7, v7
    v_cvt_pk_bf16_f32 v34, v4, v5
    v_cvt_pk_bf16_f32 v35, v6, v7
    v_mfma_f32_32x32x8bf16_1k v[16:31], v[92:93], v[84:85], v[16:31]
    v_exp_f32 v8, v8
    v_exp_f32 v9, v9
    v_exp_f32 v10, v10
    v_exp_f32 v11, v11
    v_mfma_f32_32x32x16_bf16 v[40:55], v[96:99], v[32:35], v[40:55]
    v_cvt_pk_bf16_f32 v36, v8, v9
    v_cvt_pk_bf16_f32 v37, v10, v11
    v_exp_f32 v12, v12
    v_exp_f32 v13, v13
    v_exp_f32 v14, v14
    v_exp_f32 v15, v15
    v_cvt_pk_bf16_f32 v38, v12, v13
    v_cvt_pk_bf16_f32 v39, v14, v15
    s_waitcnt lgkmcnt(0)
    v_mfma_f32_32x32x16_bf16 v[0:15], v[88:91], v[72:75], 0
    v_exp_f32 v16, v16
    v_exp_f32 v17, v17
    v_exp_f32 v18, v18
    v_exp_f32 v19, v19
    v_cvt_pk_bf16_f32 v32, v16, v17
    v_cvt_pk_bf16_f32 v33, v18, v19
    v_mfma_f32_32x32x16_bf16 v[40:55], v[100:103], v[36:39], v[40:55]
    v_exp_f32 v20, v20
    v_exp_f32 v21, v21
    v_exp_f32 v22, v22
    v_exp_f32 v23, v23
    v_cvt_pk_bf16_f32 v34, v20, v21
    v_cvt_pk_bf16_f32 v35, v22, v23
    v_mfma_f32_32x32x8bf16_1k v[0:15], v[92:93], v[78:79], v[0:15]
    v_exp_f32 v24, v24
    v_exp_f32 v25, v25
    v_exp_f32 v26, v26
    v_exp_f32 v27, v27
    v_mfma_f32_32x32x16_bf16 v[56:71], v[96:99], v[32:35], v[56:71]
    ds_read_b128 v[96:99], v106 offset:10688
    v_cvt_pk_bf16_f32 v36, v24, v25
    v_cvt_pk_bf16_f32 v37, v26, v27
    v_exp_f32 v28, v28
    v_exp_f32 v29, v29
    v_exp_f32 v30, v30
    v_exp_f32 v31, v31
    v_cvt_pk_bf16_f32 v38, v28, v29
    v_cvt_pk_bf16_f32 v39, v30, v31
    s_waitcnt lgkmcnt(0)
    v_mfma_f32_32x32x16_bf16 v[16:31], v[88:91], v[80:83], 0
    ds_read_b128 v[88:91], v104 offset:14208
    v_exp_f32 v0, v0
    v_exp_f32 v1, v1
    v_exp_f32 v2, v2
    v_exp_f32 v3, v3
    v_cvt_pk_bf16_f32 v32, v0, v1
    v_cvt_pk_bf16_f32 v33, v2, v3
    v_mfma_f32_32x32x16_bf16 v[56:71], v[100:103], v[36:39], v[56:71]
    ds_read_b128 v[100:103], v106 offset:11296
    v_exp_f32 v4, v4
    v_exp_f32 v5, v5
    v_exp_f32 v6, v6
    v_exp_f32 v7, v7
    v_cvt_pk_bf16_f32 v34, v4, v5
    v_cvt_pk_bf16_f32 v35, v6, v7
    v_mfma_f32_32x32x8bf16_1k v[16:31], v[92:93], v[86:87], v[16:31]
    ds_read_b64 v[92:93], v105 offset:14208
    v_exp_f32 v8, v8
    v_exp_f32 v9, v9
    v_exp_f32 v10, v10
    v_exp_f32 v11, v11
    v_mfma_f32_32x32x16_bf16 v[40:55], v[96:99], v[32:35], v[40:55]
    v_cvt_pk_bf16_f32 v36, v8, v9
    v_cvt_pk_bf16_f32 v37, v10, v11
    v_exp_f32 v12, v12
    v_exp_f32 v13, v13
    v_exp_f32 v14, v14
    v_exp_f32 v15, v15
    v_cvt_pk_bf16_f32 v38, v12, v13
    v_cvt_pk_bf16_f32 v39, v14, v15
    s_waitcnt lgkmcnt(0)
    v_mfma_f32_32x32x16_bf16 v[0:15], v[88:91], v[72:75], 0
    v_exp_f32 v16, v16
    v_exp_f32 v17, v17
    v_exp_f32 v18, v18
    v_exp_f32 v19, v19
    v_cvt_pk_bf16_f32 v32, v16, v17
    v_cvt_pk_bf16_f32 v33, v18, v19
    v_mfma_f32_32x32x16_bf16 v[40:55], v[100:103], v[36:39], v[40:55]
    v_exp_f32 v20, v20
    v_exp_f32 v21, v21
    v_exp_f32 v22, v22
    v_exp_f32 v23, v23
    v_cvt_pk_bf16_f32 v34, v20, v21
    v_cvt_pk_bf16_f32 v35, v22, v23
    v_mfma_f32_32x32x8bf16_1k v[0:15], v[92:93], v[76:77], v[0:15]
    v_exp_f32 v24, v24
    v_exp_f32 v25, v25
    v_exp_f32 v26, v26
    v_exp_f32 v27, v27
    v_mfma_f32_32x32x16_bf16 v[56:71], v[96:99], v[32:35], v[56:71]
    ds_read_b128 v[96:99], v106 offset:14208
    v_cvt_pk_bf16_f32 v36, v24, v25
    v_cvt_pk_bf16_f32 v37, v26, v27
    v_exp_f32 v28, v28
    v_exp_f32 v29, v29
    v_exp_f32 v30, v30
    v_exp_f32 v31, v31
    v_cvt_pk_bf16_f32 v38, v28, v29
    v_cvt_pk_bf16_f32 v39, v30, v31
    s_waitcnt lgkmcnt(0)
    v_mfma_f32_32x32x16_bf16 v[16:31], v[88:91], v[80:83], 0
    ds_read_b128 v[88:91], v104 offset:15232
    v_exp_f32 v0, v0
    v_exp_f32 v1, v1
    v_exp_f32 v2, v2
    v_exp_f32 v3, v3
    v_cvt_pk_bf16_f32 v32, v0, v1
    v_cvt_pk_bf16_f32 v33, v2, v3
    v_mfma_f32_32x32x16_bf16 v[56:71], v[100:103], v[36:39], v[56:71]
    ds_read_b128 v[100:103], v106 offset:14816
    v_exp_f32 v4, v4
    v_exp_f32 v5, v5
    v_exp_f32 v6, v6
    v_exp_f32 v7, v7
    v_cvt_pk_bf16_f32 v34, v4, v5
    v_cvt_pk_bf16_f32 v35, v6, v7
    v_mfma_f32_32x32x8bf16_1k v[16:31], v[92:93], v[84:85], v[16:31]
    v_exp_f32 v8, v8
    v_exp_f32 v9, v9
    v_exp_f32 v10, v10
    v_exp_f32 v11, v11
    v_mfma_f32_32x32x16_bf16 v[40:55], v[96:99], v[32:35], v[40:55]
    v_cvt_pk_bf16_f32 v36, v8, v9
    v_cvt_pk_bf16_f32 v37, v10, v11
    v_exp_f32 v12, v12
    v_exp_f32 v13, v13
    v_exp_f32 v14, v14
    v_exp_f32 v15, v15
    v_cvt_pk_bf16_f32 v38, v12, v13
    v_cvt_pk_bf16_f32 v39, v14, v15
    s_waitcnt lgkmcnt(0)
    v_mfma_f32_32x32x16_bf16 v[0:15], v[88:91], v[72:75], 0
    v_exp_f32 v16, v16
    v_exp_f32 v17, v17
    v_exp_f32 v18, v18
    v_exp_f32 v19, v19
    v_cvt_pk_bf16_f32 v32, v16, v17
    v_cvt_pk_bf16_f32 v33, v18, v19
    v_mfma_f32_32x32x16_bf16 v[40:55], v[100:103], v[36:39], v[40:55]
    v_exp_f32 v20, v20
    v_exp_f32 v21, v21
    v_exp_f32 v22, v22
    v_exp_f32 v23, v23
    v_cvt_pk_bf16_f32 v34, v20, v21
    v_cvt_pk_bf16_f32 v35, v22, v23
    v_mfma_f32_32x32x8bf16_1k v[0:15], v[92:93], v[78:79], v[0:15]
    v_exp_f32 v24, v24
    v_exp_f32 v25, v25
    v_exp_f32 v26, v26
    v_exp_f32 v27, v27
    v_mfma_f32_32x32x16_bf16 v[56:71], v[96:99], v[32:35], v[56:71]
    ds_read_b128 v[96:99], v106 offset:15424
    v_cvt_pk_bf16_f32 v36, v24, v25
    v_cvt_pk_bf16_f32 v37, v26, v27
    v_exp_f32 v28, v28
    v_exp_f32 v29, v29
    v_exp_f32 v30, v30
    v_exp_f32 v31, v31
    v_cvt_pk_bf16_f32 v38, v28, v29
    v_cvt_pk_bf16_f32 v39, v30, v31
    s_barrier
    v_mov_b32 v110, 163632
    ds_read_b32 v111, v110
    v_mov_b32 v112, 0x45610000
    s_waitcnt lgkmcnt(0)
    v_mul_f32 v111, s78, v111
    v_cmp_le_f32 vcc, v111, v112
    s_nop 4
    s_cbranch_vccz L_fallback_69
    buffer_load_dword v161, v161, s[52:55], 0 offen
    s_waitcnt lgkmcnt(0)
    v_mfma_f32_32x32x16_bf16 v[16:31], v[88:91], v[80:83], 0
    v_add_u32 v104, 37888, v104
    ds_read_b128 v[88:91], v104 offset:0
    v_exp_f32 v0, v0
    v_exp_f32 v1, v1
    v_exp_f32 v2, v2
    v_exp_f32 v3, v3
    v_cvt_pk_bf16_f32 v32, v0, v1
    v_cvt_pk_bf16_f32 v33, v2, v3
    v_mfma_f32_32x32x16_bf16 v[56:71], v[100:103], v[36:39], v[56:71]
    ds_read_b128 v[100:103], v106 offset:16032
    v_exp_f32 v4, v4
    v_exp_f32 v5, v5
    v_exp_f32 v6, v6
    v_exp_f32 v7, v7
    v_cvt_pk_bf16_f32 v34, v4, v5
    v_cvt_pk_bf16_f32 v35, v6, v7
    v_mfma_f32_32x32x8bf16_1k v[16:31], v[92:93], v[86:87], v[16:31]
    v_add_u32 v105, 37888, v105
    ds_read_b64 v[92:93], v105 offset:0
    v_exp_f32 v8, v8
    v_exp_f32 v9, v9
    v_exp_f32 v10, v10
    v_exp_f32 v11, v11
    v_mfma_f32_32x32x16_bf16 v[40:55], v[96:99], v[32:35], v[40:55]
    v_cvt_pk_bf16_f32 v36, v8, v9
    v_cvt_pk_bf16_f32 v37, v10, v11
    v_exp_f32 v12, v12
    v_exp_f32 v13, v13
    v_exp_f32 v14, v14
    v_exp_f32 v15, v15
    v_cvt_pk_bf16_f32 v38, v12, v13
    v_cvt_pk_bf16_f32 v39, v14, v15
    s_waitcnt lgkmcnt(0)
    v_mfma_f32_32x32x16_bf16 v[0:15], v[88:91], v[72:75], 0
    v_exp_f32 v16, v16
    v_exp_f32 v17, v17
    v_exp_f32 v18, v18
    v_exp_f32 v19, v19
    v_cvt_pk_bf16_f32 v32, v16, v17
    v_cvt_pk_bf16_f32 v33, v18, v19
    v_mfma_f32_32x32x16_bf16 v[40:55], v[100:103], v[36:39], v[40:55]
    v_exp_f32 v20, v20
    v_exp_f32 v21, v21
    v_exp_f32 v22, v22
    v_exp_f32 v23, v23
    v_cvt_pk_bf16_f32 v34, v20, v21
    v_cvt_pk_bf16_f32 v35, v22, v23
    v_mfma_f32_32x32x8bf16_1k v[0:15], v[92:93], v[76:77], v[0:15]
    v_exp_f32 v24, v24
    v_exp_f32 v25, v25
    v_exp_f32 v26, v26
    v_exp_f32 v27, v27
    v_mfma_f32_32x32x16_bf16 v[56:71], v[96:99], v[32:35], v[56:71]
    v_add_u32 v106, 37888, v106
    ds_read_b128 v[96:99], v106 offset:0
    v_cvt_pk_bf16_f32 v36, v24, v25
    v_cvt_pk_bf16_f32 v37, v26, v27
    v_exp_f32 v28, v28
    v_exp_f32 v29, v29
    v_exp_f32 v30, v30
    v_exp_f32 v31, v31
    v_cvt_pk_bf16_f32 v38, v28, v29
    v_cvt_pk_bf16_f32 v39, v30, v31
    s_waitcnt lgkmcnt(0)
    v_mfma_f32_32x32x16_bf16 v[16:31], v[88:91], v[80:83], 0
    ds_read_b128 v[88:91], v104 offset:1024
    v_exp_f32 v0, v0
    v_exp_f32 v1, v1
    v_exp_f32 v2, v2
    v_exp_f32 v3, v3
    v_cvt_pk_bf16_f32 v32, v0, v1
    v_cvt_pk_bf16_f32 v33, v2, v3
    v_mfma_f32_32x32x16_bf16 v[56:71], v[100:103], v[36:39], v[56:71]
    ds_read_b128 v[100:103], v106 offset:608
    v_exp_f32 v4, v4
    v_exp_f32 v5, v5
    v_exp_f32 v6, v6
    v_exp_f32 v7, v7
    v_cvt_pk_bf16_f32 v34, v4, v5
    v_cvt_pk_bf16_f32 v35, v6, v7
    v_mfma_f32_32x32x8bf16_1k v[16:31], v[92:93], v[84:85], v[16:31]
    v_exp_f32 v8, v8
    v_exp_f32 v9, v9
    v_exp_f32 v10, v10
    v_exp_f32 v11, v11
    v_mfma_f32_32x32x16_bf16 v[40:55], v[96:99], v[32:35], v[40:55]
    v_cvt_pk_bf16_f32 v36, v8, v9
    v_cvt_pk_bf16_f32 v37, v10, v11
    v_exp_f32 v12, v12
    v_exp_f32 v13, v13
    v_exp_f32 v14, v14
    v_exp_f32 v15, v15
    v_cvt_pk_bf16_f32 v38, v12, v13
    v_cvt_pk_bf16_f32 v39, v14, v15
    s_waitcnt lgkmcnt(0)
    v_mfma_f32_32x32x16_bf16 v[0:15], v[88:91], v[72:75], 0
    v_exp_f32 v16, v16
    v_exp_f32 v17, v17
    v_exp_f32 v18, v18
    v_exp_f32 v19, v19
    v_cvt_pk_bf16_f32 v32, v16, v17
    v_cvt_pk_bf16_f32 v33, v18, v19
    v_mfma_f32_32x32x16_bf16 v[40:55], v[100:103], v[36:39], v[40:55]
    v_exp_f32 v20, v20
    v_exp_f32 v21, v21
    v_exp_f32 v22, v22
    v_exp_f32 v23, v23
    v_cvt_pk_bf16_f32 v34, v20, v21
    v_cvt_pk_bf16_f32 v35, v22, v23
    v_mfma_f32_32x32x8bf16_1k v[0:15], v[92:93], v[78:79], v[0:15]
    v_exp_f32 v24, v24
    v_exp_f32 v25, v25
    v_exp_f32 v26, v26
    v_exp_f32 v27, v27
    v_mfma_f32_32x32x16_bf16 v[56:71], v[96:99], v[32:35], v[56:71]
    ds_read_b128 v[96:99], v106 offset:1216
    v_cvt_pk_bf16_f32 v36, v24, v25
    v_cvt_pk_bf16_f32 v37, v26, v27
    v_exp_f32 v28, v28
    v_exp_f32 v29, v29
    v_exp_f32 v30, v30
    v_exp_f32 v31, v31
    v_cvt_pk_bf16_f32 v38, v28, v29
    v_cvt_pk_bf16_f32 v39, v30, v31
    s_waitcnt lgkmcnt(0)
    v_mfma_f32_32x32x16_bf16 v[16:31], v[88:91], v[80:83], 0
    ds_read_b128 v[88:91], v104 offset:4736
    v_exp_f32 v0, v0
    v_exp_f32 v1, v1
    v_exp_f32 v2, v2
    v_exp_f32 v3, v3
    v_cvt_pk_bf16_f32 v32, v0, v1
    v_cvt_pk_bf16_f32 v33, v2, v3
    v_mfma_f32_32x32x16_bf16 v[56:71], v[100:103], v[36:39], v[56:71]
    ds_read_b128 v[100:103], v106 offset:1824
    v_exp_f32 v4, v4
    v_exp_f32 v5, v5
    v_exp_f32 v6, v6
    v_exp_f32 v7, v7
    v_cvt_pk_bf16_f32 v34, v4, v5
    v_cvt_pk_bf16_f32 v35, v6, v7
    v_mfma_f32_32x32x8bf16_1k v[16:31], v[92:93], v[86:87], v[16:31]
    ds_read_b64 v[92:93], v105 offset:4736
    v_exp_f32 v8, v8
    v_exp_f32 v9, v9
    v_exp_f32 v10, v10
    v_exp_f32 v11, v11
    v_mfma_f32_32x32x16_bf16 v[40:55], v[96:99], v[32:35], v[40:55]
    v_cvt_pk_bf16_f32 v36, v8, v9
    v_cvt_pk_bf16_f32 v37, v10, v11
    v_exp_f32 v12, v12
    v_exp_f32 v13, v13
    v_exp_f32 v14, v14
    v_exp_f32 v15, v15
    v_cvt_pk_bf16_f32 v38, v12, v13
    v_cvt_pk_bf16_f32 v39, v14, v15
    s_waitcnt lgkmcnt(0)
    v_mfma_f32_32x32x16_bf16 v[0:15], v[88:91], v[72:75], 0
    v_exp_f32 v16, v16
    v_exp_f32 v17, v17
    v_exp_f32 v18, v18
    v_exp_f32 v19, v19
    v_cvt_pk_bf16_f32 v32, v16, v17
    v_cvt_pk_bf16_f32 v33, v18, v19
    v_mfma_f32_32x32x16_bf16 v[40:55], v[100:103], v[36:39], v[40:55]
    v_exp_f32 v20, v20
    v_exp_f32 v21, v21
    v_exp_f32 v22, v22
    v_exp_f32 v23, v23
    v_cvt_pk_bf16_f32 v34, v20, v21
    v_cvt_pk_bf16_f32 v35, v22, v23
    v_mfma_f32_32x32x8bf16_1k v[0:15], v[92:93], v[76:77], v[0:15]
    v_exp_f32 v24, v24
    v_exp_f32 v25, v25
    v_exp_f32 v26, v26
    v_exp_f32 v27, v27
    v_mfma_f32_32x32x16_bf16 v[56:71], v[96:99], v[32:35], v[56:71]
    ds_read_b128 v[96:99], v106 offset:4736
    v_cvt_pk_bf16_f32 v36, v24, v25
    v_cvt_pk_bf16_f32 v37, v26, v27
    v_exp_f32 v28, v28
    v_exp_f32 v29, v29
    v_exp_f32 v30, v30
    v_exp_f32 v31, v31
    v_cvt_pk_bf16_f32 v38, v28, v29
    v_cvt_pk_bf16_f32 v39, v30, v31
    s_waitcnt lgkmcnt(0)
    v_mfma_f32_32x32x16_bf16 v[16:31], v[88:91], v[80:83], 0
    ds_read_b128 v[88:91], v104 offset:5760
    v_exp_f32 v0, v0
    v_exp_f32 v1, v1
    v_exp_f32 v2, v2
    v_exp_f32 v3, v3
    v_cvt_pk_bf16_f32 v32, v0, v1
    v_cvt_pk_bf16_f32 v33, v2, v3
    v_mfma_f32_32x32x16_bf16 v[56:71], v[100:103], v[36:39], v[56:71]
    ds_read_b128 v[100:103], v106 offset:5344
    v_exp_f32 v4, v4
    v_exp_f32 v5, v5
    v_exp_f32 v6, v6
    v_exp_f32 v7, v7
    v_cvt_pk_bf16_f32 v34, v4, v5
    v_cvt_pk_bf16_f32 v35, v6, v7
    v_mfma_f32_32x32x8bf16_1k v[16:31], v[92:93], v[84:85], v[16:31]
    v_exp_f32 v8, v8
    v_exp_f32 v9, v9
    v_exp_f32 v10, v10
    v_exp_f32 v11, v11
    v_mfma_f32_32x32x16_bf16 v[40:55], v[96:99], v[32:35], v[40:55]
    v_cvt_pk_bf16_f32 v36, v8, v9
    v_cvt_pk_bf16_f32 v37, v10, v11
    v_exp_f32 v12, v12
    v_exp_f32 v13, v13
    v_exp_f32 v14, v14
    v_exp_f32 v15, v15
    v_cvt_pk_bf16_f32 v38, v12, v13
    v_cvt_pk_bf16_f32 v39, v14, v15
    s_waitcnt lgkmcnt(0)
    v_mfma_f32_32x32x16_bf16 v[0:15], v[88:91], v[72:75], 0
    v_exp_f32 v16, v16
    v_exp_f32 v17, v17
    v_exp_f32 v18, v18
    v_exp_f32 v19, v19
    v_cvt_pk_bf16_f32 v32, v16, v17
    v_cvt_pk_bf16_f32 v33, v18, v19
    v_mfma_f32_32x32x16_bf16 v[40:55], v[100:103], v[36:39], v[40:55]
    v_exp_f32 v20, v20
    v_exp_f32 v21, v21
    v_exp_f32 v22, v22
    v_exp_f32 v23, v23
    v_cvt_pk_bf16_f32 v34, v20, v21
    v_cvt_pk_bf16_f32 v35, v22, v23
    v_mfma_f32_32x32x8bf16_1k v[0:15], v[92:93], v[78:79], v[0:15]
    v_exp_f32 v24, v24
    v_exp_f32 v25, v25
    v_exp_f32 v26, v26
    v_exp_f32 v27, v27
    v_mfma_f32_32x32x16_bf16 v[56:71], v[96:99], v[32:35], v[56:71]
    ds_read_b128 v[96:99], v106 offset:5952
    v_cvt_pk_bf16_f32 v36, v24, v25
    v_cvt_pk_bf16_f32 v37, v26, v27
    v_exp_f32 v28, v28
    v_exp_f32 v29, v29
    v_exp_f32 v30, v30
    v_exp_f32 v31, v31
    v_cvt_pk_bf16_f32 v38, v28, v29
    v_cvt_pk_bf16_f32 v39, v30, v31
    s_waitcnt lgkmcnt(0)
    v_mfma_f32_32x32x16_bf16 v[16:31], v[88:91], v[80:83], 0
    ds_read_b128 v[88:91], v104 offset:9472
    v_exp_f32 v0, v0
    v_exp_f32 v1, v1
    v_exp_f32 v2, v2
    v_exp_f32 v3, v3
    v_cvt_pk_bf16_f32 v32, v0, v1
    v_cvt_pk_bf16_f32 v33, v2, v3
    v_mfma_f32_32x32x16_bf16 v[56:71], v[100:103], v[36:39], v[56:71]
    ds_read_b128 v[100:103], v106 offset:6560
    v_exp_f32 v4, v4
    v_exp_f32 v5, v5
    v_exp_f32 v6, v6
    v_exp_f32 v7, v7
    v_cvt_pk_bf16_f32 v34, v4, v5
    v_cvt_pk_bf16_f32 v35, v6, v7
    v_mfma_f32_32x32x8bf16_1k v[16:31], v[92:93], v[86:87], v[16:31]
    ds_read_b64 v[92:93], v105 offset:9472
    v_exp_f32 v8, v8
    v_exp_f32 v9, v9
    v_exp_f32 v10, v10
    v_exp_f32 v11, v11
    v_mfma_f32_32x32x16_bf16 v[40:55], v[96:99], v[32:35], v[40:55]
    v_cvt_pk_bf16_f32 v36, v8, v9
    v_cvt_pk_bf16_f32 v37, v10, v11
    v_exp_f32 v12, v12
    v_exp_f32 v13, v13
    v_exp_f32 v14, v14
    v_exp_f32 v15, v15
    v_cvt_pk_bf16_f32 v38, v12, v13
    v_cvt_pk_bf16_f32 v39, v14, v15
    s_waitcnt lgkmcnt(0)
    v_mfma_f32_32x32x16_bf16 v[0:15], v[88:91], v[72:75], 0
    v_exp_f32 v16, v16
    v_exp_f32 v17, v17
    v_exp_f32 v18, v18
    v_exp_f32 v19, v19
    v_cvt_pk_bf16_f32 v32, v16, v17
    v_cvt_pk_bf16_f32 v33, v18, v19
    v_mfma_f32_32x32x16_bf16 v[40:55], v[100:103], v[36:39], v[40:55]
    v_exp_f32 v20, v20
    v_exp_f32 v21, v21
    v_exp_f32 v22, v22
    v_exp_f32 v23, v23
    v_cvt_pk_bf16_f32 v34, v20, v21
    v_cvt_pk_bf16_f32 v35, v22, v23
    v_mfma_f32_32x32x8bf16_1k v[0:15], v[92:93], v[76:77], v[0:15]
    v_exp_f32 v24, v24
    v_exp_f32 v25, v25
    v_exp_f32 v26, v26
    v_exp_f32 v27, v27
    v_mfma_f32_32x32x16_bf16 v[56:71], v[96:99], v[32:35], v[56:71]
    ds_read_b128 v[96:99], v106 offset:9472
    v_cvt_pk_bf16_f32 v36, v24, v25
    v_cvt_pk_bf16_f32 v37, v26, v27
    v_exp_f32 v28, v28
    v_exp_f32 v29, v29
    v_exp_f32 v30, v30
    v_exp_f32 v31, v31
    v_cvt_pk_bf16_f32 v38, v28, v29
    v_cvt_pk_bf16_f32 v39, v30, v31
    s_waitcnt lgkmcnt(0)
    v_mfma_f32_32x32x16_bf16 v[16:31], v[88:91], v[80:83], 0
    ds_read_b128 v[88:91], v104 offset:10496
    v_exp_f32 v0, v0
    v_exp_f32 v1, v1
    v_exp_f32 v2, v2
    v_exp_f32 v3, v3
    v_cvt_pk_bf16_f32 v32, v0, v1
    v_cvt_pk_bf16_f32 v33, v2, v3
    v_mfma_f32_32x32x16_bf16 v[56:71], v[100:103], v[36:39], v[56:71]
    ds_read_b128 v[100:103], v106 offset:10080
    v_exp_f32 v4, v4
    v_exp_f32 v5, v5
    v_exp_f32 v6, v6
    v_exp_f32 v7, v7
    v_cvt_pk_bf16_f32 v34, v4, v5
    v_cvt_pk_bf16_f32 v35, v6, v7
    v_mfma_f32_32x32x8bf16_1k v[16:31], v[92:93], v[84:85], v[16:31]
    v_exp_f32 v8, v8
    v_exp_f32 v9, v9
    v_exp_f32 v10, v10
    v_exp_f32 v11, v11
    v_mfma_f32_32x32x16_bf16 v[40:55], v[96:99], v[32:35], v[40:55]
    v_cvt_pk_bf16_f32 v36, v8, v9
    v_cvt_pk_bf16_f32 v37, v10, v11
    v_exp_f32 v12, v12
    v_exp_f32 v13, v13
    v_exp_f32 v14, v14
    v_exp_f32 v15, v15
    v_cvt_pk_bf16_f32 v38, v12, v13
    v_cvt_pk_bf16_f32 v39, v14, v15
    s_waitcnt lgkmcnt(0)
    v_mfma_f32_32x32x16_bf16 v[0:15], v[88:91], v[72:75], 0
    v_exp_f32 v16, v16
    v_exp_f32 v17, v17
    v_exp_f32 v18, v18
    v_exp_f32 v19, v19
    v_cvt_pk_bf16_f32 v32, v16, v17
    v_cvt_pk_bf16_f32 v33, v18, v19
    v_mfma_f32_32x32x16_bf16 v[40:55], v[100:103], v[36:39], v[40:55]
    v_exp_f32 v20, v20
    v_exp_f32 v21, v21
    v_exp_f32 v22, v22
    v_exp_f32 v23, v23
    v_cvt_pk_bf16_f32 v34, v20, v21
    v_cvt_pk_bf16_f32 v35, v22, v23
    v_mfma_f32_32x32x8bf16_1k v[0:15], v[92:93], v[78:79], v[0:15]
    v_exp_f32 v24, v24
    v_exp_f32 v25, v25
    v_exp_f32 v26, v26
    v_exp_f32 v27, v27
    v_mfma_f32_32x32x16_bf16 v[56:71], v[96:99], v[32:35], v[56:71]
    ds_read_b128 v[96:99], v106 offset:10688
    v_cvt_pk_bf16_f32 v36, v24, v25
    v_cvt_pk_bf16_f32 v37, v26, v27
    v_exp_f32 v28, v28
    v_exp_f32 v29, v29
    v_exp_f32 v30, v30
    v_exp_f32 v31, v31
    v_cvt_pk_bf16_f32 v38, v28, v29
    v_cvt_pk_bf16_f32 v39, v30, v31
    s_waitcnt lgkmcnt(0)
    v_mfma_f32_32x32x16_bf16 v[16:31], v[88:91], v[80:83], 0
    ds_read_b128 v[88:91], v104 offset:14208
    v_exp_f32 v0, v0
    v_exp_f32 v1, v1
    v_exp_f32 v2, v2
    v_exp_f32 v3, v3
    v_cvt_pk_bf16_f32 v32, v0, v1
    v_cvt_pk_bf16_f32 v33, v2, v3
    v_mfma_f32_32x32x16_bf16 v[56:71], v[100:103], v[36:39], v[56:71]
    ds_read_b128 v[100:103], v106 offset:11296
    v_exp_f32 v4, v4
    v_exp_f32 v5, v5
    v_exp_f32 v6, v6
    v_exp_f32 v7, v7
    v_cvt_pk_bf16_f32 v34, v4, v5
    v_cvt_pk_bf16_f32 v35, v6, v7
    v_mfma_f32_32x32x8bf16_1k v[16:31], v[92:93], v[86:87], v[16:31]
    ds_read_b64 v[92:93], v105 offset:14208
    v_exp_f32 v8, v8
    v_exp_f32 v9, v9
    v_exp_f32 v10, v10
    v_exp_f32 v11, v11
    v_mfma_f32_32x32x16_bf16 v[40:55], v[96:99], v[32:35], v[40:55]
    v_cvt_pk_bf16_f32 v36, v8, v9
    v_cvt_pk_bf16_f32 v37, v10, v11
    v_exp_f32 v12, v12
    v_exp_f32 v13, v13
    v_exp_f32 v14, v14
    v_exp_f32 v15, v15
    v_cvt_pk_bf16_f32 v38, v12, v13
    v_cvt_pk_bf16_f32 v39, v14, v15
    s_waitcnt lgkmcnt(0)
    v_mfma_f32_32x32x16_bf16 v[0:15], v[88:91], v[72:75], 0
    v_exp_f32 v16, v16
    v_exp_f32 v17, v17
    v_exp_f32 v18, v18
    v_exp_f32 v19, v19
    v_cvt_pk_bf16_f32 v32, v16, v17
    v_cvt_pk_bf16_f32 v33, v18, v19
    v_mfma_f32_32x32x16_bf16 v[40:55], v[100:103], v[36:39], v[40:55]
    v_exp_f32 v20, v20
    v_exp_f32 v21, v21
    v_exp_f32 v22, v22
    v_exp_f32 v23, v23
    v_cvt_pk_bf16_f32 v34, v20, v21
    v_cvt_pk_bf16_f32 v35, v22, v23
    v_mfma_f32_32x32x8bf16_1k v[0:15], v[92:93], v[76:77], v[0:15]
    v_exp_f32 v24, v24
    v_exp_f32 v25, v25
    v_exp_f32 v26, v26
    v_exp_f32 v27, v27
    v_mfma_f32_32x32x16_bf16 v[56:71], v[96:99], v[32:35], v[56:71]
    ds_read_b128 v[96:99], v106 offset:14208
    v_cvt_pk_bf16_f32 v36, v24, v25
    v_cvt_pk_bf16_f32 v37, v26, v27
    v_exp_f32 v28, v28
    v_exp_f32 v29, v29
    v_exp_f32 v30, v30
    v_exp_f32 v31, v31
    v_cvt_pk_bf16_f32 v38, v28, v29
    v_cvt_pk_bf16_f32 v39, v30, v31
    s_waitcnt lgkmcnt(0)
    v_mfma_f32_32x32x16_bf16 v[16:31], v[88:91], v[80:83], 0
    ds_read_b128 v[88:91], v104 offset:15232
    v_exp_f32 v0, v0
    v_exp_f32 v1, v1
    v_exp_f32 v2, v2
    v_exp_f32 v3, v3
    v_cvt_pk_bf16_f32 v32, v0, v1
    v_cvt_pk_bf16_f32 v33, v2, v3
    v_mfma_f32_32x32x16_bf16 v[56:71], v[100:103], v[36:39], v[56:71]
    ds_read_b128 v[100:103], v106 offset:14816
    v_exp_f32 v4, v4
    v_exp_f32 v5, v5
    v_exp_f32 v6, v6
    v_exp_f32 v7, v7
    v_cvt_pk_bf16_f32 v34, v4, v5
    v_cvt_pk_bf16_f32 v35, v6, v7
    v_mfma_f32_32x32x8bf16_1k v[16:31], v[92:93], v[84:85], v[16:31]
    v_exp_f32 v8, v8
    v_exp_f32 v9, v9
    v_exp_f32 v10, v10
    v_exp_f32 v11, v11
    v_mfma_f32_32x32x16_bf16 v[40:55], v[96:99], v[32:35], v[40:55]
    v_cvt_pk_bf16_f32 v36, v8, v9
    v_cvt_pk_bf16_f32 v37, v10, v11
    v_exp_f32 v12, v12
    v_exp_f32 v13, v13
    v_exp_f32 v14, v14
    v_exp_f32 v15, v15
    v_cvt_pk_bf16_f32 v38, v12, v13
    v_cvt_pk_bf16_f32 v39, v14, v15
    s_waitcnt lgkmcnt(0)
    v_mfma_f32_32x32x16_bf16 v[0:15], v[88:91], v[72:75], 0
    v_exp_f32 v16, v16
    v_exp_f32 v17, v17
    v_exp_f32 v18, v18
    v_exp_f32 v19, v19
    v_cvt_pk_bf16_f32 v32, v16, v17
    v_cvt_pk_bf16_f32 v33, v18, v19
    v_mfma_f32_32x32x16_bf16 v[40:55], v[100:103], v[36:39], v[40:55]
    v_exp_f32 v20, v20
    v_exp_f32 v21, v21
    v_exp_f32 v22, v22
    v_exp_f32 v23, v23
    v_cvt_pk_bf16_f32 v34, v20, v21
    v_cvt_pk_bf16_f32 v35, v22, v23
    v_mfma_f32_32x32x8bf16_1k v[0:15], v[92:93], v[78:79], v[0:15]
    v_exp_f32 v24, v24
    v_exp_f32 v25, v25
    v_exp_f32 v26, v26
    v_exp_f32 v27, v27
    v_mfma_f32_32x32x16_bf16 v[56:71], v[96:99], v[32:35], v[56:71]
    ds_read_b128 v[96:99], v106 offset:15424
    v_cvt_pk_bf16_f32 v36, v24, v25
    v_cvt_pk_bf16_f32 v37, v26, v27
    v_exp_f32 v28, v28
    v_exp_f32 v29, v29
    v_exp_f32 v30, v30
    v_exp_f32 v31, v31
    v_cvt_pk_bf16_f32 v38, v28, v29
    v_cvt_pk_bf16_f32 v39, v30, v31
    s_waitcnt lgkmcnt(0)
    v_mfma_f32_32x32x16_bf16 v[16:31], v[88:91], v[80:83], 0
    v_add_u32 v104, 37888, v104
    ds_read_b128 v[88:91], v104 offset:0
    v_exp_f32 v0, v0
    v_exp_f32 v1, v1
    v_exp_f32 v2, v2
    v_exp_f32 v3, v3
    v_cvt_pk_bf16_f32 v32, v0, v1
    v_cvt_pk_bf16_f32 v33, v2, v3
    v_mfma_f32_32x32x16_bf16 v[56:71], v[100:103], v[36:39], v[56:71]
    ds_read_b128 v[100:103], v106 offset:16032
    v_exp_f32 v4, v4
    v_exp_f32 v5, v5
    v_exp_f32 v6, v6
    v_exp_f32 v7, v7
    v_cvt_pk_bf16_f32 v34, v4, v5
    v_cvt_pk_bf16_f32 v35, v6, v7
    v_mfma_f32_32x32x8bf16_1k v[16:31], v[92:93], v[86:87], v[16:31]
    v_add_u32 v105, 37888, v105
    ds_read_b64 v[92:93], v105 offset:0
    v_exp_f32 v8, v8
    v_exp_f32 v9, v9
    v_exp_f32 v10, v10
    v_exp_f32 v11, v11
    v_mfma_f32_32x32x16_bf16 v[40:55], v[96:99], v[32:35], v[40:55]
    v_cvt_pk_bf16_f32 v36, v8, v9
    v_cvt_pk_bf16_f32 v37, v10, v11
    v_exp_f32 v12, v12
    v_exp_f32 v13, v13
    v_exp_f32 v14, v14
    v_exp_f32 v15, v15
    v_cvt_pk_bf16_f32 v38, v12, v13
    v_cvt_pk_bf16_f32 v39, v14, v15
    s_waitcnt lgkmcnt(0)
    v_mfma_f32_32x32x16_bf16 v[0:15], v[88:91], v[72:75], 0
    v_exp_f32 v16, v16
    v_exp_f32 v17, v17
    v_exp_f32 v18, v18
    v_exp_f32 v19, v19
    v_cvt_pk_bf16_f32 v32, v16, v17
    v_cvt_pk_bf16_f32 v33, v18, v19
    v_mfma_f32_32x32x16_bf16 v[40:55], v[100:103], v[36:39], v[40:55]
    v_exp_f32 v20, v20
    v_exp_f32 v21, v21
    v_exp_f32 v22, v22
    v_exp_f32 v23, v23
    v_cvt_pk_bf16_f32 v34, v20, v21
    v_cvt_pk_bf16_f32 v35, v22, v23
    v_mfma_f32_32x32x8bf16_1k v[0:15], v[92:93], v[76:77], v[0:15]
    v_exp_f32 v24, v24
    v_exp_f32 v25, v25
    v_exp_f32 v26, v26
    v_exp_f32 v27, v27
    v_mfma_f32_32x32x16_bf16 v[56:71], v[96:99], v[32:35], v[56:71]
    v_add_u32 v106, 37888, v106
    ds_read_b128 v[96:99], v106 offset:0
    v_cvt_pk_bf16_f32 v36, v24, v25
    v_cvt_pk_bf16_f32 v37, v26, v27
    v_exp_f32 v28, v28
    v_exp_f32 v29, v29
    v_exp_f32 v30, v30
    v_exp_f32 v31, v31
    v_cvt_pk_bf16_f32 v38, v28, v29
    v_cvt_pk_bf16_f32 v39, v30, v31
    s_waitcnt lgkmcnt(0)
    v_mfma_f32_32x32x16_bf16 v[16:31], v[88:91], v[80:83], 0
    ds_read_b128 v[88:91], v104 offset:1024
    v_exp_f32 v0, v0
    v_exp_f32 v1, v1
    v_exp_f32 v2, v2
    v_exp_f32 v3, v3
    v_cvt_pk_bf16_f32 v32, v0, v1
    v_cvt_pk_bf16_f32 v33, v2, v3
    v_mfma_f32_32x32x16_bf16 v[56:71], v[100:103], v[36:39], v[56:71]
    ds_read_b128 v[100:103], v106 offset:608
    v_exp_f32 v4, v4
    v_exp_f32 v5, v5
    v_exp_f32 v6, v6
    v_exp_f32 v7, v7
    v_cvt_pk_bf16_f32 v34, v4, v5
    v_cvt_pk_bf16_f32 v35, v6, v7
    v_mfma_f32_32x32x8bf16_1k v[16:31], v[92:93], v[84:85], v[16:31]
    v_exp_f32 v8, v8
    v_exp_f32 v9, v9
    v_exp_f32 v10, v10
    v_exp_f32 v11, v11
    v_mfma_f32_32x32x16_bf16 v[40:55], v[96:99], v[32:35], v[40:55]
    v_cvt_pk_bf16_f32 v36, v8, v9
    v_cvt_pk_bf16_f32 v37, v10, v11
    v_exp_f32 v12, v12
    v_exp_f32 v13, v13
    v_exp_f32 v14, v14
    v_exp_f32 v15, v15
    v_cvt_pk_bf16_f32 v38, v12, v13
    v_cvt_pk_bf16_f32 v39, v14, v15
    s_waitcnt lgkmcnt(0)
    v_mfma_f32_32x32x16_bf16 v[0:15], v[88:91], v[72:75], 0
    v_exp_f32 v16, v16
    v_exp_f32 v17, v17
    v_exp_f32 v18, v18
    v_exp_f32 v19, v19
    v_cvt_pk_bf16_f32 v32, v16, v17
    v_cvt_pk_bf16_f32 v33, v18, v19
    v_mfma_f32_32x32x16_bf16 v[40:55], v[100:103], v[36:39], v[40:55]
    v_exp_f32 v20, v20
    v_exp_f32 v21, v21
    v_exp_f32 v22, v22
    v_exp_f32 v23, v23
    v_cvt_pk_bf16_f32 v34, v20, v21
    v_cvt_pk_bf16_f32 v35, v22, v23
    v_mfma_f32_32x32x8bf16_1k v[0:15], v[92:93], v[78:79], v[0:15]
    v_exp_f32 v24, v24
    v_exp_f32 v25, v25
    v_exp_f32 v26, v26
    v_exp_f32 v27, v27
    v_mfma_f32_32x32x16_bf16 v[56:71], v[96:99], v[32:35], v[56:71]
    ds_read_b128 v[96:99], v106 offset:1216
    v_cvt_pk_bf16_f32 v36, v24, v25
    v_cvt_pk_bf16_f32 v37, v26, v27
    v_exp_f32 v28, v28
    v_exp_f32 v29, v29
    v_exp_f32 v30, v30
    v_exp_f32 v31, v31
    v_cvt_pk_bf16_f32 v38, v28, v29
    v_cvt_pk_bf16_f32 v39, v30, v31
    s_cmp_lg_u32 s40, 1
    s_cbranch_scc1 L_norel_71
    v_mov_b32 v110, 163596
    v_mov_b32 v111, 1
    ds_add_u32 v110, v111
L_norel_71:
    s_waitcnt lgkmcnt(0)
    v_mfma_f32_32x32x16_bf16 v[16:31], v[88:91], v[80:83], 0
    ds_read_b128 v[88:91], v104 offset:4736
    v_exp_f32 v0, v0
    v_exp_f32 v1, v1
    v_exp_f32 v2, v2
    v_exp_f32 v3, v3
    v_cvt_pk_bf16_f32 v32, v0, v1
    v_cvt_pk_bf16_f32 v33, v2, v3
    v_mfma_f32_32x32x16_bf16 v[56:71], v[100:103], v[36:39], v[56:71]
    ds_read_b128 v[100:103], v106 offset:1824
    v_exp_f32 v4, v4
    v_exp_f32 v5, v5
    v_exp_f32 v6, v6
    v_exp_f32 v7, v7
    v_cvt_pk_bf16_f32 v34, v4, v5
    v_cvt_pk_bf16_f32 v35, v6, v7
    v_mfma_f32_32x32x8bf16_1k v[16:31], v[92:93], v[86:87], v[16:31]
    ds_read_b64 v[92:93], v105 offset:4736
    v_exp_f32 v8, v8
    v_exp_f32 v9, v9
    v_exp_f32 v10, v10
    v_exp_f32 v11, v11
    v_mfma_f32_32x32x16_bf16 v[40:55], v[96:99], v[32:35], v[40:55]
    v_cvt_pk_bf16_f32 v36, v8, v9
    v_cvt_pk_bf16_f32 v37, v10, v11
    v_exp_f32 v12, v12
    v_exp_f32 v13, v13
    v_exp_f32 v14, v14
    v_exp_f32 v15, v15
    v_cvt_pk_bf16_f32 v38, v12, v13
    v_cvt_pk_bf16_f32 v39, v14, v15
    s_waitcnt lgkmcnt(0)
    v_mfma_f32_32x32x16_bf16 v[0:15], v[88:91], v[72:75], 0
    v_exp_f32 v16, v16
    v_exp_f32 v17, v17
    v_exp_f32 v18, v18
    v_exp_f32 v19, v19
    v_cvt_pk_bf16_f32 v32, v16, v17
    v_cvt_pk_bf16_f32 v33, v18, v19
    v_mfma_f32_32x32x16_bf16 v[40:55], v[100:103], v[36:39], v[40:55]
    v_exp_f32 v20, v20
    v_exp_f32 v21, v21
    v_exp_f32 v22, v22
    v_exp_f32 v23, v23
    v_cvt_pk_bf16_f32 v34, v20, v21
    v_cvt_pk_bf16_f32 v35, v22, v23
    v_mfma_f32_32x32x8bf16_1k v[0:15], v[92:93], v[76:77], v[0:15]
    v_exp_f32 v24, v24
    v_exp_f32 v25, v25
    v_exp_f32 v26, v26
    v_exp_f32 v27, v27
    v_mfma_f32_32x32x16_bf16 v[56:71], v[96:99], v[32:35], v[56:71]
    ds_read_b128 v[96:99], v106 offset:4736
    v_cvt_pk_bf16_f32 v36, v24, v25
    v_cvt_pk_bf16_f32 v37, v26, v27
    v_exp_f32 v28, v28
    v_exp_f32 v29, v29
    v_exp_f32 v30, v30
    v_exp_f32 v31, v31
    v_cvt_pk_bf16_f32 v38, v28, v29
    v_cvt_pk_bf16_f32 v39, v30, v31
    s_waitcnt lgkmcnt(0)
    v_mfma_f32_32x32x16_bf16 v[16:31], v[88:91], v[80:83], 0
    ds_read_b128 v[88:91], v104 offset:5760
    v_exp_f32 v0, v0
    v_exp_f32 v1, v1
    v_exp_f32 v2, v2
    v_exp_f32 v3, v3
    v_cvt_pk_bf16_f32 v32, v0, v1
    v_cvt_pk_bf16_f32 v33, v2, v3
    v_mfma_f32_32x32x16_bf16 v[56:71], v[100:103], v[36:39], v[56:71]
    ds_read_b128 v[100:103], v106 offset:5344
    v_exp_f32 v4, v4
    v_exp_f32 v5, v5
    v_exp_f32 v6, v6
    v_exp_f32 v7, v7
    v_cvt_pk_bf16_f32 v34, v4, v5
    v_cvt_pk_bf16_f32 v35, v6, v7
    v_mfma_f32_32x32x8bf16_1k v[16:31], v[92:93], v[84:85], v[16:31]
    v_exp_f32 v8, v8
    v_exp_f32 v9, v9
    v_exp_f32 v10, v10
    v_exp_f32 v11, v11
    v_mfma_f32_32x32x16_bf16 v[40:55], v[96:99], v[32:35], v[40:55]
    v_cvt_pk_bf16_f32 v36, v8, v9
    v_cvt_pk_bf16_f32 v37, v10, v11
    v_exp_f32 v12, v12
    v_exp_f32 v13, v13
    v_exp_f32 v14, v14
    v_exp_f32 v15, v15
    v_cvt_pk_bf16_f32 v38, v12, v13
    v_cvt_pk_bf16_f32 v39, v14, v15
    s_waitcnt lgkmcnt(0)
    v_mfma_f32_32x32x16_bf16 v[0:15], v[88:91], v[72:75], 0
    v_exp_f32 v16, v16
    v_exp_f32 v17, v17
    v_exp_f32 v18, v18
    v_exp_f32 v19, v19
    v_cvt_pk_bf16_f32 v32, v16, v17
    v_cvt_pk_bf16_f32 v33, v18, v19
    v_mfma_f32_32x32x16_bf16 v[40:55], v[100:103], v[36:39], v[40:55]
    v_exp_f32 v20, v20
    v_exp_f32 v21, v21
    v_exp_f32 v22, v22
    v_exp_f32 v23, v23
    v_cvt_pk_bf16_f32 v34, v20, v21
    v_cvt_pk_bf16_f32 v35, v22, v23
    v_mfma_f32_32x32x8bf16_1k v[0:15], v[92:93], v[78:79], v[0:15]
    v_exp_f32 v24, v24
    v_exp_f32 v25, v25
    v_exp_f32 v26, v26
    v_exp_f32 v27, v27
    v_mfma_f32_32x32x16_bf16 v[56:71], v[96:99], v[32:35], v[56:71]
    ds_read_b128 v[96:99], v106 offset:5952
    v_cvt_pk_bf16_f32 v36, v24, v25
    v_cvt_pk_bf16_f32 v37, v26, v27
    v_exp_f32 v28, v28
    v_exp_f32 v29, v29
    v_exp_f32 v30, v30
    v_exp_f32 v31, v31
    v_cvt_pk_bf16_f32 v38, v28, v29
    v_cvt_pk_bf16_f32 v39, v30, v31
    s_waitcnt lgkmcnt(0)
    v_mfma_f32_32x32x16_bf16 v[16:31], v[88:91], v[80:83], 0
    ds_read_b128 v[88:91], v104 offset:9472
    v_exp_f32 v0, v0
    v_exp_f32 v1, v1
    v_exp_f32 v2, v2
    v_exp_f32 v3, v3
    v_cvt_pk_bf16_f32 v32, v0, v1
    v_cvt_pk_bf16_f32 v33, v2, v3
    v_mfma_f32_32x32x16_bf16 v[56:71], v[100:103], v[36:39], v[56:71]
    ds_read_b128 v[100:103], v106 offset:6560
    v_exp_f32 v4, v4
    v_exp_f32 v5, v5
    v_exp_f32 v6, v6
    v_exp_f32 v7, v7
    v_cvt_pk_bf16_f32 v34, v4, v5
    v_cvt_pk_bf16_f32 v35, v6, v7
    v_mfma_f32_32x32x8bf16_1k v[16:31], v[92:93], v[86:87], v[16:31]
    ds_read_b64 v[92:93], v105 offset:9472
    v_exp_f32 v8, v8
    v_exp_f32 v9, v9
    v_exp_f32 v10, v10
    v_exp_f32 v11, v11
    v_mfma_f32_32x32x16_bf16 v[40:55], v[96:99], v[32:35], v[40:55]
    v_cvt_pk_bf16_f32 v36, v8, v9
    v_cvt_pk_bf16_f32 v37, v10, v11
    v_exp_f32 v12, v12
    v_exp_f32 v13, v13
    v_exp_f32 v14, v14
    v_exp_f32 v15, v15
    v_cvt_pk_bf16_f32 v38, v12, v13
    v_cvt_pk_bf16_f32 v39, v14, v15
    s_waitcnt lgkmcnt(0)
    v_mfma_f32_32x32x16_bf16 v[0:15], v[88:91], v[72:75], 0
    v_exp_f32 v16, v16
    v_exp_f32 v17, v17
    v_exp_f32 v18, v18
    v_exp_f32 v19, v19
    v_cvt_pk_bf16_f32 v32, v16, v17
    v_cvt_pk_bf16_f32 v33, v18, v19
    v_mfma_f32_32x32x16_bf16 v[40:55], v[100:103], v[36:39], v[40:55]
    v_exp_f32 v20, v20
    v_exp_f32 v21, v21
    v_exp_f32 v22, v22
    v_exp_f32 v23, v23
    v_cvt_pk_bf16_f32 v34, v20, v21
    v_cvt_pk_bf16_f32 v35, v22, v23
    v_mfma_f32_32x32x8bf16_1k v[0:15], v[92:93], v[76:77], v[0:15]
    v_exp_f32 v24, v24
    v_exp_f32 v25, v25
    v_exp_f32 v26, v26
    v_exp_f32 v27, v27
    v_mfma_f32_32x32x16_bf16 v[56:71], v[96:99], v[32:35], v[56:71]
    ds_read_b128 v[96:99], v106 offset:9472
    v_cvt_pk_bf16_f32 v36, v24, v25
    v_cvt_pk_bf16_f32 v37, v26, v27
    v_exp_f32 v28, v28
    v_exp_f32 v29, v29
    v_exp_f32 v30, v30
    v_exp_f32 v31, v31
    v_cvt_pk_bf16_f32 v38, v28, v29
    v_cvt_pk_bf16_f32 v39, v30, v31
    s_waitcnt lgkmcnt(0)
    v_mfma_f32_32x32x16_bf16 v[16:31], v[88:91], v[80:83], 0
    ds_read_b128 v[88:91], v104 offset:10496
    v_exp_f32 v0, v0
    v_exp_f32 v1, v1
    v_exp_f32 v2, v2
    v_exp_f32 v3, v3
    v_cvt_pk_bf16_f32 v32, v0, v1
    v_cvt_pk_bf16_f32 v33, v2, v3
    v_mfma_f32_32x32x16_bf16 v[56:71], v[100:103], v[36:39], v[56:71]
    ds_read_b128 v[100:103], v106 offset:10080
    v_exp_f32 v4, v4
    v_exp_f32 v5, v5
    v_exp_f32 v6, v6
    v_exp_f32 v7, v7
    v_cvt_pk_bf16_f32 v34, v4, v5
    v_cvt_pk_bf16_f32 v35, v6, v7
    v_mfma_f32_32x32x8bf16_1k v[16:31], v[92:93], v[84:85], v[16:31]
    v_exp_f32 v8, v8
    v_exp_f32 v9, v9
    v_exp_f32 v10, v10
    v_exp_f32 v11, v11
    v_mfma_f32_32x32x16_bf16 v[40:55], v[96:99], v[32:35], v[40:55]
    v_cvt_pk_bf16_f32 v36, v8, v9
    v_cvt_pk_bf16_f32 v37, v10, v11
    v_exp_f32 v12, v12
    v_exp_f32 v13, v13
    v_exp_f32 v14, v14
    v_exp_f32 v15, v15
    v_cvt_pk_bf16_f32 v38, v12, v13
    v_cvt_pk_bf16_f32 v39, v14, v15
    s_waitcnt lgkmcnt(0)
    v_mfma_f32_32x32x16_bf16 v[0:15], v[88:91], v[72:75], 0
    v_exp_f32 v16, v16
    v_exp_f32 v17, v17
    v_exp_f32 v18, v18
    v_exp_f32 v19, v19
    v_cvt_pk_bf16_f32 v32, v16, v17
    v_cvt_pk_bf16_f32 v33, v18, v19
    v_mfma_f32_32x32x16_bf16 v[40:55], v[100:103], v[36:39], v[40:55]
    v_exp_f32 v20, v20
    v_exp_f32 v21, v21
    v_exp_f32 v22, v22
    v_exp_f32 v23, v23
    v_cvt_pk_bf16_f32 v34, v20, v21
    v_cvt_pk_bf16_f32 v35, v22, v23
    v_mfma_f32_32x32x8bf16_1k v[0:15], v[92:93], v[78:79], v[0:15]
    v_exp_f32 v24, v24
    v_exp_f32 v25, v25
    v_exp_f32 v26, v26
    v_exp_f32 v27, v27
    v_mfma_f32_32x32x16_bf16 v[56:71], v[96:99], v[32:35], v[56:71]
    ds_read_b128 v[96:99], v106 offset:10688
    v_cvt_pk_bf16_f32 v36, v24, v25
    v_cvt_pk_bf16_f32 v37, v26, v27
    v_exp_f32 v28, v28
    v_exp_f32 v29, v29
    v_exp_f32 v30, v30
    v_exp_f32 v31, v31
    v_cvt_pk_bf16_f32 v38, v28, v29
    v_cvt_pk_bf16_f32 v39, v30, v31
    s_cmp_lg_u32 s40, 0
    s_cbranch_scc1 L_norel_72
    v_mov_b32 v110, 163596
    v_mov_b32 v111, 1
    ds_add_u32 v110, v111
L_norel_72:
    s_waitcnt lgkmcnt(0)
    v_mfma_f32_32x32x16_bf16 v[16:31], v[88:91], v[80:83], 0
    ds_read_b128 v[88:91], v104 offset:14208
    v_exp_f32 v0, v0
    v_exp_f32 v1, v1
    v_exp_f32 v2, v2
    v_exp_f32 v3, v3
    v_cvt_pk_bf16_f32 v32, v0, v1
    v_cvt_pk_bf16_f32 v33, v2, v3
    v_mfma_f32_32x32x16_bf16 v[56:71], v[100:103], v[36:39], v[56:71]
    ds_read_b128 v[100:103], v106 offset:11296
    v_exp_f32 v4, v4
    v_exp_f32 v5, v5
    v_exp_f32 v6, v6
    v_exp_f32 v7, v7
    v_cvt_pk_bf16_f32 v34, v4, v5
    v_cvt_pk_bf16_f32 v35, v6, v7
    v_mfma_f32_32x32x8bf16_1k v[16:31], v[92:93], v[86:87], v[16:31]
    ds_read_b64 v[92:93], v105 offset:14208
    v_exp_f32 v8, v8
    v_exp_f32 v9, v9
    v_exp_f32 v10, v10
    v_exp_f32 v11, v11
    v_mfma_f32_32x32x16_bf16 v[40:55], v[96:99], v[32:35], v[40:55]
    v_cvt_pk_bf16_f32 v36, v8, v9
    v_cvt_pk_bf16_f32 v37, v10, v11
    v_exp_f32 v12, v12
    v_exp_f32 v13, v13
    v_exp_f32 v14, v14
    v_exp_f32 v15, v15
    v_cvt_pk_bf16_f32 v38, v12, v13
    v_cvt_pk_bf16_f32 v39, v14, v15
    s_waitcnt lgkmcnt(0)
    v_mfma_f32_32x32x16_bf16 v[0:15], v[88:91], v[72:75], 0
    v_exp_f32 v16, v16
    v_exp_f32 v17, v17
    v_exp_f32 v18, v18
    v_exp_f32 v19, v19
    v_cvt_pk_bf16_f32 v32, v16, v17
    v_cvt_pk_bf16_f32 v33, v18, v19
    v_mfma_f32_32x32x16_bf16 v[40:55], v[100:103], v[36:39], v[40:55]
    v_exp_f32 v20, v20
    v_exp_f32 v21, v21
    v_exp_f32 v22, v22
    v_exp_f32 v23, v23
    v_cvt_pk_bf16_f32 v34, v20, v21
    v_cvt_pk_bf16_f32 v35, v22, v23
    v_mfma_f32_32x32x8bf16_1k v[0:15], v[92:93], v[76:77], v[0:15]
    v_exp_f32 v24, v24
    v_exp_f32 v25, v25
    v_exp_f32 v26, v26
    v_exp_f32 v27, v27
    v_mfma_f32_32x32x16_bf16 v[56:71], v[96:99], v[32:35], v[56:71]
    ds_read_b128 v[96:99], v106 offset:14208
    v_cvt_pk_bf16_f32 v36, v24, v25
    v_cvt_pk_bf16_f32 v37, v26, v27
    v_exp_f32 v28, v28
    v_exp_f32 v29, v29
    v_exp_f32 v30, v30
    v_exp_f32 v31, v31
    v_cvt_pk_bf16_f32 v38, v28, v29
    v_cvt_pk_bf16_f32 v39, v30, v31
    s_waitcnt lgkmcnt(0)
    v_mfma_f32_32x32x16_bf16 v[16:31], v[88:91], v[80:83], 0
    ds_read_b128 v[88:91], v104 offset:15232
    v_exp_f32 v0, v0
    v_exp_f32 v1, v1
    v_exp_f32 v2, v2
    v_exp_f32 v3, v3
    v_cvt_pk_bf16_f32 v32, v0, v1
    v_cvt_pk_bf16_f32 v33, v2, v3
    v_mfma_f32_32x32x16_bf16 v[56:71], v[100:103], v[36:39], v[56:71]
    ds_read_b128 v[100:103], v106 offset:14816
    v_exp_f32 v4, v4
    v_exp_f32 v5, v5
    v_exp_f32 v6, v6
    v_exp_f32 v7, v7
    v_cvt_pk_bf16_f32 v34, v4, v5
    v_cvt_pk_bf16_f32 v35, v6, v7
    v_mfma_f32_32x32x8bf16_1k v[16:31], v[92:93], v[84:85], v[16:31]
    v_exp_f32 v8, v8
    v_exp_f32 v9, v9
    v_exp_f32 v10, v10
    v_exp_f32 v11, v11
    v_mfma_f32_32x32x16_bf16 v[40:55], v[96:99], v[32:35], v[40:55]
    v_cvt_pk_bf16_f32 v36, v8, v9
    v_cvt_pk_bf16_f32 v37, v10, v11
    v_exp_f32 v12, v12
    v_exp_f32 v13, v13
    v_exp_f32 v14, v14
    v_exp_f32 v15, v15
    v_cvt_pk_bf16_f32 v38, v12, v13
    v_cvt_pk_bf16_f32 v39, v14, v15
    s_waitcnt lgkmcnt(0)
    v_mfma_f32_32x32x16_bf16 v[0:15], v[88:91], v[72:75], 0
    v_exp_f32 v16, v16
    v_exp_f32 v17, v17
    v_exp_f32 v18, v18
    v_exp_f32 v19, v19
    v_cvt_pk_bf16_f32 v32, v16, v17
    v_cvt_pk_bf16_f32 v33, v18, v19
    v_mfma_f32_32x32x16_bf16 v[40:55], v[100:103], v[36:39], v[40:55]
    v_exp_f32 v20, v20
    v_exp_f32 v21, v21
    v_exp_f32 v22, v22
    v_exp_f32 v23, v23
    v_cvt_pk_bf16_f32 v34, v20, v21
    v_cvt_pk_bf16_f32 v35, v22, v23
    v_mfma_f32_32x32x8bf16_1k v[0:15], v[92:93], v[78:79], v[0:15]
    v_exp_f32 v24, v24
    v_exp_f32 v25, v25
    v_exp_f32 v26, v26
    v_exp_f32 v27, v27
    v_mfma_f32_32x32x16_bf16 v[56:71], v[96:99], v[32:35], v[56:71]
    ds_read_b128 v[96:99], v106 offset:15424
    v_cvt_pk_bf16_f32 v36, v24, v25
    v_cvt_pk_bf16_f32 v37, v26, v27
    v_exp_f32 v28, v28
    v_exp_f32 v29, v29
    v_exp_f32 v30, v30
    v_exp_f32 v31, v31
    v_cvt_pk_bf16_f32 v38, v28, v29
    v_cvt_pk_bf16_f32 v39, v30, v31
    s_waitcnt lgkmcnt(0)
    v_mfma_f32_32x32x16_bf16 v[16:31], v[88:91], v[80:83], 0
    v_add_u32 v104, 37888, v104
    ds_read_b128 v[88:91], v104 offset:0
    v_exp_f32 v0, v0
    v_exp_f32 v1, v1
    v_exp_f32 v2, v2
    v_exp_f32 v3, v3
    v_cvt_pk_bf16_f32 v32, v0, v1
    v_cvt_pk_bf16_f32 v33, v2, v3
    v_mfma_f32_32x32x16_bf16 v[56:71], v[100:103], v[36:39], v[56:71]
    ds_read_b128 v[100:103], v106 offset:16032
    v_exp_f32 v4, v4
    v_exp_f32 v5, v5
    v_exp_f32 v6, v6
    v_exp_f32 v7, v7
    v_cvt_pk_bf16_f32 v34, v4, v5
    v_cvt_pk_bf16_f32 v35, v6, v7
    v_mfma_f32_32x32x8bf16_1k v[16:31], v[92:93], v[86:87], v[16:31]
    v_add_u32 v105, 37888, v105
    ds_read_b64 v[92:93], v105 offset:0
    v_exp_f32 v8, v8
    v_exp_f32 v9, v9
    v_exp_f32 v10, v10
    v_exp_f32 v11, v11
    v_mfma_f32_32x32x16_bf16 v[40:55], v[96:99], v[32:35], v[40:55]
    v_cvt_pk_bf16_f32 v36, v8, v9
    v_cvt_pk_bf16_f32 v37, v10, v11
    v_exp_f32 v12, v12
    v_exp_f32 v13, v13
    v_exp_f32 v14, v14
    v_exp_f32 v15, v15
    v_cvt_pk_bf16_f32 v38, v12, v13
    v_cvt_pk_bf16_f32 v39, v14, v15
    s_waitcnt lgkmcnt(0)
    v_mfma_f32_32x32x16_bf16 v[0:15], v[88:91], v[72:75], 0
    v_exp_f32 v16, v16
    v_exp_f32 v17, v17
    v_exp_f32 v18, v18
    v_exp_f32 v19, v19
    v_cvt_pk_bf16_f32 v32, v16, v17
    v_cvt_pk_bf16_f32 v33, v18, v19
    v_mfma_f32_32x32x16_bf16 v[40:55], v[100:103], v[36:39], v[40:55]
    v_exp_f32 v20, v20
    v_exp_f32 v21, v21
    v_exp_f32 v22, v22
    v_exp_f32 v23, v23
    v_cvt_pk_bf16_f32 v34, v20, v21
    v_cvt_pk_bf16_f32 v35, v22, v23
    v_mfma_f32_32x32x8bf16_1k v[0:15], v[92:93], v[76:77], v[0:15]
    v_exp_f32 v24, v24
    v_exp_f32 v25, v25
    v_exp_f32 v26, v26
    v_exp_f32 v27, v27
    v_mfma_f32_32x32x16_bf16 v[56:71], v[96:99], v[32:35], v[56:71]
    v_add_u32 v106, 37888, v106
    ds_read_b128 v[96:99], v106 offset:0
    v_cvt_pk_bf16_f32 v36, v24, v25
    v_cvt_pk_bf16_f32 v37, v26, v27
    v_exp_f32 v28, v28
    v_exp_f32 v29, v29
    v_exp_f32 v30, v30
    v_exp_f32 v31, v31
    v_cvt_pk_bf16_f32 v38, v28, v29
    v_cvt_pk_bf16_f32 v39, v30, v31
    s_waitcnt lgkmcnt(0)
    v_mfma_f32_32x32x16_bf16 v[16:31], v[88:91], v[80:83], 0
    ds_read_b128 v[88:91], v104 offset:1024
    v_exp_f32 v0, v0
    v_exp_f32 v1, v1
    v_exp_f32 v2, v2
    v_exp_f32 v3, v3
    v_cvt_pk_bf16_f32 v32, v0, v1
    v_cvt_pk_bf16_f32 v33, v2, v3
    v_mfma_f32_32x32x16_bf16 v[56:71], v[100:103], v[36:39], v[56:71]
    ds_read_b128 v[100:103], v106 offset:608
    v_exp_f32 v4, v4
    v_exp_f32 v5, v5
    v_exp_f32 v6, v6
    v_exp_f32 v7, v7
    v_cvt_pk_bf16_f32 v34, v4, v5
    v_cvt_pk_bf16_f32 v35, v6, v7
    v_mfma_f32_32x32x8bf16_1k v[16:31], v[92:93], v[84:85], v[16:31]
    v_exp_f32 v8, v8
    v_exp_f32 v9, v9
    v_exp_f32 v10, v10
    v_exp_f32 v11, v11
    v_mfma_f32_32x32x16_bf16 v[40:55], v[96:99], v[32:35], v[40:55]
    v_cvt_pk_bf16_f32 v36, v8, v9
    v_cvt_pk_bf16_f32 v37, v10, v11
    v_exp_f32 v12, v12
    v_exp_f32 v13, v13
    v_exp_f32 v14, v14
    v_exp_f32 v15, v15
    v_cvt_pk_bf16_f32 v38, v12, v13
    v_cvt_pk_bf16_f32 v39, v14, v15
    s_waitcnt lgkmcnt(0)
    v_mfma_f32_32x32x16_bf16 v[0:15], v[88:91], v[72:75], 0
    v_exp_f32 v16, v16
    v_exp_f32 v17, v17
    v_exp_f32 v18, v18
    v_exp_f32 v19, v19
    v_cvt_pk_bf16_f32 v32, v16, v17
    v_cvt_pk_bf16_f32 v33, v18, v19
    v_mfma_f32_32x32x16_bf16 v[40:55], v[100:103], v[36:39], v[40:55]
    v_exp_f32 v20, v20
    v_exp_f32 v21, v21
    v_exp_f32 v22, v22
    v_exp_f32 v23, v23
    v_cvt_pk_bf16_f32 v34, v20, v21
    v_cvt_pk_bf16_f32 v35, v22, v23
    v_mfma_f32_32x32x8bf16_1k v[0:15], v[92:93], v[78:79], v[0:15]
    v_exp_f32 v24, v24
    v_exp_f32 v25, v25
    v_exp_f32 v26, v26
    v_exp_f32 v27, v27
    v_mfma_f32_32x32x16_bf16 v[56:71], v[96:99], v[32:35], v[56:71]
    ds_read_b128 v[96:99], v106 offset:1216
    v_cvt_pk_bf16_f32 v36, v24, v25
    v_cvt_pk_bf16_f32 v37, v26, v27
    v_exp_f32 v28, v28
    v_exp_f32 v29, v29
    v_exp_f32 v30, v30
    v_exp_f32 v31, v31
    v_cvt_pk_bf16_f32 v38, v28, v29
    v_cvt_pk_bf16_f32 v39, v30, v31
    s_waitcnt lgkmcnt(0)
    v_mfma_f32_32x32x16_bf16 v[16:31], v[88:91], v[80:83], 0
    ds_read_b128 v[88:91], v104 offset:4736
    v_exp_f32 v0, v0
    v_exp_f32 v1, v1
    v_exp_f32 v2, v2
    v_exp_f32 v3, v3
    v_cvt_pk_bf16_f32 v32, v0, v1
    v_cvt_pk_bf16_f32 v33, v2, v3
    v_mfma_f32_32x32x16_bf16 v[56:71], v[100:103], v[36:39], v[56:71]
    ds_read_b128 v[100:103], v106 offset:1824
    v_exp_f32 v4, v4
    v_exp_f32 v5, v5
    v_exp_f32 v6, v6
    v_exp_f32 v7, v7
    v_cvt_pk_bf16_f32 v34, v4, v5
    v_cvt_pk_bf16_f32 v35, v6, v7
    v_mfma_f32_32x32x8bf16_1k v[16:31], v[92:93], v[86:87], v[16:31]
    ds_read_b64 v[92:93], v105 offset:4736
    v_exp_f32 v8, v8
    v_exp_f32 v9, v9
    v_exp_f32 v10, v10
    v_exp_f32 v11, v11
    v_mfma_f32_32x32x16_bf16 v[40:55], v[96:99], v[32:35], v[40:55]
    v_cvt_pk_bf16_f32 v36, v8, v9
    v_cvt_pk_bf16_f32 v37, v10, v11
    v_exp_f32 v12, v12
    v_exp_f32 v13, v13
    v_exp_f32 v14, v14
    v_exp_f32 v15, v15
    v_cvt_pk_bf16_f32 v38, v12, v13
    v_cvt_pk_bf16_f32 v39, v14, v15
    s_waitcnt lgkmcnt(0)
    v_mfma_f32_32x32x16_bf16 v[0:15], v[88:91], v[72:75], 0
    v_exp_f32 v16, v16
    v_exp_f32 v17, v17
    v_exp_f32 v18, v18
    v_exp_f32 v19, v19
    v_cvt_pk_bf16_f32 v32, v16, v17
    v_cvt_pk_bf16_f32 v33, v18, v19
    v_mfma_f32_32x32x16_bf16 v[40:55], v[100:103], v[36:39], v[40:55]
    v_exp_f32 v20, v20
    v_exp_f32 v21, v21
    v_exp_f32 v22, v22
    v_exp_f32 v23, v23
    v_cvt_pk_bf16_f32 v34, v20, v21
    v_cvt_pk_bf16_f32 v35, v22, v23
    v_mfma_f32_32x32x8bf16_1k v[0:15], v[92:93], v[76:77], v[0:15]
    v_exp_f32 v24, v24
    v_exp_f32 v25, v25
    v_exp_f32 v26, v26
    v_exp_f32 v27, v27
    v_mfma_f32_32x32x16_bf16 v[56:71], v[96:99], v[32:35], v[56:71]
    ds_read_b128 v[96:99], v106 offset:4736
    v_cvt_pk_bf16_f32 v36, v24, v25
    v_cvt_pk_bf16_f32 v37, v26, v27
    v_exp_f32 v28, v28
    v_exp_f32 v29, v29
    v_exp_f32 v30, v30
    v_exp_f32 v31, v31
    v_cvt_pk_bf16_f32 v38, v28, v29
    v_cvt_pk_bf16_f32 v39, v30, v31
    s_waitcnt lgkmcnt(0)
    v_mfma_f32_32x32x16_bf16 v[16:31], v[88:91], v[80:83], 0
    ds_read_b128 v[88:91], v104 offset:5760
    v_exp_f32 v0, v0
    v_exp_f32 v1, v1
    v_exp_f32 v2, v2
    v_exp_f32 v3, v3
    v_cvt_pk_bf16_f32 v32, v0, v1
    v_cvt_pk_bf16_f32 v33, v2, v3
    v_mfma_f32_32x32x16_bf16 v[56:71], v[100:103], v[36:39], v[56:71]
    ds_read_b128 v[100:103], v106 offset:5344
    v_exp_f32 v4, v4
    v_exp_f32 v5, v5
    v_exp_f32 v6, v6
    v_exp_f32 v7, v7
    v_cvt_pk_bf16_f32 v34, v4, v5
    v_cvt_pk_bf16_f32 v35, v6, v7
    v_mfma_f32_32x32x8bf16_1k v[16:31], v[92:93], v[84:85], v[16:31]
    v_exp_f32 v8, v8
    v_exp_f32 v9, v9
    v_exp_f32 v10, v10
    v_exp_f32 v11, v11
    v_mfma_f32_32x32x16_bf16 v[40:55], v[96:99], v[32:35], v[40:55]
    v_cvt_pk_bf16_f32 v36, v8, v9
    v_cvt_pk_bf16_f32 v37, v10, v11
    v_exp_f32 v12, v12
    v_exp_f32 v13, v13
    v_exp_f32 v14, v14
    v_exp_f32 v15, v15
    v_cvt_pk_bf16_f32 v38, v12, v13
    v_cvt_pk_bf16_f32 v39, v14, v15
    s_waitcnt lgkmcnt(0)
    v_mfma_f32_32x32x16_bf16 v[0:15], v[88:91], v[72:75], 0
    v_exp_f32 v16, v16
    v_exp_f32 v17, v17
    v_exp_f32 v18, v18
    v_exp_f32 v19, v19
    v_cvt_pk_bf16_f32 v32, v16, v17
    v_cvt_pk_bf16_f32 v33, v18, v19
    v_mfma_f32_32x32x16_bf16 v[40:55], v[100:103], v[36:39], v[40:55]
    v_exp_f32 v20, v20
    v_exp_f32 v21, v21
    v_exp_f32 v22, v22
    v_exp_f32 v23, v23
    v_cvt_pk_bf16_f32 v34, v20, v21
    v_cvt_pk_bf16_f32 v35, v22, v23
    v_mfma_f32_32x32x8bf16_1k v[0:15], v[92:93], v[78:79], v[0:15]
    v_exp_f32 v24, v24
    v_exp_f32 v25, v25
    v_exp_f32 v26, v26
    v_exp_f32 v27, v27
    v_mfma_f32_32x32x16_bf16 v[56:71], v[96:99], v[32:35], v[56:71]
    ds_read_b128 v[96:99], v106 offset:5952
    v_cvt_pk_bf16_f32 v36, v24, v25
    v_cvt_pk_bf16_f32 v37, v26, v27
    v_exp_f32 v28, v28
    v_exp_f32 v29, v29
    v_exp_f32 v30, v30
    v_exp_f32 v31, v31
    v_cvt_pk_bf16_f32 v38, v28, v29
    v_cvt_pk_bf16_f32 v39, v30, v31
    s_waitcnt lgkmcnt(0)
    v_mfma_f32_32x32x16_bf16 v[16:31], v[88:91], v[80:83], 0
    ds_read_b128 v[88:91], v104 offset:9472
    v_exp_f32 v0, v0
    v_exp_f32 v1, v1
    v_exp_f32 v2, v2
    v_exp_f32 v3, v3
    v_cvt_pk_bf16_f32 v32, v0, v1
    v_cvt_pk_bf16_f32 v33, v2, v3
    v_mfma_f32_32x32x16_bf16 v[56:71], v[100:103], v[36:39], v[56:71]
    ds_read_b128 v[100:103], v106 offset:6560
    v_exp_f32 v4, v4
    v_exp_f32 v5, v5
    v_exp_f32 v6, v6
    v_exp_f32 v7, v7
    v_cvt_pk_bf16_f32 v34, v4, v5
    v_cvt_pk_bf16_f32 v35, v6, v7
    v_mfma_f32_32x32x8bf16_1k v[16:31], v[92:93], v[86:87], v[16:31]
    ds_read_b64 v[92:93], v105 offset:9472
    v_exp_f32 v8, v8
    v_exp_f32 v9, v9
    v_exp_f32 v10, v10
    v_exp_f32 v11, v11
    v_mfma_f32_32x32x16_bf16 v[40:55], v[96:99], v[32:35], v[40:55]
    v_cvt_pk_bf16_f32 v36, v8, v9
    v_cvt_pk_bf16_f32 v37, v10, v11
    v_exp_f32 v12, v12
    v_exp_f32 v13, v13
    v_exp_f32 v14, v14
    v_exp_f32 v15, v15
    v_cvt_pk_bf16_f32 v38, v12, v13
    v_cvt_pk_bf16_f32 v39, v14, v15
    s_waitcnt lgkmcnt(0)
    v_mfma_f32_32x32x16_bf16 v[0:15], v[88:91], v[72:75], 0
    v_exp_f32 v16, v16
    v_exp_f32 v17, v17
    v_exp_f32 v18, v18
    v_exp_f32 v19, v19
    v_cvt_pk_bf16_f32 v32, v16, v17
    v_cvt_pk_bf16_f32 v33, v18, v19
    v_mfma_f32_32x32x16_bf16 v[40:55], v[100:103], v[36:39], v[40:55]
    v_exp_f32 v20, v20
    v_exp_f32 v21, v21
    v_exp_f32 v22, v22
    v_exp_f32 v23, v23
    v_cvt_pk_bf16_f32 v34, v20, v21
    v_cvt_pk_bf16_f32 v35, v22, v23
    v_mfma_f32_32x32x8bf16_1k v[0:15], v[92:93], v[76:77], v[0:15]
    v_exp_f32 v24, v24
    v_exp_f32 v25, v25
    v_exp_f32 v26, v26
    v_exp_f32 v27, v27
    v_mfma_f32_32x32x16_bf16 v[56:71], v[96:99], v[32:35], v[56:71]
    ds_read_b128 v[96:99], v106 offset:9472
    v_cvt_pk_bf16_f32 v36, v24, v25
    v_cvt_pk_bf16_f32 v37, v26, v27
    v_exp_f32 v28, v28
    v_exp_f32 v29, v29
    v_exp_f32 v30, v30
    v_exp_f32 v31, v31
    v_cvt_pk_bf16_f32 v38, v28, v29
    v_cvt_pk_bf16_f32 v39, v30, v31
    s_waitcnt lgkmcnt(0)
    v_mfma_f32_32x32x16_bf16 v[16:31], v[88:91], v[80:83], 0
    ds_read_b128 v[88:91], v104 offset:10496
    v_exp_f32 v0, v0
    v_exp_f32 v1, v1
    v_exp_f32 v2, v2
    v_exp_f32 v3, v3
    v_cvt_pk_bf16_f32 v32, v0, v1
    v_cvt_pk_bf16_f32 v33, v2, v3
    v_mfma_f32_32x32x16_bf16 v[56:71], v[100:103], v[36:39], v[56:71]
    ds_read_b128 v[100:103], v106 offset:10080
    v_exp_f32 v4, v4
    v_exp_f32 v5, v5
    v_exp_f32 v6, v6
    v_exp_f32 v7, v7
    v_cvt_pk_bf16_f32 v34, v4, v5
    v_cvt_pk_bf16_f32 v35, v6, v7
    v_mfma_f32_32x32x8bf16_1k v[16:31], v[92:93], v[84:85], v[16:31]
    v_exp_f32 v8, v8
    v_exp_f32 v9, v9
    v_exp_f32 v10, v10
    v_exp_f32 v11, v11
    v_mfma_f32_32x32x16_bf16 v[40:55], v[96:99], v[32:35], v[40:55]
    v_cvt_pk_bf16_f32 v36, v8, v9
    v_cvt_pk_bf16_f32 v37, v10, v11
    v_exp_f32 v12, v12
    v_exp_f32 v13, v13
    v_exp_f32 v14, v14
    v_exp_f32 v15, v15
    v_cvt_pk_bf16_f32 v38, v12, v13
    v_cvt_pk_bf16_f32 v39, v14, v15
    s_waitcnt lgkmcnt(0)
    v_mfma_f32_32x32x16_bf16 v[0:15], v[88:91], v[72:75], 0
    v_exp_f32 v16, v16
    v_exp_f32 v17, v17
    v_exp_f32 v18, v18
    v_exp_f32 v19, v19
    v_cvt_pk_bf16_f32 v32, v16, v17
    v_cvt_pk_bf16_f32 v33, v18, v19
    v_mfma_f32_32x32x16_bf16 v[40:55], v[100:103], v[36:39], v[40:55]
    v_exp_f32 v20, v20
    v_exp_f32 v21, v21
    v_exp_f32 v22, v22
    v_exp_f32 v23, v23
    v_cvt_pk_bf16_f32 v34, v20, v21
    v_cvt_pk_bf16_f32 v35, v22, v23
    v_mfma_f32_32x32x8bf16_1k v[0:15], v[92:93], v[78:79], v[0:15]
    v_exp_f32 v24, v24
    v_exp_f32 v25, v25
    v_exp_f32 v26, v26
    v_exp_f32 v27, v27
    v_mfma_f32_32x32x16_bf16 v[56:71], v[96:99], v[32:35], v[56:71]
    ds_read_b128 v[96:99], v106 offset:10688
    v_cvt_pk_bf16_f32 v36, v24, v25
    v_cvt_pk_bf16_f32 v37, v26, v27
    v_exp_f32 v28, v28
    v_exp_f32 v29, v29
    v_exp_f32 v30, v30
    v_exp_f32 v31, v31
    v_cvt_pk_bf16_f32 v38, v28, v29
    v_cvt_pk_bf16_f32 v39, v30, v31
    s_waitcnt lgkmcnt(0)
    v_mfma_f32_32x32x16_bf16 v[16:31], v[88:91], v[80:83], 0
    ds_read_b128 v[88:91], v104 offset:14208
    v_exp_f32 v0, v0
    v_exp_f32 v1, v1
    v_exp_f32 v2, v2
    v_exp_f32 v3, v3
    v_cvt_pk_bf16_f32 v32, v0, v1
    v_cvt_pk_bf16_f32 v33, v2, v3
    v_mfma_f32_32x32x16_bf16 v[56:71], v[100:103], v[36:39], v[56:71]
    ds_read_b128 v[100:103], v106 offset:11296
    v_exp_f32 v4, v4
    v_exp_f32 v5, v5
    v_exp_f32 v6, v6
    v_exp_f32 v7, v7
    v_cvt_pk_bf16_f32 v34, v4, v5
    v_cvt_pk_bf16_f32 v35, v6, v7
    v_mfma_f32_32x32x8bf16_1k v[16:31], v[92:93], v[86:87], v[16:31]
    ds_read_b64 v[92:93], v105 offset:14208
    v_exp_f32 v8, v8
    v_exp_f32 v9, v9
    v_exp_f32 v10, v10
    v_exp_f32 v11, v11
    v_mfma_f32_32x32x16_bf16 v[40:55], v[96:99], v[32:35], v[40:55]
    v_cvt_pk_bf16_f32 v36, v8, v9
    v_cvt_pk_bf16_f32 v37, v10, v11
    v_exp_f32 v12, v12
    v_exp_f32 v13, v13
    v_exp_f32 v14, v14
    v_exp_f32 v15, v15
    v_cvt_pk_bf16_f32 v38, v12, v13
    v_cvt_pk_bf16_f32 v39, v14, v15
    s_waitcnt lgkmcnt(0)
    v_mfma_f32_32x32x16_bf16 v[0:15], v[88:91], v[72:75], 0
    v_exp_f32 v16, v16
    v_exp_f32 v17, v17
    v_exp_f32 v18, v18
    v_exp_f32 v19, v19
    v_cvt_pk_bf16_f32 v32, v16, v17
    v_cvt_pk_bf16_f32 v33, v18, v19
    v_mfma_f32_32x32x16_bf16 v[40:55], v[100:103], v[36:39], v[40:55]
    v_exp_f32 v20, v20
    v_exp_f32 v21, v21
    v_exp_f32 v22, v22
    v_exp_f32 v23, v23
    v_cvt_pk_bf16_f32 v34, v20, v21
    v_cvt_pk_bf16_f32 v35, v22, v23
    v_mfma_f32_32x32x8bf16_1k v[0:15], v[92:93], v[76:77], v[0:15]
    v_exp_f32 v24, v24
    v_exp_f32 v25, v25
    v_exp_f32 v26, v26
    v_exp_f32 v27, v27
    v_mfma_f32_32x32x16_bf16 v[56:71], v[96:99], v[32:35], v[56:71]
    ds_read_b128 v[96:99], v106 offset:14208
    v_cvt_pk_bf16_f32 v36, v24, v25
    v_cvt_pk_bf16_f32 v37, v26, v27
    v_exp_f32 v28, v28
    v_exp_f32 v29, v29
    v_exp_f32 v30, v30
    v_exp_f32 v31, v31
    v_cvt_pk_bf16_f32 v38, v28, v29
    v_cvt_pk_bf16_f32 v39, v30, v31
    s_waitcnt lgkmcnt(0)
    v_mfma_f32_32x32x16_bf16 v[16:31], v[88:91], v[80:83], 0
    ds_read_b128 v[88:91], v104 offset:15232
    v_exp_f32 v0, v0
    v_exp_f32 v1, v1
    v_exp_f32 v2, v2
    v_exp_f32 v3, v3
    v_cvt_pk_bf16_f32 v32, v0, v1
    v_cvt_pk_bf16_f32 v33, v2, v3
    v_mfma_f32_32x32x16_bf16 v[56:71], v[100:103], v[36:39], v[56:71]
    ds_read_b128 v[100:103], v106 offset:14816
    v_exp_f32 v4, v4
    v_exp_f32 v5, v5
    v_exp_f32 v6, v6
    v_exp_f32 v7, v7
    v_cvt_pk_bf16_f32 v34, v4, v5
    v_cvt_pk_bf16_f32 v35, v6, v7
    v_mfma_f32_32x32x8bf16_1k v[16:31], v[92:93], v[84:85], v[16:31]
    v_exp_f32 v8, v8
    v_exp_f32 v9, v9
    v_exp_f32 v10, v10
    v_exp_f32 v11, v11
    v_mfma_f32_32x32x16_bf16 v[40:55], v[96:99], v[32:35], v[40:55]
    v_cvt_pk_bf16_f32 v36, v8, v9
    v_cvt_pk_bf16_f32 v37, v10, v11
    v_exp_f32 v12, v12
    v_exp_f32 v13, v13
    v_exp_f32 v14, v14
    v_exp_f32 v15, v15
    v_cvt_pk_bf16_f32 v38, v12, v13
    v_cvt_pk_bf16_f32 v39, v14, v15
    s_waitcnt lgkmcnt(0)
    v_mfma_f32_32x32x16_bf16 v[0:15], v[88:91], v[72:75], 0
    v_exp_f32 v16, v16
    v_exp_f32 v17, v17
    v_exp_f32 v18, v18
    v_exp_f32 v19, v19
    v_cvt_pk_bf16_f32 v32, v16, v17
    v_cvt_pk_bf16_f32 v33, v18, v19
    v_mfma_f32_32x32x16_bf16 v[40:55], v[100:103], v[36:39], v[40:55]
    v_exp_f32 v20, v20
    v_exp_f32 v21, v21
    v_exp_f32 v22, v22
    v_exp_f32 v23, v23
    v_cvt_pk_bf16_f32 v34, v20, v21
    v_cvt_pk_bf16_f32 v35, v22, v23
    v_mfma_f32_32x32x8bf16_1k v[0:15], v[92:93], v[78:79], v[0:15]
    v_exp_f32 v24, v24
    v_exp_f32 v25, v25
    v_exp_f32 v26, v26
    v_exp_f32 v27, v27
    v_mfma_f32_32x32x16_bf16 v[56:71], v[96:99], v[32:35], v[56:71]
    ds_read_b128 v[96:99], v106 offset:15424
    v_cvt_pk_bf16_f32 v36, v24, v25
    v_cvt_pk_bf16_f32 v37, v26, v27
    v_exp_f32 v28, v28
    v_exp_f32 v29, v29
    v_exp_f32 v30, v30
    v_exp_f32 v31, v31
    v_cvt_pk_bf16_f32 v38, v28, v29
    v_cvt_pk_bf16_f32 v39, v30, v31
    s_waitcnt lgkmcnt(0)
    v_mfma_f32_32x32x16_bf16 v[16:31], v[88:91], v[80:83], 0
    v_exp_f32 v0, v0
    v_exp_f32 v1, v1
    v_exp_f32 v2, v2
    v_exp_f32 v3, v3
    v_cvt_pk_bf16_f32 v32, v0, v1
    v_cvt_pk_bf16_f32 v33, v2, v3
    v_mfma_f32_32x32x16_bf16 v[56:71], v[100:103], v[36:39], v[56:71]
    ds_read_b128 v[100:103], v106 offset:16032
    v_exp_f32 v4, v4
    v_exp_f32 v5, v5
    v_exp_f32 v6, v6
    v_exp_f32 v7, v7
    v_cvt_pk_bf16_f32 v34, v4, v5
    v_cvt_pk_bf16_f32 v35, v6, v7
    v_mfma_f32_32x32x8bf16_1k v[16:31], v[92:93], v[86:87], v[16:31]
    v_exp_f32 v8, v8
    v_exp_f32 v9, v9
    v_exp_f32 v10, v10
    v_exp_f32 v11, v11
    v_mfma_f32_32x32x16_bf16 v[40:55], v[96:99], v[32:35], v[40:55]
    v_cvt_pk_bf16_f32 v36, v8, v9
    v_cvt_pk_bf16_f32 v37, v10, v11
    v_exp_f32 v12, v12
    v_exp_f32 v13, v13
    v_exp_f32 v14, v14
    v_exp_f32 v15, v15
    v_cvt_pk_bf16_f32 v38, v12, v13
    v_cvt_pk_bf16_f32 v39, v14, v15
    s_waitcnt lgkmcnt(0)
    v_exp_f32 v16, v16
    v_exp_f32 v17, v17
    v_exp_f32 v18, v18
    v_exp_f32 v19, v19
    v_cvt_pk_bf16_f32 v32, v16, v17
    v_cvt_pk_bf16_f32 v33, v18, v19
    v_mfma_f32_32x32x16_bf16 v[40:55], v[100:103], v[36:39], v[40:55]
    v_exp_f32 v20, v20
    v_exp_f32 v21, v21
    v_exp_f32 v22, v22
    v_exp_f32 v23, v23
    v_cvt_pk_bf16_f32 v34, v20, v21
    v_cvt_pk_bf16_f32 v35, v22, v23
    v_exp_f32 v24, v24
    v_exp_f32 v25, v25
    v_exp_f32 v26, v26
    v_exp_f32 v27, v27
    v_mfma_f32_32x32x16_bf16 v[56:71], v[96:99], v[32:35], v[56:71]
    v_cvt_pk_bf16_f32 v36, v24, v25
    v_cvt_pk_bf16_f32 v37, v26, v27
    v_exp_f32 v28, v28
    v_exp_f32 v29, v29
    v_exp_f32 v30, v30
    v_exp_f32 v31, v31
    v_cvt_pk_bf16_f32 v38, v28, v29
    v_cvt_pk_bf16_f32 v39, v30, v31
    s_nop 1
    v_mfma_f32_32x32x16_bf16 v[56:71], v[100:103], v[36:39], v[56:71]
    s_branch L_attdone_70
L_fallback_69:
    buffer_load_dword v161, v161, s[52:55], 0 offen
    v_mov_b32 v93, 0
    v_mov_b32 v110, 0xff800000
    s_mov_b32 s36, 0
L_fb1a_73:
    s_lshr_b32 s37, s36, 1
    s_mul_i32 s37, s37, 4736
    s_and_b32 s38, s36, 1
    v_lshlrev_b32 v111, 4, v156
    v_add_u32 v111, s37, v111
    s_lshl_b32 s80, s38, 10
    v_add_u32 v111, s80, v111
    v_lshlrev_b32 v32, 3, v157
    s_lshl_b32 s80, s38, 2
    s_add_u32 s80, s80, s37
    s_add_u32 s80, s80, 2048
    v_add_u32 v32, s80, v32
    ds_read_b128 v[88:91], v111
    ds_read_b32 v92, v32
    s_waitcnt lgkmcnt(0)
    v_mfma_f32_32x32x16_bf16 v[0:15], v[88:91], v[72:75], 0
    v_mfma_f32_32x32x8bf16_1k v[0:15], v[92:93], v[76:77], v[0:15]
    s_nop 7
    s_nop 7
    v_max3_f32 v110, v0, v1, v110
    v_max3_f32 v110, v2, v3, v110
    v_max3_f32 v110, v4, v5, v110
    v_max3_f32 v110, v6, v7, v110
    v_max3_f32 v110, v8, v9, v110
    v_max3_f32 v110, v10, v11, v110
    v_max3_f32 v110, v12, v13, v110
    v_max3_f32 v110, v14, v15, v110
    s_add_u32 s36, s36, 1
    s_cmp_lt_u32 s36, 64
    s_cbranch_scc1 L_fb1a_73
    v_mov_b32 v111, v110
    s_nop 1
    v_permlane32_swap_b32 v110, v111
    v_max_f32 v110, v110, v111
    v_sub_f32 v110, 0, v110
    v_mov_b32 v112, v110
    v_mov_b32 v113, v110
    v_mov_b32 v114, v110
    v_mov_b32 v115, v110
    v_mov_b32 v116, v110
    v_mov_b32 v117, v110
    v_mov_b32 v118, v110
    v_mov_b32 v119, v110
    v_mov_b32 v120, v110
    v_mov_b32 v121, v110
    v_mov_b32 v122, v110
    v_mov_b32 v123, v110
    v_mov_b32 v124, v110
    v_mov_b32 v125, v110
    v_mov_b32 v126, v110
    v_mov_b32 v127, v110
    s_mov_b32 s36, 0
    v_mov_b32 v40, 0
    v_mov_b32 v41, 0
    v_mov_b32 v42, 0
    v_mov_b32 v43, 0
    v_mov_b32 v44, 0
    v_mov_b32 v45, 0
    v_mov_b32 v46, 0
    v_mov_b32 v47, 0
    v_mov_b32 v48, 0
    v_mov_b32 v49, 0
    v_mov_b32 v50, 0
    v_mov_b32 v51, 0
    v_mov_b32 v52, 0
    v_mov_b32 v53, 0
    v_mov_b32 v54, 0
    v_mov_b32 v55, 0
L_fb2a_74:
    s_lshr_b32 s37, s36, 3
    s_lshl_b32 s37, s37, 3
    s_lshr_b32 s38, s36, 1
    s_and_b32 s38, s38, 3
    s_add_u32 s37, s37, s38
    s_mul_i32 s37, s37, 4736
    s_and_b32 s38, s36, 1
    s_lshl_b32 s80, s38, 10
    s_add_u32 s80, s80, s37
    v_add_u32 v16, s80, v104
    s_lshl_b32 s80, s38, 2
    s_add_u32 s80, s80, s37
    v_add_u32 v17, s80, v105
    s_mul_i32 s80, s38, 1216
    s_add_u32 s80, s80, s37
    v_add_u32 v18, s80, v106
    ds_read_b128 v[88:91], v16
    ds_read_b32 v92, v17
    ds_read_b128 v[96:99], v18
    ds_read_b128 v[100:103], v18 offset:608
    s_waitcnt lgkmcnt(0)
    v_mfma_f32_32x32x16_bf16 v[0:15], v[88:91], v[72:75], v[112:127]
    v_mfma_f32_32x32x8bf16_1k v[0:15], v[92:93], v[76:77], v[0:15]
    s_nop 7
    s_nop 7
    v_exp_f32 v0, v0
    v_exp_f32 v1, v1
    v_exp_f32 v2, v2
    v_exp_f32 v3, v3
    v_exp_f32 v4, v4
    v_exp_f32 v5, v5
    v_exp_f32 v6, v6
    v_exp_f32 v7, v7
    v_exp_f32 v8, v8
    v_exp_f32 v9, v9
    v_exp_f32 v10, v10
    v_exp_f32 v11, v11
    v_exp_f32 v12, v12
    v_exp_f32 v13, v13
    v_exp_f32 v14, v14
    v_exp_f32 v15, v15
    s_nop 0
    v_cvt_pk_bf16_f32 v32, v0, v1
    v_cvt_pk_bf16_f32 v33, v2, v3
    v_cvt_pk_bf16_f32 v34, v4, v5
    v_cvt_pk_bf16_f32 v35, v6, v7
    v_cvt_pk_bf16_f32 v36, v8, v9
    v_cvt_pk_bf16_f32 v37, v10, v11
    v_cvt_pk_bf16_f32 v38, v12, v13
    v_cvt_pk_bf16_f32 v39, v14, v15
    s_nop 1
    v_mfma_f32_32x32x16_bf16 v[40:55], v[96:99], v[32:35], v[40:55]
    v_mfma_f32_32x32x16_bf16 v[40:55], v[100:103], v[36:39], v[40:55]
    s_add_u32 s36, s36, 1
    s_cmp_lt_u32 s36, 32
    s_cbranch_scc1 L_fb2a_74
    s_nop 7
    s_nop 7
    v_mov_b32 v110, 0xff800000
    s_mov_b32 s36, 0
L_fb1b_75:
    s_lshr_b32 s37, s36, 1
    s_mul_i32 s37, s37, 4736
    s_and_b32 s38, s36, 1
    v_lshlrev_b32 v111, 4, v156
    v_add_u32 v111, s37, v111
    s_lshl_b32 s80, s38, 10
    v_add_u32 v111, s80, v111
    v_lshlrev_b32 v32, 3, v157
    s_lshl_b32 s80, s38, 2
    s_add_u32 s80, s80, s37
    s_add_u32 s80, s80, 2048
    v_add_u32 v32, s80, v32
    ds_read_b128 v[88:91], v111
    ds_read_b32 v92, v32
    s_waitcnt lgkmcnt(0)
    v_mfma_f32_32x32x16_bf16 v[0:15], v[88:91], v[80:83], 0
    v_mfma_f32_32x32x8bf16_1k v[0:15], v[92:93], v[84:85], v[0:15]
    s_nop 7
    s_nop 7
    v_max3_f32 v110, v0, v1, v110
    v_max3_f32 v110, v2, v3, v110
    v_max3_f32 v110, v4, v5, v110
    v_max3_f32 v110, v6, v7, v110
    v_max3_f32 v110, v8, v9, v110
    v_max3_f32 v110, v10, v11, v110
    v_max3_f32 v110, v12, v13, v110
    v_max3_f32 v110, v14, v15, v110
    s_add_u32 s36, s36, 1
    s_cmp_lt_u32 s36, 64
    s_cbranch_scc1 L_fb1b_75
    v_mov_b32 v111, v110
    s_nop 1
    v_permlane32_swap_b32 v110, v111
    v_max_f32 v110, v110, v111
    v_sub_f32 v110, 0, v110
    v_mov_b32 v112, v110
    v_mov_b32 v113, v110
    v_mov_b32 v114, v110
    v_mov_b32 v115, v110
    v_mov_b32 v116, v110
    v_mov_b32 v117, v110
    v_mov_b32 v118, v110
    v_mov_b32 v119, v110
    v_mov_b32 v120, v110
    v_mov_b32 v121, v110
    v_mov_b32 v122, v110
    v_mov_b32 v123, v110
    v_mov_b32 v124, v110
    v_mov_b32 v125, v110
    v_mov_b32 v126, v110
    v_mov_b32 v127, v110
    s_mov_b32 s36, 0
    v_mov_b32 v56, 0
    v_mov_b32 v57, 0
    v_mov_b32 v58, 0
    v_mov_b32 v59, 0
    v_mov_b32 v60, 0
    v_mov_b32 v61, 0
    v_mov_b32 v62, 0
    v_mov_b32 v63, 0
    v_mov_b32 v64, 0
    v_mov_b32 v65, 0
    v_mov_b32 v66, 0
    v_mov_b32 v67, 0
    v_mov_b32 v68, 0
    v_mov_b32 v69, 0
    v_mov_b32 v70, 0
    v_mov_b32 v71, 0
L_fb2b_76:
    s_lshr_b32 s37, s36, 3
    s_lshl_b32 s37, s37, 3
    s_lshr_b32 s38, s36, 1
    s_and_b32 s38, s38, 3
    s_add_u32 s37, s37, s38
    s_mul_i32 s37, s37, 4736
    s_and_b32 s38, s36, 1
    s_lshl_b32 s80, s38, 10
    s_add_u32 s80, s80, s37
    v_add_u32 v16, s80, v104
    s_lshl_b32 s80, s38, 2
    s_add_u32 s80, s80, s37
    v_add_u32 v17, s80, v105
    s_mul_i32 s80, s38, 1216
    s_add_u32 s80, s80, s37
    v_add_u32 v18, s80, v106
    ds_read_b128 v[88:91], v16
    ds_read_b32 v92, v17
    ds_read_b128 v[96:99], v18
    ds_read_b128 v[100:103], v18 offset:608
    s_waitcnt lgkmcnt(0)
    v_mfma_f32_32x32x16_bf16 v[0:15], v[88:91], v[80:83], v[112:127]
    v_mfma_f32_32x32x8bf16_1k v[0:15], v[92:93], v[84:85], v[0:15]
    s_nop 7
    s_nop 7
    v_exp_f32 v0, v0
    v_exp_f32 v1, v1
    v_exp_f32 v2, v2
    v_exp_f32 v3, v3
    v_exp_f32 v4, v4
    v_exp_f32 v5, v5
    v_exp_f32 v6, v6
    v_exp_f32 v7, v7
    v_exp_f32 v8, v8
    v_exp_f32 v9, v9
    v_exp_f32 v10, v10
    v_exp_f32 v11, v11
    v_exp_f32 v12, v12
    v_exp_f32 v13, v13
    v_exp_f32 v14, v14
    v_exp_f32 v15, v15
    s_nop 0
    v_cvt_pk_bf16_f32 v32, v0, v1
    v_cvt_pk_bf16_f32 v33, v2, v3
    v_cvt_pk_bf16_f32 v34, v4, v5
    v_cvt_pk_bf16_f32 v35, v6, v7
    v_cvt_pk_bf16_f32 v36, v8, v9
    v_cvt_pk_bf16_f32 v37, v10, v11
    v_cvt_pk_bf16_f32 v38, v12, v13
    v_cvt_pk_bf16_f32 v39, v14, v15
    s_nop 1
    v_mfma_f32_32x32x16_bf16 v[56:71], v[96:99], v[32:35], v[56:71]
    v_mfma_f32_32x32x16_bf16 v[56:71], v[100:103], v[36:39], v[56:71]
    s_add_u32 s36, s36, 1
    s_cmp_lt_u32 s36, 32
    s_cbranch_scc1 L_fb2b_76
    s_nop 7
    s_nop 7
    v_mov_b32 v110, 163596
    v_mov_b32 v111, 1
    ds_add_u32 v110, v111
L_attdone_70:
    s_nop 7
    s_nop 3
    s_barrier
    s_cmp_eq_u32 s40, 0
    s_cbranch_scc0 L_sw_77
    ds_write_b128 v144, v[56:59] offset:0
    ds_write_b128 v144, v[60:63] offset:1024
    ds_write_b128 v144, v[64:67] offset:2048
    s_waitcnt lgkmcnt(0)
    s_barrier
    ds_read_b128 v[0:3], v145 offset:0
    ds_read_b128 v[4:7], v145 offset:1024
    ds_read_b128 v[8:11], v145 offset:2048
    s_waitcnt lgkmcnt(0)
    v_add_f32 v50, v50, v10
    v_add_f32 v40, v40, v0
    v_add_f32 v41, v41, v1
    v_add_f32 v42, v42, v2
    v_add_f32 v43, v43, v3
    v_add_f32 v44, v44, v4
    v_add_f32 v45, v45, v5
    v_add_f32 v46, v46, v6
    v_add_f32 v47, v47, v7
    v_add_f32 v48, v48, v8
    v_add_f32 v49, v49, v9
    v_mov_b32 v110, v50
    s_nop 1
    v_permlane32_swap_b32 v50, v110
    v_rcp_f32 v110, v50
    s_nop 0
    v_mul_f32 v40, v40, v110
    v_mul_f32 v41, v41, v110
    v_mul_f32 v42, v42, v110
    v_mul_f32 v43, v43, v110
    v_mul_f32 v44, v44, v110
    v_mul_f32 v45, v45, v110
    v_mul_f32 v46, v46, v110
    v_mul_f32 v47, v47, v110
    v_mul_f32 v48, v48, v110
    v_mul_f32 v49, v49, v110
    v_cvt_pk_bf16_f32 v32, v40, v41
    v_cvt_pk_bf16_f32 v33, v42, v43
    v_cvt_pk_bf16_f32 v34, v44, v45
    v_cvt_pk_bf16_f32 v35, v46, v47
    v_cvt_pk_bf16_f32 v36, v48, v49
    ds_write2_b32 v146, v32, v33 offset0:0 offset1:1
    ds_write2_b32 v146, v34, v35 offset0:2 offset1:3
    v_cmp_eq_u32 vcc, 0, v158
    s_nop 0
    s_and_saveexec_b64 s[76:77], vcc
    ds_write_b32 v146, v36 offset:32
    s_mov_b64 exec, s[76:77]
    s_branch L_swd_78
L_sw_77:
    ds_write_b128 v144, v[40:43] offset:0
    ds_write_b128 v144, v[44:47] offset:1024
    ds_write_b128 v144, v[48:51] offset:2048
    s_waitcnt lgkmcnt(0)
    s_barrier
    ds_read_b128 v[0:3], v145 offset:0
    ds_read_b128 v[4:7], v145 offset:1024
    ds_read_b128 v[8:11], v145 offset:2048
    s_waitcnt lgkmcnt(0)
    v_add_f32 v66, v66, v10
    v_add_f32 v56, v56, v0
    v_add_f32 v57, v57, v1
    v_add_f32 v58, v58, v2
    v_add_f32 v59, v59, v3
    v_add_f32 v60, v60, v4
    v_add_f32 v61, v61, v5
    v_add_f32 v62, v62, v6
    v_add_f32 v63, v63, v7
    v_add_f32 v64, v64, v8
    v_add_f32 v65, v65, v9
    v_mov_b32 v110, v66
    s_nop 1
    v_permlane32_swap_b32 v66, v110
    v_rcp_f32 v110, v66
    s_nop 0
    v_mul_f32 v56, v56, v110
    v_mul_f32 v57, v57, v110
    v_mul_f32 v58, v58, v110
    v_mul_f32 v59, v59, v110
    v_mul_f32 v60, v60, v110
    v_mul_f32 v61, v61, v110
    v_mul_f32 v62, v62, v110
    v_mul_f32 v63, v63, v110
    v_mul_f32 v64, v64, v110
    v_mul_f32 v65, v65, v110
    v_cvt_pk_bf16_f32 v32, v56, v57
    v_cvt_pk_bf16_f32 v33, v58, v59
    v_cvt_pk_bf16_f32 v34, v60, v61
    v_cvt_pk_bf16_f32 v35, v62, v63
    v_cvt_pk_bf16_f32 v36, v64, v65
    ds_write2_b32 v146, v32, v33 offset0:0 offset1:1
    ds_write2_b32 v146, v34, v35 offset0:2 offset1:3
    v_cmp_eq_u32 vcc, 0, v158
    s_nop 0
    s_and_saveexec_b64 s[76:77], vcc
    ds_write_b32 v146, v36 offset:32
    s_mov_b64 exec, s[76:77]
L_swd_78:
    s_waitcnt lgkmcnt(0)
    s_barrier
    ds_read_b128 v[0:3], v152
    s_waitcnt lgkmcnt(0)
    buffer_store_dwordx4 v[0:3], v153, s[52:55], s43 offen sc1
    s_waitcnt vmcnt(0)
    s_barrier
    s_cmp_lg_u32 s33, 0
    s_cbranch_scc1 L_nogrp_79
    s_lshl_b32 s36, s34, 10
    s_add_u32 s36, s36, 198656
    v_mov_b32 v110, s36
    v_mov_b32 v111, 1
    s_mov_b64 exec, 1
    buffer_atomic_add v111, v110, s[52:55], 0 offen sc1
    s_mov_b64 exec, -1
L_nogrp_79:
    s_lshl_b32 s36, s39, 4
    v_add_u32 v72, s36, v159
    v_lshlrev_b32 v72, 7, v72
    v_lshrrev_b32 v73, 1, v159
    v_xor_b32 v73, v73, v160
    v_lshl_add_u32 v150, v73, 4, v72
    v_xor_b32 v151, 64, v150
    v_add_u32 v150, 82944, v150
    v_add_u32 v151, 82944, v151
    v_bfe_u32 v72, v156, 2, 2
    v_lshlrev_b32 v72, 1, v72
    v_lshl_add_u32 v72, v160, 3, v72
    v_mul_u32_u24 v72, 144, v72
    v_and_b32 v73, 3, v156
    v_lshl_add_u32 v72, v73, 3, v72
    s_mul_i32 s36, s40, 96
    s_add_u32 s36, s36, 0
    v_add_u32 v148, s36, v72
    v_add_u32 v149, 41472, v148
    s_lshl_b32 s36, s39, 4
    v_add_u32 v80, s36, v159
    v_mul_u32_u24 v80, 144, v80
    v_lshl_add_u32 v80, v160, 3, v80
    s_mul_i32 s36, s40, 96
    s_add_u32 s36, s36, 0
    v_add_u32 v80, s36, v80
    v_subrev_u32 v152, 115712, v152
    v_mov_b32 v144, v80
    v_sub_f32 v145, 1.0, v161
    v_cvt_pk_bf16_f32 v145, v145, v145
    v_and_b32 v145, 0xffff0000, v145
    v_mov_b32 v72, 163616
    ds_read_b64 v[76:77], v72
    s_waitcnt lgkmcnt(0)
    v_readfirstlane_b32 s80, v76
    v_readfirstlane_b32 s81, v77
    s_cmp_eq_u32 s40, 0
    s_cbranch_scc0 L_p3f1_80
    ds_read_b64_tr_b16 v[24:25], v148 offset:0
    ds_read_b64_tr_b16 v[26:27], v148 offset:144
    ds_read_b64_tr_b16 v[28:29], v148 offset:32
    ds_read_b64_tr_b16 v[30:31], v148 offset:176
    ds_read_b64_tr_b16 v[32:33], v148 offset:64
    ds_read_b64_tr_b16 v[34:35], v148 offset:208
    ds_read_b64_tr_b16 v[36:37], v148 offset:4608
    ds_read_b64_tr_b16 v[38:39], v148 offset:4752
    ds_read_b64_tr_b16 v[40:41], v148 offset:4640
    ds_read_b64_tr_b16 v[42:43], v148 offset:4784
    ds_read_b64_tr_b16 v[44:45], v148 offset:4672
    ds_read_b64_tr_b16 v[46:47], v148 offset:4816
    ds_read_b64_tr_b16 v[48:49], v148 offset:9216
    ds_read_b64_tr_b16 v[50:51], v148 offset:9360
    ds_read_b64_tr_b16 v[52:53], v148 offset:9248
    ds_read_b64_tr_b16 v[54:55], v148 offset:9392
    ds_read_b64_tr_b16 v[56:57], v148 offset:9280
    ds_read_b64_tr_b16 v[58:59], v148 offset:9424
    ds_read_b64_tr_b16 v[60:61], v148 offset:13824
    ds_read_b64_tr_b16 v[62:63], v148 offset:13968
    ds_read_b64_tr_b16 v[64:65], v148 offset:13856
    ds_read_b64_tr_b16 v[66:67], v148 offset:14000
    ds_read_b64_tr_b16 v[68:69], v148 offset:13888
    ds_read_b64_tr_b16 v[70:71], v148 offset:14032
    ds_read_b64_tr_b16 v[72:73], v148 offset:18432
    ds_read_b64_tr_b16 v[74:75], v148 offset:18576
    ds_read_b64_tr_b16 v[76:77], v148 offset:18464
    ds_read_b64_tr_b16 v[78:79], v148 offset:18608
    ds_read_b64_tr_b16 v[80:81], v148 offset:18496
    ds_read_b64_tr_b16 v[82:83], v148 offset:18640
    ds_read_b64_tr_b16 v[84:85], v148 offset:23040
    ds_read_b64_tr_b16 v[86:87], v148 offset:23184
    ds_read_b64_tr_b16 v[88:89], v148 offset:23072
    ds_read_b64_tr_b16 v[90:91], v148 offset:23216
    ds_read_b64_tr_b16 v[92:93], v148 offset:23104
    ds_read_b64_tr_b16 v[94:95], v148 offset:23248
    ds_read_b64_tr_b16 v[96:97], v148 offset:27648
    ds_read_b64_tr_b16 v[98:99], v148 offset:27792
    ds_read_b64_tr_b16 v[100:101], v148 offset:27680
    ds_read_b64_tr_b16 v[102:103], v148 offset:27824
    ds_read_b64_tr_b16 v[104:105], v148 offset:27712
    ds_read_b64_tr_b16 v[106:107], v148 offset:27856
    ds_read_b64_tr_b16 v[108:109], v148 offset:32256
    ds_read_b64_tr_b16 v[110:111], v148 offset:32400
    ds_read_b64_tr_b16 v[112:113], v148 offset:32288
    ds_read_b64_tr_b16 v[114:115], v148 offset:32432
    ds_read_b64_tr_b16 v[116:117], v148 offset:32320
    ds_read_b64_tr_b16 v[118:119], v148 offset:32464
    ds_read_b64_tr_b16 v[120:121], v148 offset:36864
    ds_read_b64_tr_b16 v[122:123], v148 offset:37008
    ds_read_b64_tr_b16 v[124:125], v148 offset:36896
    ds_read_b64_tr_b16 v[126:127], v148 offset:37040
    ds_read_b64_tr_b16 v[128:129], v148 offset:36928
    ds_read_b64_tr_b16 v[130:131], v148 offset:37072
    ds_read_b64_tr_b16 v[132:133], v149 offset:0
    ds_read_b64_tr_b16 v[134:135], v149 offset:144
    ds_read_b64_tr_b16 v[136:137], v149 offset:32
    ds_read_b64_tr_b16 v[138:139], v149 offset:176
    ds_read_b64_tr_b16 v[140:141], v149 offset:64
    ds_read_b64_tr_b16 v[142:143], v149 offset:208
    s_barrier
    s_barrier
    ds_read_b128 v[12:15], v150 offset:0
    ds_read_b128 v[16:19], v151 offset:0
    ds_read_b128 v[20:23], v150 offset:8192
    s_waitcnt lgkmcnt(2)
    v_mfma_f32_16x16x32_bf16 v[0:3], v[24:27], v[12:15], 0
    v_mfma_f32_16x16x32_bf16 v[4:7], v[28:31], v[12:15], 0
    v_mfma_f32_16x16x32_bf16 v[8:11], v[32:35], v[12:15], 0
    ds_read_b128 v[12:15], v151 offset:8192
    ds_read_b64_tr_b16 v[24:25], v149 offset:4608
    ds_read_b64_tr_b16 v[26:27], v149 offset:4752
    ds_read_b64_tr_b16 v[28:29], v149 offset:4640
    ds_read_b64_tr_b16 v[30:31], v149 offset:4784
    ds_read_b64_tr_b16 v[32:33], v149 offset:4672
    ds_read_b64_tr_b16 v[34:35], v149 offset:4816
    s_waitcnt lgkmcnt(8)
    v_mfma_f32_16x16x32_bf16 v[0:3], v[36:39], v[16:19], v[0:3]
    v_mfma_f32_16x16x32_bf16 v[4:7], v[40:43], v[16:19], v[4:7]
    v_mfma_f32_16x16x32_bf16 v[8:11], v[44:47], v[16:19], v[8:11]
    ds_read_b64_tr_b16 v[36:37], v149 offset:9216
    ds_read_b64_tr_b16 v[38:39], v149 offset:9360
    ds_read_b64_tr_b16 v[40:41], v149 offset:9248
    ds_read_b64_tr_b16 v[42:43], v149 offset:9392
    ds_read_b64_tr_b16 v[44:45], v149 offset:9280
    ds_read_b64_tr_b16 v[46:47], v149 offset:9424
    s_waitcnt lgkmcnt(13)
    v_mfma_f32_16x16x32_bf16 v[0:3], v[48:51], v[20:23], v[0:3]
    v_mfma_f32_16x16x32_bf16 v[4:7], v[52:55], v[20:23], v[4:7]
    v_mfma_f32_16x16x32_bf16 v[8:11], v[56:59], v[20:23], v[8:11]
    ds_read_b64_tr_b16 v[48:49], v149 offset:13824
    ds_read_b64_tr_b16 v[50:51], v149 offset:13968
    ds_read_b64_tr_b16 v[52:53], v149 offset:13856
    ds_read_b64_tr_b16 v[54:55], v149 offset:14000
    ds_read_b64_tr_b16 v[56:57], v149 offset:13888
    ds_read_b64_tr_b16 v[58:59], v149 offset:14032
    s_waitcnt lgkmcnt(15)
    v_mfma_f32_16x16x32_bf16 v[0:3], v[60:63], v[12:15], v[0:3]
    v_mfma_f32_16x16x32_bf16 v[4:7], v[64:67], v[12:15], v[4:7]
    v_mfma_f32_16x16x32_bf16 v[8:11], v[68:71], v[12:15], v[8:11]
    s_barrier
    ds_read_b128 v[16:19], v150 offset:16384
    ds_read_b128 v[20:23], v151 offset:16384
    ds_read_b128 v[12:15], v150 offset:24576
    ds_read_b64_tr_b16 v[60:61], v149 offset:18432
    ds_read_b64_tr_b16 v[62:63], v149 offset:18576
    ds_read_b64_tr_b16 v[64:65], v149 offset:18464
    ds_read_b64_tr_b16 v[66:67], v149 offset:18608
    ds_read_b64_tr_b16 v[68:69], v149 offset:18496
    ds_read_b64_tr_b16 v[70:71], v149 offset:18640
    s_waitcnt lgkmcnt(8)
    v_mfma_f32_16x16x32_bf16 v[0:3], v[72:75], v[16:19], v[0:3]
    v_mfma_f32_16x16x32_bf16 v[4:7], v[76:79], v[16:19], v[4:7]
    v_mfma_f32_16x16x32_bf16 v[8:11], v[80:83], v[16:19], v[8:11]
    ds_read_b128 v[16:19], v151 offset:24576
    ds_read_b64_tr_b16 v[72:73], v149 offset:23040
    ds_read_b64_tr_b16 v[74:75], v149 offset:23184
    ds_read_b64_tr_b16 v[76:77], v149 offset:23072
    ds_read_b64_tr_b16 v[78:79], v149 offset:23216
    ds_read_b64_tr_b16 v[80:81], v149 offset:23104
    ds_read_b64_tr_b16 v[82:83], v149 offset:23248
    s_waitcnt lgkmcnt(14)
    v_mfma_f32_16x16x32_bf16 v[0:3], v[84:87], v[20:23], v[0:3]
    v_mfma_f32_16x16x32_bf16 v[4:7], v[88:91], v[20:23], v[4:7]
    v_mfma_f32_16x16x32_bf16 v[8:11], v[92:95], v[20:23], v[8:11]
    ds_read_b128 v[20:23], v150 offset:32768
    ds_read_b64_tr_b16 v[84:85], v149 offset:27648
    ds_read_b64_tr_b16 v[86:87], v149 offset:27792
    ds_read_b64_tr_b16 v[88:89], v149 offset:27680
    ds_read_b64_tr_b16 v[90:91], v149 offset:27824
    ds_read_b64_tr_b16 v[92:93], v149 offset:27712
    ds_read_b64_tr_b16 v[94:95], v149 offset:27856
    s_waitcnt lgkmcnt(15)
    v_mfma_f32_16x16x32_bf16 v[0:3], v[96:99], v[12:15], v[0:3]
    v_mfma_f32_16x16x32_bf16 v[4:7], v[100:103], v[12:15], v[4:7]
    v_mfma_f32_16x16x32_bf16 v[8:11], v[104:107], v[12:15], v[8:11]
    ds_read_b128 v[12:15], v151 offset:32768
    ds_read_b64_tr_b16 v[96:97], v149 offset:32256
    ds_read_b64_tr_b16 v[98:99], v149 offset:32400
    ds_read_b64_tr_b16 v[100:101], v149 offset:32288
    ds_read_b64_tr_b16 v[102:103], v149 offset:32432
    ds_read_b64_tr_b16 v[104:105], v149 offset:32320
    ds_read_b64_tr_b16 v[106:107], v149 offset:32464
    s_waitcnt lgkmcnt(15)
    v_mfma_f32_16x16x32_bf16 v[0:3], v[108:111], v[16:19], v[0:3]
    v_mfma_f32_16x16x32_bf16 v[4:7], v[112:115], v[16:19], v[4:7]
    v_mfma_f32_16x16x32_bf16 v[8:11], v[116:119], v[16:19], v[8:11]
    ds_read_b64_tr_b16 v[108:109], v149 offset:36864
    ds_read_b64_tr_b16 v[110:111], v149 offset:37008
    ds_read_b64_tr_b16 v[112:113], v149 offset:36896
    ds_read_b64_tr_b16 v[114:115], v149 offset:37040
    ds_read_b64_tr_b16 v[116:117], v149 offset:36928
    ds_read_b64_tr_b16 v[118:119], v149 offset:37072
    s_waitcnt lgkmcnt(15)
    v_mfma_f32_16x16x32_bf16 v[0:3], v[120:123], v[20:23], v[0:3]
    v_mfma_f32_16x16x32_bf16 v[4:7], v[124:127], v[20:23], v[4:7]
    v_mfma_f32_16x16x32_bf16 v[8:11], v[128:131], v[20:23], v[8:11]
    s_waitcnt lgkmcnt(12)
    v_mfma_f32_16x16x32_bf16 v[0:3], v[132:135], v[12:15], v[0:3]
    v_mfma_f32_16x16x32_bf16 v[4:7], v[136:139], v[12:15], v[4:7]
    v_mfma_f32_16x16x32_bf16 v[8:11], v[140:143], v[12:15], v[8:11]
    s_barrier
    ds_read_b128 v[16:19], v150 offset:40960
    ds_read_b128 v[20:23], v151 offset:40960
    ds_read_b128 v[12:15], v150 offset:49152
    s_waitcnt lgkmcnt(2)
    v_mfma_f32_16x16x32_bf16 v[0:3], v[24:27], v[16:19], v[0:3]
    v_mfma_f32_16x16x32_bf16 v[4:7], v[28:31], v[16:19], v[4:7]
    v_mfma_f32_16x16x32_bf16 v[8:11], v[32:35], v[16:19], v[8:11]
    ds_read_b128 v[16:19], v151 offset:49152
    s_waitcnt lgkmcnt(2)
    v_mfma_f32_16x16x32_bf16 v[0:3], v[36:39], v[20:23], v[0:3]
    v_mfma_f32_16x16x32_bf16 v[4:7], v[40:43], v[20:23], v[4:7]
    v_mfma_f32_16x16x32_bf16 v[8:11], v[44:47], v[20:23], v[8:11]
    ds_read_b128 v[20:23], v150 offset:57344
    s_waitcnt lgkmcnt(2)
    v_mfma_f32_16x16x32_bf16 v[0:3], v[48:51], v[12:15], v[0:3]
    v_mfma_f32_16x16x32_bf16 v[4:7], v[52:55], v[12:15], v[4:7]
    v_mfma_f32_16x16x32_bf16 v[8:11], v[56:59], v[12:15], v[8:11]
    ds_read_b128 v[12:15], v151 offset:57344
    s_waitcnt lgkmcnt(2)
    v_mfma_f32_16x16x32_bf16 v[0:3], v[60:63], v[16:19], v[0:3]
    v_mfma_f32_16x16x32_bf16 v[4:7], v[64:67], v[16:19], v[4:7]
    v_mfma_f32_16x16x32_bf16 v[8:11], v[68:71], v[16:19], v[8:11]
    v_add_u32 v150, 8192, v150
    v_add_u32 v151, 8192, v151
    ds_read_b128 v[16:19], v150 offset:57344
    s_waitcnt lgkmcnt(2)
    v_mfma_f32_16x16x32_bf16 v[0:3], v[72:75], v[20:23], v[0:3]
    v_mfma_f32_16x16x32_bf16 v[4:7], v[76:79], v[20:23], v[4:7]
    v_mfma_f32_16x16x32_bf16 v[8:11], v[80:83], v[20:23], v[8:11]
    ds_read_b128 v[20:23], v151 offset:57344
    s_waitcnt lgkmcnt(2)
    v_mfma_f32_16x16x32_bf16 v[0:3], v[84:87], v[12:15], v[0:3]
    v_mfma_f32_16x16x32_bf16 v[4:7], v[88:91], v[12:15], v[4:7]
    v_mfma_f32_16x16x32_bf16 v[8:11], v[92:95], v[12:15], v[8:11]
    s_waitcnt lgkmcnt(1)
    v_mfma_f32_16x16x32_bf16 v[0:3], v[96:99], v[16:19], v[0:3]
    v_mfma_f32_16x16x32_bf16 v[4:7], v[100:103], v[16:19], v[4:7]
    v_mfma_f32_16x16x32_bf16 v[8:11], v[104:107], v[16:19], v[8:11]
    s_waitcnt lgkmcnt(0)
    v_mfma_f32_16x16x32_bf16 v[0:3], v[108:111], v[20:23], v[0:3]
    v_mfma_f32_16x16x32_bf16 v[4:7], v[112:115], v[20:23], v[4:7]
    v_mfma_f32_16x16x32_bf16 v[8:11], v[116:119], v[20:23], v[8:11]
    s_nop 7
    v_lshlrev_b32 v16, 16, v162
    v_and_b32 v17, 0xffff0000, v162
    v_lshlrev_b32 v18, 16, v163
    v_and_b32 v19, 0xffff0000, v163
    v_lshlrev_b32 v20, 16, v164
    v_and_b32 v21, 0xffff0000, v164
    v_lshlrev_b32 v22, 16, v165
    v_and_b32 v23, 0xffff0000, v165
    v_lshlrev_b32 v24, 16, v166
    v_and_b32 v25, 0xffff0000, v166
    v_lshlrev_b32 v26, 16, v167
    v_and_b32 v27, 0xffff0000, v167
    s_lshl_b32 s36, s39, 4
    s_add_u32 s36, s36, s41
    s_sub_u32 s84, s80, s36
    s_cmp_lt_u32 s84, 16
    s_cbranch_scc0 L_nort_82
    s_mul_i32 s37, s40, 192
    s_add_u32 s37, s37, 160896
    v_lshlrev_b32 v72, 4, v160
    v_add_u32 v72, s37, v72
    ds_read_b128 v[40:43], v72 offset:0
    ds_read_b128 v[44:47], v72 offset:64
    ds_read_b128 v[48:51], v72 offset:128
    v_cmp_eq_u32 vcc, s84, v159
    s_waitcnt lgkmcnt(0)
    v_add_f32 v40, v16, v40
    v_cvt_pk_bf16_f32 v40, v40, v40
    v_and_b32 v40, 0xffff0000, v40
    v_cndmask_b32 v16, v16, v40, vcc
    v_add_f32 v41, v17, v41
    v_cvt_pk_bf16_f32 v41, v41, v41
    v_and_b32 v41, 0xffff0000, v41
    v_cndmask_b32 v17, v17, v41, vcc
    v_add_f32 v42, v18, v42
    v_cvt_pk_bf16_f32 v42, v42, v42
    v_and_b32 v42, 0xffff0000, v42
    v_cndmask_b32 v18, v18, v42, vcc
    v_add_f32 v43, v19, v43
    v_cvt_pk_bf16_f32 v43, v43, v43
    v_and_b32 v43, 0xffff0000, v43
    v_cndmask_b32 v19, v19, v43, vcc
    v_add_f32 v44, v20, v44
    v_cvt_pk_bf16_f32 v44, v44, v44
    v_and_b32 v44, 0xffff0000, v44
    v_cndmask_b32 v20, v20, v44, vcc
    v_add_f32 v45, v21, v45
    v_cvt_pk_bf16_f32 v45, v45, v45
    v_and_b32 v45, 0xffff0000, v45
    v_cndmask_b32 v21, v21, v45, vcc
    v_add_f32 v46, v22, v46
    v_cvt_pk_bf16_f32 v46, v46, v46
    v_and_b32 v46, 0xffff0000, v46
    v_cndmask_b32 v22, v22, v46, vcc
    v_add_f32 v47, v23, v47
    v_cvt_pk_bf16_f32 v47, v47, v47
    v_and_b32 v47, 0xffff0000, v47
    v_cndmask_b32 v23, v23, v47, vcc
    v_add_f32 v48, v24, v48
    v_cvt_pk_bf16_f32 v48, v48, v48
    v_and_b32 v48, 0xffff0000, v48
    v_cndmask_b32 v24, v24, v48, vcc
    v_add_f32 v49, v25, v49
    v_cvt_pk_bf16_f32 v49, v49, v49
    v_and_b32 v49, 0xffff0000, v49
    v_cndmask_b32 v25, v25, v49, vcc
    v_add_f32 v50, v26, v50
    v_cvt_pk_bf16_f32 v50, v50, v50
    v_and_b32 v50, 0xffff0000, v50
    v_cndmask_b32 v26, v26, v50, vcc
    v_add_f32 v51, v27, v51
    v_cvt_pk_bf16_f32 v51, v51, v51
    v_and_b32 v51, 0xffff0000, v51
    v_cndmask_b32 v27, v27, v51, vcc
L_nort_82:
    s_lshl_b32 s36, s39, 4
    s_add_u32 s36, s36, s41
    s_sub_u32 s84, s81, s36
    s_cmp_lt_u32 s84, 16
    s_cbranch_scc0 L_nort_83
    s_mul_i32 s37, s40, 192
    s_add_u32 s37, s37, 161184
    v_lshlrev_b32 v72, 4, v160
    v_add_u32 v72, s37, v72
    ds_read_b128 v[40:43], v72 offset:0
    ds_read_b128 v[44:47], v72 offset:64
    ds_read_b128 v[48:51], v72 offset:128
    v_cmp_eq_u32 vcc, s84, v159
    s_waitcnt lgkmcnt(0)
    v_add_f32 v40, v16, v40
    v_cvt_pk_bf16_f32 v40, v40, v40
    v_and_b32 v40, 0xffff0000, v40
    v_cndmask_b32 v16, v16, v40, vcc
    v_add_f32 v41, v17, v41
    v_cvt_pk_bf16_f32 v41, v41, v41
    v_and_b32 v41, 0xffff0000, v41
    v_cndmask_b32 v17, v17, v41, vcc
    v_add_f32 v42, v18, v42
    v_cvt_pk_bf16_f32 v42, v42, v42
    v_and_b32 v42, 0xffff0000, v42
    v_cndmask_b32 v18, v18, v42, vcc
    v_add_f32 v43, v19, v43
    v_cvt_pk_bf16_f32 v43, v43, v43
    v_and_b32 v43, 0xffff0000, v43
    v_cndmask_b32 v19, v19, v43, vcc
    v_add_f32 v44, v20, v44
    v_cvt_pk_bf16_f32 v44, v44, v44
    v_and_b32 v44, 0xffff0000, v44
    v_cndmask_b32 v20, v20, v44, vcc
    v_add_f32 v45, v21, v45
    v_cvt_pk_bf16_f32 v45, v45, v45
    v_and_b32 v45, 0xffff0000, v45
    v_cndmask_b32 v21, v21, v45, vcc
    v_add_f32 v46, v22, v46
    v_cvt_pk_bf16_f32 v46, v46, v46
    v_and_b32 v46, 0xffff0000, v46
    v_cndmask_b32 v22, v22, v46, vcc
    v_add_f32 v47, v23, v47
    v_cvt_pk_bf16_f32 v47, v47, v47
    v_and_b32 v47, 0xffff0000, v47
    v_cndmask_b32 v23, v23, v47, vcc
    v_add_f32 v48, v24, v48
    v_cvt_pk_bf16_f32 v48, v48, v48
    v_and_b32 v48, 0xffff0000, v48
    v_cndmask_b32 v24, v24, v48, vcc
    v_add_f32 v49, v25, v49
    v_cvt_pk_bf16_f32 v49, v49, v49
    v_and_b32 v49, 0xffff0000, v49
    v_cndmask_b32 v25, v25, v49, vcc
    v_add_f32 v50, v26, v50
    v_cvt_pk_bf16_f32 v50, v50, v50
    v_and_b32 v50, 0xffff0000, v50
    v_cndmask_b32 v26, v26, v50, vcc
    v_add_f32 v51, v27, v51
    v_cvt_pk_bf16_f32 v51, v51, v51
    v_and_b32 v51, 0xffff0000, v51
    v_cndmask_b32 v27, v27, v51, vcc
L_nort_83:
    v_mul_f32 v16, v145, v16
    v_fma_f32 v16, v161, v0, v16
    v_mul_f32 v17, v145, v17
    v_fma_f32 v17, v161, v1, v17
    v_mul_f32 v18, v145, v18
    v_fma_f32 v18, v161, v2, v18
    v_mul_f32 v19, v145, v19
    v_fma_f32 v19, v161, v3, v19
    v_cvt_pk_bf16_f32 v72, v16, v17
    v_cvt_pk_bf16_f32 v73, v18, v19
    ds_write_b64 v144, v[72:73] offset:0
    v_mul_f32 v20, v145, v20
    v_fma_f32 v20, v161, v4, v20
    v_mul_f32 v21, v145, v21
    v_fma_f32 v21, v161, v5, v21
    v_mul_f32 v22, v145, v22
    v_fma_f32 v22, v161, v6, v22
    v_mul_f32 v23, v145, v23
    v_fma_f32 v23, v161, v7, v23
    v_cvt_pk_bf16_f32 v74, v20, v21
    v_cvt_pk_bf16_f32 v75, v22, v23
    ds_write_b64 v144, v[74:75] offset:32
    v_mul_f32 v24, v145, v24
    v_fma_f32 v24, v161, v8, v24
    v_mul_f32 v25, v145, v25
    v_fma_f32 v25, v161, v9, v25
    v_mul_f32 v26, v145, v26
    v_fma_f32 v26, v161, v10, v26
    v_mul_f32 v27, v145, v27
    v_fma_f32 v27, v161, v11, v27
    v_cvt_pk_bf16_f32 v76, v24, v25
    v_cvt_pk_bf16_f32 v77, v26, v27
    ds_write_b64 v144, v[76:77] offset:64
    s_waitcnt lgkmcnt(0)
    s_branch L_p3e_81
L_p3f1_80:
    ds_read_b64_tr_b16 v[24:25], v148 offset:0
    ds_read_b64_tr_b16 v[26:27], v148 offset:144
    ds_read_b64_tr_b16 v[28:29], v148 offset:32
    ds_read_b64_tr_b16 v[30:31], v148 offset:176
    ds_read_b64_tr_b16 v[32:33], v148 offset:4608
    ds_read_b64_tr_b16 v[34:35], v148 offset:4752
    ds_read_b64_tr_b16 v[36:37], v148 offset:4640
    ds_read_b64_tr_b16 v[38:39], v148 offset:4784
    ds_read_b64_tr_b16 v[40:41], v148 offset:9216
    ds_read_b64_tr_b16 v[42:43], v148 offset:9360
    ds_read_b64_tr_b16 v[44:45], v148 offset:9248
    ds_read_b64_tr_b16 v[46:47], v148 offset:9392
    ds_read_b64_tr_b16 v[48:49], v148 offset:13824
    ds_read_b64_tr_b16 v[50:51], v148 offset:13968
    ds_read_b64_tr_b16 v[52:53], v148 offset:13856
    ds_read_b64_tr_b16 v[54:55], v148 offset:14000
    ds_read_b64_tr_b16 v[56:57], v148 offset:18432
    ds_read_b64_tr_b16 v[58:59], v148 offset:18576
    ds_read_b64_tr_b16 v[60:61], v148 offset:18464
    ds_read_b64_tr_b16 v[62:63], v148 offset:18608
    ds_read_b64_tr_b16 v[64:65], v148 offset:23040
    ds_read_b64_tr_b16 v[66:67], v148 offset:23184
    ds_read_b64_tr_b16 v[68:69], v148 offset:23072
    ds_read_b64_tr_b16 v[70:71], v148 offset:23216
    ds_read_b64_tr_b16 v[72:73], v148 offset:27648
    ds_read_b64_tr_b16 v[74:75], v148 offset:27792
    ds_read_b64_tr_b16 v[76:77], v148 offset:27680
    ds_read_b64_tr_b16 v[78:79], v148 offset:27824
    ds_read_b64_tr_b16 v[80:81], v148 offset:32256
    ds_read_b64_tr_b16 v[82:83], v148 offset:32400
    ds_read_b64_tr_b16 v[84:85], v148 offset:32288
    ds_read_b64_tr_b16 v[86:87], v148 offset:32432
    ds_read_b64_tr_b16 v[88:89], v148 offset:36864
    ds_read_b64_tr_b16 v[90:91], v148 offset:37008
    ds_read_b64_tr_b16 v[92:93], v148 offset:36896
    ds_read_b64_tr_b16 v[94:95], v148 offset:37040
    ds_read_b64_tr_b16 v[96:97], v149 offset:0
    ds_read_b64_tr_b16 v[98:99], v149 offset:144
    ds_read_b64_tr_b16 v[100:101], v149 offset:32
    ds_read_b64_tr_b16 v[102:103], v149 offset:176
    ds_read_b64_tr_b16 v[104:105], v149 offset:4608
    ds_read_b64_tr_b16 v[106:107], v149 offset:4752
    ds_read_b64_tr_b16 v[108:109], v149 offset:4640
    ds_read_b64_tr_b16 v[110:111], v149 offset:4784
    ds_read_b64_tr_b16 v[112:113], v149 offset:9216
    ds_read_b64_tr_b16 v[114:115], v149 offset:9360
    ds_read_b64_tr_b16 v[116:117], v149 offset:9248
    ds_read_b64_tr_b16 v[118:119], v149 offset:9392
    ds_read_b64_tr_b16 v[120:121], v149 offset:13824
    ds_read_b64_tr_b16 v[122:123], v149 offset:13968
    ds_read_b64_tr_b16 v[124:125], v149 offset:13856
    ds_read_b64_tr_b16 v[126:127], v149 offset:14000
    ds_read_b64_tr_b16 v[128:129], v149 offset:18432
    ds_read_b64_tr_b16 v[130:131], v149 offset:18576
    ds_read_b64_tr_b16 v[132:133], v149 offset:18464
    ds_read_b64_tr_b16 v[134:135], v149 offset:18608
    ds_read_b64_tr_b16 v[136:137], v149 offset:23040
    ds_read_b64_tr_b16 v[138:139], v149 offset:23184
    ds_read_b64_tr_b16 v[140:141], v149 offset:23072
    ds_read_b64_tr_b16 v[142:143], v149 offset:23216
    s_barrier
    s_barrier
    ds_read_b128 v[12:15], v150 offset:0
    ds_read_b128 v[16:19], v151 offset:0
    ds_read_b128 v[20:23], v150 offset:8192
    s_waitcnt lgkmcnt(2)
    v_mfma_f32_16x16x32_bf16 v[0:3], v[24:27], v[12:15], 0
    v_mfma_f32_16x16x32_bf16 v[4:7], v[28:31], v[12:15], 0
    ds_read_b128 v[12:15], v151 offset:8192
    ds_read_b64_tr_b16 v[24:25], v149 offset:27648
    ds_read_b64_tr_b16 v[26:27], v149 offset:27792
    ds_read_b64_tr_b16 v[28:29], v149 offset:27680
    ds_read_b64_tr_b16 v[30:31], v149 offset:27824
    s_waitcnt lgkmcnt(6)
    v_mfma_f32_16x16x32_bf16 v[0:3], v[32:35], v[16:19], v[0:3]
    v_mfma_f32_16x16x32_bf16 v[4:7], v[36:39], v[16:19], v[4:7]
    ds_read_b64_tr_b16 v[32:33], v149 offset:32256
    ds_read_b64_tr_b16 v[34:35], v149 offset:32400
    ds_read_b64_tr_b16 v[36:37], v149 offset:32288
    ds_read_b64_tr_b16 v[38:39], v149 offset:32432
    s_waitcnt lgkmcnt(9)
    v_mfma_f32_16x16x32_bf16 v[0:3], v[40:43], v[20:23], v[0:3]
    v_mfma_f32_16x16x32_bf16 v[4:7], v[44:47], v[20:23], v[4:7]
    ds_read_b64_tr_b16 v[40:41], v149 offset:36864
    ds_read_b64_tr_b16 v[42:43], v149 offset:37008
    ds_read_b64_tr_b16 v[44:45], v149 offset:36896
    ds_read_b64_tr_b16 v[46:47], v149 offset:37040
    s_waitcnt lgkmcnt(12)
    v_mfma_f32_16x16x32_bf16 v[0:3], v[48:51], v[12:15], v[0:3]
    v_mfma_f32_16x16x32_bf16 v[4:7], v[52:55], v[12:15], v[4:7]
    s_barrier
    ds_read_b128 v[16:19], v150 offset:16384
    ds_read_b128 v[20:23], v151 offset:16384
    ds_read_b128 v[12:15], v150 offset:24576
    s_waitcnt lgkmcnt(2)
    v_mfma_f32_16x16x32_bf16 v[0:3], v[56:59], v[16:19], v[0:3]
    v_mfma_f32_16x16x32_bf16 v[4:7], v[60:63], v[16:19], v[4:7]
    ds_read_b128 v[16:19], v151 offset:24576
    s_waitcnt lgkmcnt(2)
    v_mfma_f32_16x16x32_bf16 v[0:3], v[64:67], v[20:23], v[0:3]
    v_mfma_f32_16x16x32_bf16 v[4:7], v[68:71], v[20:23], v[4:7]
    ds_read_b128 v[20:23], v150 offset:32768
    s_waitcnt lgkmcnt(2)
    v_mfma_f32_16x16x32_bf16 v[0:3], v[72:75], v[12:15], v[0:3]
    v_mfma_f32_16x16x32_bf16 v[4:7], v[76:79], v[12:15], v[4:7]
    ds_read_b128 v[12:15], v151 offset:32768
    s_waitcnt lgkmcnt(2)
    v_mfma_f32_16x16x32_bf16 v[0:3], v[80:83], v[16:19], v[0:3]
    v_mfma_f32_16x16x32_bf16 v[4:7], v[84:87], v[16:19], v[4:7]
    s_waitcnt lgkmcnt(1)
    v_mfma_f32_16x16x32_bf16 v[0:3], v[88:91], v[20:23], v[0:3]
    v_mfma_f32_16x16x32_bf16 v[4:7], v[92:95], v[20:23], v[4:7]
    s_waitcnt lgkmcnt(0)
    v_mfma_f32_16x16x32_bf16 v[0:3], v[96:99], v[12:15], v[0:3]
    v_mfma_f32_16x16x32_bf16 v[4:7], v[100:103], v[12:15], v[4:7]
    s_barrier
    ds_read_b128 v[16:19], v150 offset:40960
    ds_read_b128 v[20:23], v151 offset:40960
    ds_read_b128 v[12:15], v150 offset:49152
    s_waitcnt lgkmcnt(2)
    v_mfma_f32_16x16x32_bf16 v[0:3], v[104:107], v[16:19], v[0:3]
    v_mfma_f32_16x16x32_bf16 v[4:7], v[108:111], v[16:19], v[4:7]
    ds_read_b128 v[16:19], v151 offset:49152
    s_waitcnt lgkmcnt(2)
    v_mfma_f32_16x16x32_bf16 v[0:3], v[112:115], v[20:23], v[0:3]
    v_mfma_f32_16x16x32_bf16 v[4:7], v[116:119], v[20:23], v[4:7]
    ds_read_b128 v[20:23], v150 offset:57344
    s_waitcnt lgkmcnt(2)
    v_mfma_f32_16x16x32_bf16 v[0:3], v[120:123], v[12:15], v[0:3]
    v_mfma_f32_16x16x32_bf16 v[4:7], v[124:127], v[12:15], v[4:7]
    ds_read_b128 v[12:15], v151 offset:57344
    s_waitcnt lgkmcnt(2)
    v_mfma_f32_16x16x32_bf16 v[0:3], v[128:131], v[16:19], v[0:3]
    v_mfma_f32_16x16x32_bf16 v[4:7], v[132:135], v[16:19], v[4:7]
    v_add_u32 v150, 8192, v150
    v_add_u32 v151, 8192, v151
    ds_read_b128 v[16:19], v150 offset:57344
    s_waitcnt lgkmcnt(2)
    v_mfma_f32_16x16x32_bf16 v[0:3], v[136:139], v[20:23], v[0:3]
    v_mfma_f32_16x16x32_bf16 v[4:7], v[140:143], v[20:23], v[4:7]
    ds_read_b128 v[20:23], v151 offset:57344
    s_waitcnt lgkmcnt(2)
    v_mfma_f32_16x16x32_bf16 v[0:3], v[24:27], v[12:15], v[0:3]
    v_mfma_f32_16x16x32_bf16 v[4:7], v[28:31], v[12:15], v[4:7]
    s_waitcnt lgkmcnt(1)
    v_mfma_f32_16x16x32_bf16 v[0:3], v[32:35], v[16:19], v[0:3]
    v_mfma_f32_16x16x32_bf16 v[4:7], v[36:39], v[16:19], v[4:7]
    s_waitcnt lgkmcnt(0)
    v_mfma_f32_16x16x32_bf16 v[0:3], v[40:43], v[20:23], v[0:3]
    v_mfma_f32_16x16x32_bf16 v[4:7], v[44:47], v[20:23], v[4:7]
    s_nop 7
    v_lshlrev_b32 v16, 16, v162
    v_and_b32 v17, 0xffff0000, v162
    v_lshlrev_b32 v18, 16, v163
    v_and_b32 v19, 0xffff0000, v163
    v_lshlrev_b32 v20, 16, v164
    v_and_b32 v21, 0xffff0000, v164
    v_lshlrev_b32 v22, 16, v165
    v_and_b32 v23, 0xffff0000, v165
    s_lshl_b32 s36, s39, 4
    s_add_u32 s36, s36, s41
    s_sub_u32 s84, s80, s36
    s_cmp_lt_u32 s84, 16
    s_cbranch_scc0 L_nort_84
    s_mul_i32 s37, s40, 192
    s_add_u32 s37, s37, 160896
    v_lshlrev_b32 v72, 4, v160
    v_add_u32 v72, s37, v72
    ds_read_b128 v[40:43], v72 offset:0
    ds_read_b128 v[44:47], v72 offset:64
    v_cmp_eq_u32 vcc, s84, v159
    s_waitcnt lgkmcnt(0)
    v_add_f32 v40, v16, v40
    v_cvt_pk_bf16_f32 v40, v40, v40
    v_and_b32 v40, 0xffff0000, v40
    v_cndmask_b32 v16, v16, v40, vcc
    v_add_f32 v41, v17, v41
    v_cvt_pk_bf16_f32 v41, v41, v41
    v_and_b32 v41, 0xffff0000, v41
    v_cndmask_b32 v17, v17, v41, vcc
    v_add_f32 v42, v18, v42
    v_cvt_pk_bf16_f32 v42, v42, v42
    v_and_b32 v42, 0xffff0000, v42
    v_cndmask_b32 v18, v18, v42, vcc
    v_add_f32 v43, v19, v43
    v_cvt_pk_bf16_f32 v43, v43, v43
    v_and_b32 v43, 0xffff0000, v43
    v_cndmask_b32 v19, v19, v43, vcc
    v_add_f32 v44, v20, v44
    v_cvt_pk_bf16_f32 v44, v44, v44
    v_and_b32 v44, 0xffff0000, v44
    v_cndmask_b32 v20, v20, v44, vcc
    v_add_f32 v45, v21, v45
    v_cvt_pk_bf16_f32 v45, v45, v45
    v_and_b32 v45, 0xffff0000, v45
    v_cndmask_b32 v21, v21, v45, vcc
    v_add_f32 v46, v22, v46
    v_cvt_pk_bf16_f32 v46, v46, v46
    v_and_b32 v46, 0xffff0000, v46
    v_cndmask_b32 v22, v22, v46, vcc
    v_add_f32 v47, v23, v47
    v_cvt_pk_bf16_f32 v47, v47, v47
    v_and_b32 v47, 0xffff0000, v47
    v_cndmask_b32 v23, v23, v47, vcc
L_nort_84:
    s_lshl_b32 s36, s39, 4
    s_add_u32 s36, s36, s41
    s_sub_u32 s84, s81, s36
    s_cmp_lt_u32 s84, 16
    s_cbranch_scc0 L_nort_85
    s_mul_i32 s37, s40, 192
    s_add_u32 s37, s37, 161184
    v_lshlrev_b32 v72, 4, v160
    v_add_u32 v72, s37, v72
    ds_read_b128 v[40:43], v72 offset:0
    ds_read_b128 v[44:47], v72 offset:64
    v_cmp_eq_u32 vcc, s84, v159
    s_waitcnt lgkmcnt(0)
    v_add_f32 v40, v16, v40
    v_cvt_pk_bf16_f32 v40, v40, v40
    v_and_b32 v40, 0xffff0000, v40
    v_cndmask_b32 v16, v16, v40, vcc
    v_add_f32 v41, v17, v41
    v_cvt_pk_bf16_f32 v41, v41, v41
    v_and_b32 v41, 0xffff0000, v41
    v_cndmask_b32 v17, v17, v41, vcc
    v_add_f32 v42, v18, v42
    v_cvt_pk_bf16_f32 v42, v42, v42
    v_and_b32 v42, 0xffff0000, v42
    v_cndmask_b32 v18, v18, v42, vcc
    v_add_f32 v43, v19, v43
    v_cvt_pk_bf16_f32 v43, v43, v43
    v_and_b32 v43, 0xffff0000, v43
    v_cndmask_b32 v19, v19, v43, vcc
    v_add_f32 v44, v20, v44
    v_cvt_pk_bf16_f32 v44, v44, v44
    v_and_b32 v44, 0xffff0000, v44
    v_cndmask_b32 v20, v20, v44, vcc
    v_add_f32 v45, v21, v45
    v_cvt_pk_bf16_f32 v45, v45, v45
    v_and_b32 v45, 0xffff0000, v45
    v_cndmask_b32 v21, v21, v45, vcc
    v_add_f32 v46, v22, v46
    v_cvt_pk_bf16_f32 v46, v46, v46
    v_and_b32 v46, 0xffff0000, v46
    v_cndmask_b32 v22, v22, v46, vcc
    v_add_f32 v47, v23, v47
    v_cvt_pk_bf16_f32 v47, v47, v47
    v_and_b32 v47, 0xffff0000, v47
    v_cndmask_b32 v23, v23, v47, vcc
L_nort_85:
    v_mul_f32 v16, v145, v16
    v_fma_f32 v16, v161, v0, v16
    v_mul_f32 v17, v145, v17
    v_fma_f32 v17, v161, v1, v17
    v_mul_f32 v18, v145, v18
    v_fma_f32 v18, v161, v2, v18
    v_mul_f32 v19, v145, v19
    v_fma_f32 v19, v161, v3, v19
    v_cvt_pk_bf16_f32 v72, v16, v17
    v_cvt_pk_bf16_f32 v73, v18, v19
    ds_write_b64 v144, v[72:73] offset:0
    v_mul_f32 v20, v145, v20
    v_fma_f32 v20, v161, v4, v20
    v_mul_f32 v21, v145, v21
    v_fma_f32 v21, v161, v5, v21
    v_mul_f32 v22, v145, v22
    v_fma_f32 v22, v161, v6, v22
    v_mul_f32 v23, v145, v23
    v_fma_f32 v23, v161, v7, v23
    v_cvt_pk_bf16_f32 v74, v20, v21
    v_cvt_pk_bf16_f32 v75, v22, v23
    v_cmp_gt_u32 vcc, 2, v160
    s_nop 0
    s_and_saveexec_b64 s[76:77], vcc
    ds_write_b64 v144, v[74:75] offset:32
    s_mov_b64 exec, s[76:77]
    s_waitcnt lgkmcnt(0)
L_p3e_81:
    s_barrier
    ds_read_b128 v[0:3], v152
    s_waitcnt lgkmcnt(0)
    buffer_store_dwordx4 v[0:3], v153, s[64:67], s42 offen
    s_endpgm
L_helper_1:
    s_setprio 3
    s_sub_u32 s39, s33, 8
    v_and_b32 v0, 63, v0
    v_lshrrev_b32 v8, 3, v0
    v_mul_u32_u24 v8, 1152, v8
    v_and_b32 v9, 7, v0
    v_lshrrev_b32 v10, 4, v0
    v_xor_b32 v9, v9, v10
    v_lshl_add_u32 v1, v9, 4, v8
    v_xor_b32 v2, 64, v1
    s_lshl_b32 s36, s39, 7
    s_add_u32 s36, s36, 0
    v_add_u32 v8, s36, v0
    v_mul_u32_u24 v9, 7282, v8
    v_lshrrev_b32 v9, 16, v9
    v_mul_u32_u24 v10, 9, v9
    v_sub_u32 v10, v8, v10
    v_and_b32 v11, 0x38, v9
    v_and_b32 v12, 1, v9
    v_lshl_add_u32 v11, v12, 2, v11
    v_bfe_u32 v12, v9, 1, 2
    v_add_u32 v11, v11, v12
    v_mul_u32_u24 v11, 1152, v11
    v_lshl_add_u32 v3, v10, 4, v11
    s_lshl_b32 s36, s39, 7
    s_add_u32 s36, s36, 64
    v_add_u32 v8, s36, v0
    v_mul_u32_u24 v9, 7282, v8
    v_lshrrev_b32 v9, 16, v9
    v_mul_u32_u24 v10, 9, v9
    v_sub_u32 v10, v8, v10
    v_and_b32 v11, 0x38, v9
    v_and_b32 v12, 1, v9
    v_lshl_add_u32 v11, v12, 2, v11
    v_bfe_u32 v12, v9, 1, 2
    v_add_u32 v11, v11, v12
    v_mul_u32_u24 v11, 1152, v11
    v_lshl_add_u32 v4, v10, 4, v11
    v_add_u32 v8, 512, v0
    v_mul_u32_u24 v9, 7282, v8
    v_lshrrev_b32 v9, 16, v9
    v_mul_u32_u24 v10, 9, v9
    v_sub_u32 v10, v8, v10
    v_and_b32 v11, 0x38, v9
    v_and_b32 v12, 1, v9
    v_lshl_add_u32 v11, v12, 2, v11
    v_bfe_u32 v12, v9, 1, 2
    v_add_u32 v11, v11, v12
    v_mul_u32_u24 v11, 1152, v11
    v_lshl_add_u32 v5, v10, 4, v11
    v_lshlrev_b32 v6, 4, v0
    s_mul_i32 s38, s41, 1152
    s_mul_i32 s84, s39, 18432
    s_add_u32 s84, s84, s38
    s_lshl_b32 s85, s39, 11
    s_add_u32 s85, s85, 0
    s_mov_b32 s86, s35
    s_lshl_b32 s36, s86, 7
    s_add_u32 s36, s36, s84
    s_lshl_b32 s37, s86, 13
    s_add_u32 s37, s37, s85
    s_mov_b32 m0, s37
    s_nop 0
    buffer_load_dwordx4 v1, s[44:47], s36 offen lds
    s_add_u32 s36, s36, 9216
    s_add_u32 m0, s37, 1024
    s_nop 0
    buffer_load_dwordx4 v2, s[44:47], s36 offen lds
    s_add_u32 s86, s86, 1
    s_cmp_eq_u32 s86, 9
    s_cselect_b32 s86, 0, s86
    s_lshl_b32 s36, s86, 7
    s_add_u32 s36, s36, s84
    s_lshl_b32 s37, s86, 13
    s_add_u32 s37, s37, s85
    s_mov_b32 m0, s37
    s_nop 0
    buffer_load_dwordx4 v1, s[44:47], s36 offen lds
    s_add_u32 s36, s36, 9216
    s_add_u32 m0, s37, 1024
    s_nop 0
    buffer_load_dwordx4 v2, s[44:47], s36 offen lds
    s_add_u32 s86, s86, 1
    s_cmp_eq_u32 s86, 9
    s_cselect_b32 s86, 0, s86
    s_lshl_b32 s36, s86, 7
    s_add_u32 s36, s36, s84
    s_lshl_b32 s37, s86, 13
    s_add_u32 s37, s37, s85
    s_mov_b32 m0, s37
    s_nop 0
    buffer_load_dwordx4 v1, s[44:47], s36 offen lds
    s_add_u32 s36, s36, 9216
    s_add_u32 m0, s37, 1024
    s_nop 0
    buffer_load_dwordx4 v2, s[44:47], s36 offen lds
    s_add_u32 s86, s86, 1
    s_cmp_eq_u32 s86, 9
    s_cselect_b32 s86, 0, s86
    s_lshl_b32 s36, s86, 7
    s_add_u32 s36, s36, s84
    s_lshl_b32 s37, s86, 13
    s_add_u32 s37, s37, s85
    s_mov_b32 m0, s37
    s_nop 0
    buffer_load_dwordx4 v1, s[44:47], s36 offen lds
    s_add_u32 s36, s36, 9216
    s_add_u32 m0, s37, 1024
    s_nop 0
    buffer_load_dwordx4 v2, s[44:47], s36 offen lds
    s_add_u32 s86, s86, 1
    s_cmp_eq_u32 s86, 9
    s_cselect_b32 s86, 0, s86
    s_lshl_b32 s36, s86, 7
    s_add_u32 s36, s36, s84
    s_lshl_b32 s37, s86, 13
    s_add_u32 s37, s37, s85
    s_mov_b32 m0, s37
    s_nop 0
    buffer_load_dwordx4 v1, s[44:47], s36 offen lds
    s_add_u32 s36, s36, 9216
    s_add_u32 m0, s37, 1024
    s_nop 0
    buffer_load_dwordx4 v2, s[44:47], s36 offen lds
    s_add_u32 s86, s86, 1
    s_cmp_eq_u32 s86, 9
    s_cselect_b32 s86, 0, s86
    s_lshl_b32 s36, s86, 7
    s_add_u32 s36, s36, s84
    s_lshl_b32 s37, s86, 13
    s_add_u32 s37, s37, s85
    s_mov_b32 m0, s37
    s_nop 0
    buffer_load_dwordx4 v1, s[44:47], s36 offen lds
    s_add_u32 s36, s36, 9216
    s_add_u32 m0, s37, 1024
    s_nop 0
    buffer_load_dwordx4 v2, s[44:47], s36 offen lds
    s_add_u32 s86, s86, 1
    s_cmp_eq_u32 s86, 9
    s_cselect_b32 s86, 0, s86
    s_lshl_b32 s36, s86, 7
    s_add_u32 s36, s36, s84
    s_lshl_b32 s37, s86, 13
    s_add_u32 s37, s37, s85
    s_mov_b32 m0, s37
    s_nop 0
    buffer_load_dwordx4 v1, s[44:47], s36 offen lds
    s_add_u32 s36, s36, 9216
    s_add_u32 m0, s37, 1024
    s_nop 0
    buffer_load_dwordx4 v2, s[44:47], s36 offen lds
    s_add_u32 s86, s86, 1
    s_cmp_eq_u32 s86, 9
    s_cselect_b32 s86, 0, s86
    s_lshl_b32 s36, s86, 7
    s_add_u32 s36, s36, s84
    s_lshl_b32 s37, s86, 13
    s_add_u32 s37, s37, s85
    s_mov_b32 m0, s37
    s_nop 0
    buffer_load_dwordx4 v1, s[44:47], s36 offen lds
    s_add_u32 s36, s36, 9216
    s_add_u32 m0, s37, 1024
    s_nop 0
    buffer_load_dwordx4 v2, s[44:47], s36 offen lds
    s_add_u32 s86, s86, 1
    s_cmp_eq_u32 s86, 9
    s_cselect_b32 s86, 0, s86
    s_lshl_b32 s36, s86, 7
    s_add_u32 s36, s36, s84
    s_lshl_b32 s37, s86, 13
    s_add_u32 s37, s37, s85
    s_mov_b32 m0, s37
    s_nop 0
    buffer_load_dwordx4 v1, s[44:47], s36 offen lds
    s_add_u32 s36, s36, 9216
    s_add_u32 m0, s37, 1024
    s_nop 0
    buffer_load_dwordx4 v2, s[44:47], s36 offen lds
    s_cmp_eq_u32 s39, 3
    s_cbranch_scc1 L_h3_86
    s_cmp_lt_u32 s35, 3
    s_cbranch_scc1 L_hduty_87
    s_mul_i32 s36, s35, 144
    s_add_u32 s36, s36, 0
    s_lshl_b32 s37, s39, 11
    s_add_u32 m0, s37, 73728
    s_nop 0
    buffer_load_dwordx4 v3, s[48:51], s36 offen lds
    s_lshl_b32 s37, s39, 11
    s_add_u32 m0, s37, 74752
    s_nop 0
    buffer_load_dwordx4 v4, s[48:51], s36 offen lds
    s_mul_i32 s36, s35, 144
    s_add_u32 s36, s36, 73728
    s_lshl_b32 s37, s39, 11
    s_add_u32 m0, s37, 82944
    s_nop 0
    buffer_load_dwordx4 v3, s[48:51], s36 offen lds
    s_lshl_b32 s37, s39, 11
    s_add_u32 m0, s37, 83968
    s_nop 0
    buffer_load_dwordx4 v4, s[48:51], s36 offen lds
    s_mul_i32 s36, s35, 144
    s_add_u32 s36, s36, 147456
    s_lshl_b32 s37, s39, 11
    s_add_u32 m0, s37, 92160
    s_nop 0
    buffer_load_dwordx4 v3, s[48:51], s36 offen lds
    s_lshl_b32 s37, s39, 11
    s_add_u32 m0, s37, 93184
    s_nop 0
    buffer_load_dwordx4 v4, s[48:51], s36 offen lds
    s_mul_i32 s36, s35, 144
    s_add_u32 s36, s36, 221184
    s_lshl_b32 s37, s39, 11
    s_add_u32 m0, s37, 101376
    s_nop 0
    buffer_load_dwordx4 v3, s[48:51], s36 offen lds
    s_lshl_b32 s37, s39, 11
    s_add_u32 m0, s37, 102400
    s_nop 0
    buffer_load_dwordx4 v4, s[48:51], s36 offen lds
    s_mul_i32 s36, s35, 144
    s_add_u32 s36, s36, 294912
    s_lshl_b32 s37, s39, 11
    s_add_u32 m0, s37, 110592
    s_nop 0
    buffer_load_dwordx4 v3, s[48:51], s36 offen lds
    s_lshl_b32 s37, s39, 11
    s_add_u32 m0, s37, 111616
    s_nop 0
    buffer_load_dwordx4 v4, s[48:51], s36 offen lds
    s_mul_i32 s36, s35, 144
    s_add_u32 s36, s36, 368640
    s_lshl_b32 s37, s39, 11
    s_add_u32 m0, s37, 119808
    s_nop 0
    buffer_load_dwordx4 v3, s[48:51], s36 offen lds
    s_lshl_b32 s37, s39, 11
    s_add_u32 m0, s37, 120832
    s_nop 0
    buffer_load_dwordx4 v4, s[48:51], s36 offen lds
    s_mul_i32 s36, s35, 144
    s_add_u32 s36, s36, 442368
    s_lshl_b32 s37, s39, 11
    s_add_u32 m0, s37, 129024
    s_nop 0
    buffer_load_dwordx4 v3, s[48:51], s36 offen lds
    s_lshl_b32 s37, s39, 11
    s_add_u32 m0, s37, 130048
    s_nop 0
    buffer_load_dwordx4 v4, s[48:51], s36 offen lds
    s_mul_i32 s36, s35, 144
    s_add_u32 s36, s36, 516096
    s_lshl_b32 s37, s39, 11
    s_add_u32 m0, s37, 138240
    s_nop 0
    buffer_load_dwordx4 v3, s[48:51], s36 offen lds
    s_lshl_b32 s37, s39, 11
    s_add_u32 m0, s37, 139264
    s_nop 0
    buffer_load_dwordx4 v4, s[48:51], s36 offen lds
    s_mul_i32 s36, s35, 144
    s_add_u32 s36, s36, 589824
    s_lshl_b32 s37, s39, 11
    s_add_u32 m0, s37, 147456
    s_nop 0
    buffer_load_dwordx4 v3, s[48:51], s36 offen lds
    s_lshl_b32 s37, s39, 11
    s_add_u32 m0, s37, 148480
    s_nop 0
    buffer_load_dwordx4 v4, s[48:51], s36 offen lds
    s_waitcnt vmcnt(18)
    s_barrier
    s_waitcnt vmcnt(14)
    s_barrier
    s_waitcnt vmcnt(10)
    s_barrier
    s_waitcnt vmcnt(6)
    s_barrier
    v_mov_b32 v147, 0
    s_sub_u32 s36, s39, 1
    s_cmp_lt_u32 s36, 2
    s_cbranch_scc1 L_iissue_89
    buffer_load_dword v146, v147, s[68:71], 0 offen
L_iissue_89:
    s_waitcnt vmcnt(0)
    s_barrier
    s_sub_u32 s36, s39, 1
    s_cmp_lt_u32 s36, 2
    s_cbranch_scc1 L_icheck_90
    s_waitcnt vmcnt(0)
    s_mov_b32 s80, 0
L_icheckp_91:
    v_readfirstlane_b32 s81, v146
    s_nop 0
    s_cmp_ge_u32 s81, 32
    s_cbranch_scc1 L_icheck_90
    s_sleep 8
    buffer_load_dword v146, v147, s[68:71], 0 offen sc1
    s_waitcnt vmcnt(0)
    s_add_u32 s80, s80, 1
    s_cmp_lt_u32 s80, 0x40000
    s_cbranch_scc1 L_icheckp_91
L_icheck_90:
    s_cmp_lg_u32 s39, 0
    s_cbranch_scc1 L_pissue_92
    v_and_b32 v8, 1, v0
    v_lshlrev_b32 v8, 2, v8
    v_and_b32 v9, 2, v0
    v_lshl_add_u32 v8, v9, 7, v8
    s_lshl_b32 s36, s34, 10
    s_add_u32 s36, s36, 197888
    v_add_u32 v8, s36, v8
    buffer_load_dword v144, v8, s[52:55], 0 offen sc1
L_pissue_92:
    s_barrier
    s_branch L_hj_88
L_hduty_87:
    s_mul_i32 s36, s35, 144
    s_add_u32 s36, s36, 0
    s_lshl_b32 s37, s39, 11
    s_add_u32 m0, s37, 73728
    s_nop 0
    buffer_load_dwordx4 v3, s[48:51], s36 offen lds
    s_lshl_b32 s37, s39, 11
    s_add_u32 m0, s37, 74752
    s_nop 0
    buffer_load_dwordx4 v4, s[48:51], s36 offen lds
    s_mul_i32 s36, s35, 144
    s_add_u32 s36, s36, 73728
    s_lshl_b32 s37, s39, 11
    s_add_u32 m0, s37, 82944
    s_nop 0
    buffer_load_dwordx4 v3, s[48:51], s36 offen lds
    s_lshl_b32 s37, s39, 11
    s_add_u32 m0, s37, 83968
    s_nop 0
    buffer_load_dwordx4 v4, s[48:51], s36 offen lds
    s_mul_i32 s36, s35, 144
    s_add_u32 s36, s36, 147456
    s_lshl_b32 s37, s39, 11
    s_add_u32 m0, s37, 92160
    s_nop 0
    buffer_load_dwordx4 v3, s[48:51], s36 offen lds
    s_lshl_b32 s37, s39, 11
    s_add_u32 m0, s37, 93184
    s_nop 0
    buffer_load_dwordx4 v4, s[48:51], s36 offen lds
    s_mul_i32 s36, s35, 144
    s_add_u32 s36, s36, 221184
    s_lshl_b32 s37, s39, 11
    s_add_u32 m0, s37, 101376
    s_nop 0
    buffer_load_dwordx4 v3, s[48:51], s36 offen lds
    s_lshl_b32 s37, s39, 11
    s_add_u32 m0, s37, 102400
    s_nop 0
    buffer_load_dwordx4 v4, s[48:51], s36 offen lds
    s_mul_i32 s36, s35, 144
    s_add_u32 s36, s36, 294912
    s_lshl_b32 s37, s39, 11
    s_add_u32 m0, s37, 110592
    s_nop 0
    buffer_load_dwordx4 v3, s[48:51], s36 offen lds
    s_lshl_b32 s37, s39, 11
    s_add_u32 m0, s37, 111616
    s_nop 0
    buffer_load_dwordx4 v4, s[48:51], s36 offen lds
    s_mul_i32 s36, s35, 144
    s_add_u32 s36, s36, 368640
    s_lshl_b32 s37, s39, 11
    s_add_u32 m0, s37, 119808
    s_nop 0
    buffer_load_dwordx4 v3, s[48:51], s36 offen lds
    s_lshl_b32 s37, s39, 11
    s_add_u32 m0, s37, 120832
    s_nop 0
    buffer_load_dwordx4 v4, s[48:51], s36 offen lds
    s_waitcnt vmcnt(12)
    s_barrier
    s_barrier
    s_mul_i32 s36, s35, 144
    s_add_u32 s36, s36, 442368
    s_lshl_b32 s37, s39, 11
    s_add_u32 m0, s37, 129024
    s_nop 0
    buffer_load_dwordx4 v3, s[48:51], s36 offen lds
    s_lshl_b32 s37, s39, 11
    s_add_u32 m0, s37, 130048
    s_nop 0
    buffer_load_dwordx4 v4, s[48:51], s36 offen lds
    s_mul_i32 s36, s35, 144
    s_add_u32 s36, s36, 516096
    s_lshl_b32 s37, s39, 11
    s_add_u32 m0, s37, 138240
    s_nop 0
    buffer_load_dwordx4 v3, s[48:51], s36 offen lds
    s_lshl_b32 s37, s39, 11
    s_add_u32 m0, s37, 139264
    s_nop 0
    buffer_load_dwordx4 v4, s[48:51], s36 offen lds
    s_mul_i32 s36, s35, 144
    s_add_u32 s36, s36, 589824
    s_lshl_b32 s37, s39, 11
    s_add_u32 m0, s37, 147456
    s_nop 0
    buffer_load_dwordx4 v3, s[48:51], s36 offen lds
    s_lshl_b32 s37, s39, 11
    s_add_u32 m0, s37, 148480
    s_nop 0
    buffer_load_dwordx4 v4, s[48:51], s36 offen lds
    s_waitcnt vmcnt(6)
    s_barrier
    v_mov_b32 v147, 0
    s_sub_u32 s36, s39, 1
    s_cmp_lt_u32 s36, 2
    s_cbranch_scc1 L_iissue_93
    buffer_load_dword v146, v147, s[68:71], 0 offen
L_iissue_93:
    s_waitcnt vmcnt(0)
    s_barrier
    s_sub_u32 s36, s39, 1
    s_cmp_lt_u32 s36, 2
    s_cbranch_scc1 L_icheck_94
    s_waitcnt vmcnt(0)
    s_mov_b32 s80, 0
L_icheckp_95:
    v_readfirstlane_b32 s81, v146
    s_nop 0
    s_cmp_ge_u32 s81, 32
    s_cbranch_scc1 L_icheck_94
    s_sleep 8
    buffer_load_dword v146, v147, s[68:71], 0 offen sc1
    s_waitcnt vmcnt(0)
    s_add_u32 s80, s80, 1
    s_cmp_lt_u32 s80, 0x40000
    s_cbranch_scc1 L_icheckp_95
L_icheck_94:
    s_cmp_lg_u32 s35, 0
    s_cbranch_scc1 L_nopk_96
    s_cmp_lg_u32 s39, 3
    s_cbranch_scc1 L_nopk_96
    v_lshrrev_b32 v8, 5, v0
    v_and_b32 v9, 31, v0
    v_lshlrev_b32 v10, 10, v8
    v_lshl_add_u32 v10, v9, 4, v10
    v_add_u32 v10, 156672, v10
    v_lshlrev_b32 v11, 3, v9
    v_lshl_add_u32 v11, v8, 2, v11
    v_add_u32 v11, 158720, v11
    ds_read_b128 v[28:31], v10
    ds_read_b128 v[32:35], v10 offset:512
    ds_read_b32 v36, v11
    s_waitcnt lgkmcnt(0)
    v_dot2_f32_bf16 v8, v28, v28, 0
    v_dot2_f32_bf16 v8, v29, v29, v8
    v_dot2_f32_bf16 v8, v30, v30, v8
    v_dot2_f32_bf16 v8, v31, v31, v8
    v_dot2_f32_bf16 v8, v32, v32, v8
    v_dot2_f32_bf16 v8, v33, v33, v8
    v_dot2_f32_bf16 v8, v34, v34, v8
    v_dot2_f32_bf16 v8, v35, v35, v8
    v_dot2_f32_bf16 v8, v36, v36, v8
    s_nop 2
    v_max_f32_dpp v8, v8, v8 row_ror:1 row_mask:0xf bank_mask:0xf
    s_nop 1
    v_max_f32_dpp v8, v8, v8 row_ror:2 row_mask:0xf bank_mask:0xf
    s_nop 1
    v_max_f32_dpp v8, v8, v8 row_ror:4 row_mask:0xf bank_mask:0xf
    s_nop 1
    v_max_f32_dpp v8, v8, v8 row_ror:8 row_mask:0xf bank_mask:0xf
    s_nop 0
    v_readlane_b32 s80, v8, 0
    v_readlane_b32 s81, v8, 16
    s_nop 0
    s_max_u32 s80, s80, s81
    v_readlane_b32 s81, v8, 32
    s_nop 0
    s_max_u32 s80, s80, s81
    v_readlane_b32 s81, v8, 48
    s_nop 0
    s_max_u32 s80, s80, s81
    v_mov_b32 v8, s80
    v_mul_f32 v8, 0x3f8020c5, v8
    v_or_b32 v8, 1, v8
    s_lshl_b32 s36, s34, 2
    s_add_u32 s36, s36, 198784
    v_lshlrev_b32 v9, 10, v0
    v_cmp_gt_u32 vcc, 32, v0
    s_nop 0
    s_and_saveexec_b64 s[76:77], vcc
    buffer_store_dword v8, v9, s[52:55], s36 offen sc1
    s_mov_b64 exec, s[76:77]
L_nopk_96:
    s_cmp_lg_u32 s39, 0
    s_cbranch_scc1 L_pissue_97
    v_and_b32 v8, 1, v0
    v_lshlrev_b32 v8, 2, v8
    v_and_b32 v9, 2, v0
    v_lshl_add_u32 v8, v9, 7, v8
    s_lshl_b32 s36, s34, 10
    s_add_u32 s36, s36, 197888
    v_add_u32 v8, s36, v8
    buffer_load_dword v144, v8, s[52:55], 0 offen sc1
L_pissue_97:
    s_barrier
L_hj_88:
    s_cmp_lg_u32 s39, 0
    s_cbranch_scc1 L_kv0skip_98
    s_mov_b32 s80, 0
    s_branch L_kv0chk_101
L_kv0lp_99:
    buffer_load_dword v144, v8, s[52:55], 0 offen sc1
L_kv0chk_101:
    s_waitcnt vmcnt(0)
    v_mov_b32 v10, 0x01010101
    v_cmp_eq_u32 vcc, v10, v144
    s_nop 1
    s_not_b64 s[82:83], vcc
    s_cmp_eq_u64 s[82:83], 0
    s_cbranch_scc1 L_kv0ok_100
    s_sleep 1
    s_add_u32 s80, s80, 1
    s_cmp_lt_u32 s80, 0x80000
    s_cbranch_scc1 L_kv0lp_99
L_kv0ok_100:
L_kv0skip_98:
    s_barrier
    s_lshl_b32 s37, s39, 10
    s_add_u32 s36, s37, 0
    s_mov_b32 m0, s36
    s_nop 0
    buffer_load_dwordx4 v6, s[60:63], s36 offen lds
    s_add_u32 s36, s37, 4096
    s_mov_b32 m0, s36
    s_nop 0
    buffer_load_dwordx4 v6, s[60:63], s36 offen lds
    s_add_u32 s36, s37, 8192
    s_mov_b32 m0, s36
    s_nop 0
    buffer_load_dwordx4 v6, s[60:63], s36 offen lds
    s_add_u32 s36, s37, 12288
    s_mov_b32 m0, s36
    s_nop 0
    buffer_load_dwordx4 v6, s[60:63], s36 offen lds
    s_add_u32 s36, s37, 16384
    s_mov_b32 m0, s36
    s_nop 0
    buffer_load_dwordx4 v6, s[60:63], s36 offen lds
    s_add_u32 s36, s37, 20480
    s_mov_b32 m0, s36
    s_nop 0
    buffer_load_dwordx4 v6, s[60:63], s36 offen lds
    s_add_u32 s36, s37, 24576
    s_mov_b32 m0, s36
    s_nop 0
    buffer_load_dwordx4 v6, s[60:63], s36 offen lds
    s_add_u32 s36, s37, 28672
    s_mov_b32 m0, s36
    s_nop 0
    buffer_load_dwordx4 v6, s[60:63], s36 offen lds
    s_add_u32 s36, s37, 32768
    s_mov_b32 m0, s36
    s_nop 0
    buffer_load_dwordx4 v6, s[60:63], s36 offen lds
    s_cmp_ge_u32 s39, 1
    s_cbranch_scc1 L_kvt_102
    s_add_u32 s36, s37, 36864
    s_mov_b32 m0, s36
    s_nop 0
    buffer_load_dwordx4 v6, s[60:63], s36 offen lds
L_kvt_102:
    s_waitcnt vmcnt(0)
    s_barrier
    s_cmp_lg_u32 s39, 0
    s_cbranch_scc1 L_kvpskip_103
    s_mov_b32 s80, 0
    v_min_u32 v8, 23, v0
    v_and_b32 v9, 3, v8
    v_lshrrev_b32 v8, 2, v8
    v_lshlrev_b32 v8, 7, v8
    v_lshl_add_u32 v8, v9, 2, v8
    s_lshl_b32 s36, s34, 10
    s_add_u32 s36, s36, 197888
    v_add_u32 v8, s36, v8
L_kvplp_104:
    buffer_load_dword v144, v8, s[52:55], 0 offen sc1
L_kvpchk_106:
    s_waitcnt vmcnt(0)
    v_mov_b32 v10, 0x01010101
    v_cmp_eq_u32 vcc, v10, v144
    s_nop 1
    s_not_b64 s[82:83], vcc
    s_cmp_eq_u64 s[82:83], 0
    s_cbranch_scc1 L_kvpok_105
    s_sleep 1
    s_add_u32 s80, s80, 1
    s_cmp_lt_u32 s80, 0x80000
    s_cbranch_scc1 L_kvplp_104
L_kvpok_105:
L_kvpskip_103:
    s_waitcnt lgkmcnt(0)
    v_mov_b32 v20, 163600
    v_mov_b32 v21, 1
    s_mov_b64 s[76:77], exec
    s_mov_b64 exec, 1
    ds_add_u32 v20, v21
    s_mov_b64 exec, s[76:77]
    s_mov_b32 s80, 0
L_hsall_107:
    ds_read_b32 v21, v20
    s_waitcnt lgkmcnt(0)
    v_readfirstlane_b32 s81, v21
    s_nop 0
    s_cmp_ge_u32 s81, 4
    s_cbranch_scc1 L_hsalld_108
    s_sleep 4
    s_add_u32 s80, s80, 1
    s_cmp_lt_u32 s80, 0x100000
    s_cbranch_scc1 L_hsall_107
L_hsalld_108:
    s_mov_b32 s36, 160000
    buffer_load_dwordx4 v[148:151], v6, s[52:55], s36 offen
    s_lshl_b32 s37, s39, 10
    s_add_u32 s36, s37, 37888
    s_mov_b32 m0, s36
    s_nop 0
    buffer_load_dwordx4 v6, s[60:63], s36 offen lds
    s_add_u32 s36, s37, 41984
    s_mov_b32 m0, s36
    s_nop 0
    buffer_load_dwordx4 v6, s[60:63], s36 offen lds
    s_add_u32 s36, s37, 46080
    s_mov_b32 m0, s36
    s_nop 0
    buffer_load_dwordx4 v6, s[60:63], s36 offen lds
    s_add_u32 s36, s37, 50176
    s_mov_b32 m0, s36
    s_nop 0
    buffer_load_dwordx4 v6, s[60:63], s36 offen lds
    s_add_u32 s36, s37, 54272
    s_mov_b32 m0, s36
    s_nop 0
    buffer_load_dwordx4 v6, s[60:63], s36 offen lds
    s_add_u32 s36, s37, 58368
    s_mov_b32 m0, s36
    s_nop 0
    buffer_load_dwordx4 v6, s[60:63], s36 offen lds
    s_add_u32 s36, s37, 62464
    s_mov_b32 m0, s36
    s_nop 0
    buffer_load_dwordx4 v6, s[60:63], s36 offen lds
    s_add_u32 s36, s37, 66560
    s_mov_b32 m0, s36
    s_nop 0
    buffer_load_dwordx4 v6, s[60:63], s36 offen lds
    s_add_u32 s36, s37, 70656
    s_mov_b32 m0, s36
    s_nop 0
    buffer_load_dwordx4 v6, s[60:63], s36 offen lds
    s_add_u32 s36, s37, 74752
    s_mov_b32 m0, s36
    s_nop 0
    buffer_load_dwordx4 v6, s[60:63], s36 offen lds
    s_add_u32 s36, s37, 78848
    s_mov_b32 m0, s36
    s_nop 0
    buffer_load_dwordx4 v6, s[60:63], s36 offen lds
    s_add_u32 s36, s37, 82944
    s_mov_b32 m0, s36
    s_nop 0
    buffer_load_dwordx4 v6, s[60:63], s36 offen lds
    s_add_u32 s36, s37, 87040
    s_mov_b32 m0, s36
    s_nop 0
    buffer_load_dwordx4 v6, s[60:63], s36 offen lds
    s_add_u32 s36, s37, 91136
    s_mov_b32 m0, s36
    s_nop 0
    buffer_load_dwordx4 v6, s[60:63], s36 offen lds
    s_add_u32 s36, s37, 95232
    s_mov_b32 m0, s36
    s_nop 0
    buffer_load_dwordx4 v6, s[60:63], s36 offen lds
    s_add_u32 s36, s37, 99328
    s_mov_b32 m0, s36
    s_nop 0
    buffer_load_dwordx4 v6, s[60:63], s36 offen lds
    s_add_u32 s36, s37, 103424
    s_mov_b32 m0, s36
    s_nop 0
    buffer_load_dwordx4 v6, s[60:63], s36 offen lds
    s_add_u32 s36, s37, 107520
    s_mov_b32 m0, s36
    s_nop 0
    buffer_load_dwordx4 v6, s[60:63], s36 offen lds
    s_add_u32 s36, s37, 111616
    s_mov_b32 m0, s36
    s_nop 0
    buffer_load_dwordx4 v6, s[60:63], s36 offen lds
    s_add_u32 s36, s37, 115712
    s_mov_b32 m0, s36
    s_nop 0
    buffer_load_dwordx4 v6, s[60:63], s36 offen lds
    s_add_u32 s36, s37, 119808
    s_mov_b32 m0, s36
    s_nop 0
    buffer_load_dwordx4 v6, s[60:63], s36 offen lds
    s_add_u32 s36, s37, 123904
    s_mov_b32 m0, s36
    s_nop 0
    buffer_load_dwordx4 v6, s[60:63], s36 offen lds
    s_add_u32 s36, s37, 128000
    s_mov_b32 m0, s36
    s_nop 0
    buffer_load_dwordx4 v6, s[60:63], s36 offen lds
    s_add_u32 s36, s37, 132096
    s_mov_b32 m0, s36
    s_nop 0
    buffer_load_dwordx4 v6, s[60:63], s36 offen lds
    s_add_u32 s36, s37, 136192
    s_mov_b32 m0, s36
    s_nop 0
    buffer_load_dwordx4 v6, s[60:63], s36 offen lds
    s_add_u32 s36, s37, 140288
    s_mov_b32 m0, s36
    s_nop 0
    buffer_load_dwordx4 v6, s[60:63], s36 offen lds
    s_add_u32 s36, s37, 144384
    s_mov_b32 m0, s36
    s_nop 0
    buffer_load_dwordx4 v6, s[60:63], s36 offen lds
    s_cmp_ge_u32 s39, 3
    s_cbranch_scc1 L_kvt_109
    s_add_u32 s36, s37, 148480
    s_mov_b32 m0, s36
    s_nop 0
    buffer_load_dwordx4 v6, s[60:63], s36 offen lds
L_kvt_109:
    v_and_b32 v8, 31, v0
    v_lshlrev_b32 v8, 2, v8
    s_lshl_b32 s36, s34, 10
    s_add_u32 s36, s36, 198784
    v_add_u32 v8, s36, v8
    s_cmp_lg_u32 s39, 1
    s_cbranch_scc1 L_nokn_110
    s_mov_b32 s80, 0
L_knp_111:
    buffer_load_dword v9, v8, s[52:55], 0 offen sc1
    s_waitcnt vmcnt(0)
    v_cmp_eq_u32 vcc, 0, v9
    s_nop 1
    s_cmp_eq_u64 vcc, 0
    s_cbranch_scc1 L_knd_112
    s_sleep 4
    s_add_u32 s80, s80, 1
    s_cmp_lt_u32 s80, 0x40000
    s_cbranch_scc1 L_knp_111
L_knd_112:
    v_max_f32_dpp v9, v9, v9 row_ror:1 row_mask:0xf bank_mask:0xf
    s_nop 1
    v_max_f32_dpp v9, v9, v9 row_ror:2 row_mask:0xf bank_mask:0xf
    s_nop 1
    v_max_f32_dpp v9, v9, v9 row_ror:4 row_mask:0xf bank_mask:0xf
    s_nop 1
    v_max_f32_dpp v9, v9, v9 row_ror:8 row_mask:0xf bank_mask:0xf
    s_nop 0
    v_readlane_b32 s80, v9, 0
    v_readlane_b32 s81, v9, 16
    s_nop 0
    s_max_u32 s80, s80, s81
    v_mov_b32 v8, 163632
    v_mov_b32 v9, s80
    ds_write_b32 v8, v9
L_nokn_110:
    s_waitcnt vmcnt(0)
    s_cmp_lg_u32 s39, 0
    s_cbranch_scc1 L_nosel_113
    v_max_u32 v8, v148, v149
    v_min_u32 v9, v148, v149
    v_med3_u32 v9, v8, v9, v150
    v_max_u32 v8, v8, v150
    v_med3_u32 v9, v8, v9, v151
    v_max_u32 v8, v8, v151
    v_mov_b32 v10, v8
    s_nop 1
    v_max_u32_dpp v10, v10, v10 row_ror:1 row_mask:0xf bank_mask:0xf
    s_nop 1
    v_max_u32_dpp v10, v10, v10 row_ror:2 row_mask:0xf bank_mask:0xf
    s_nop 1
    v_max_u32_dpp v10, v10, v10 row_ror:4 row_mask:0xf bank_mask:0xf
    s_nop 1
    v_max_u32_dpp v10, v10, v10 row_ror:8 row_mask:0xf bank_mask:0xf
    s_nop 0
    v_readlane_b32 s80, v10, 0
    v_readlane_b32 s36, v10, 16
    s_nop 0
    s_max_u32 s80, s80, s36
    v_readlane_b32 s36, v10, 32
    s_nop 0
    s_max_u32 s80, s80, s36
    v_readlane_b32 s36, v10, 48
    s_nop 0
    s_max_u32 s80, s80, s36
    v_cmp_eq_u32 vcc, s80, v8
    s_nop 1
    v_cndmask_b32 v8, v8, v9, vcc
    v_mov_b32 v10, v8
    s_nop 1
    v_max_u32_dpp v10, v10, v10 row_ror:1 row_mask:0xf bank_mask:0xf
    s_nop 1
    v_max_u32_dpp v10, v10, v10 row_ror:2 row_mask:0xf bank_mask:0xf
    s_nop 1
    v_max_u32_dpp v10, v10, v10 row_ror:4 row_mask:0xf bank_mask:0xf
    s_nop 1
    v_max_u32_dpp v10, v10, v10 row_ror:8 row_mask:0xf bank_mask:0xf
    s_nop 0
    v_readlane_b32 s81, v10, 0
    v_readlane_b32 s36, v10, 16
    s_nop 0
    s_max_u32 s81, s81, s36
    v_readlane_b32 s36, v10, 32
    s_nop 0
    s_max_u32 s81, s81, s36
    v_readlane_b32 s36, v10, 48
    s_nop 0
    s_max_u32 s81, s81, s36
    v_mov_b32 v8, s80
    v_mov_b32 v9, s81
    v_cmp_eq_u32 vcc, 1, v0
    s_nop 1
    v_cndmask_b32 v8, v8, v9, vcc
    v_lshrrev_b32 v9, 16, v8
    v_xor_b32 v10, 0x8000, v9
    v_xor_b32 v11, 0xffff, v9
    v_cmp_lt_u32 vcc, 0x7fff, v9
    s_nop 1
    v_cndmask_b32 v9, v11, v10, vcc
    v_lshlrev_b32 v9, 16, v9
    v_mul_f32 v9, 0xbfb8aa3b, v9
    v_exp_f32 v9, v9
    s_nop 0
    v_add_f32 v9, 1.0, v9
    v_rcp_f32 v9, v9
    s_nop 0
    v_cvt_pk_bf16_f32 v9, v9, v9
    v_and_b32 v9, 0xffff0000, v9
    v_and_b32 v8, 0xffff, v8
    v_sub_u32 v8, 0xffff, v8
    v_min_u32 v8, 2047, v8
    v_lshlrev_b32 v10, 2, v0
    v_add_u32 v10, 163616, v10
    v_cmp_gt_u32 vcc, 2, v0
    s_nop 0
    s_and_saveexec_b64 s[76:77], vcc
    ds_write_b32 v10, v8
    ds_write_b32 v10, v9 offset:8
    s_mov_b64 exec, s[76:77]
L_nosel_113:
    s_waitcnt vmcnt(0) lgkmcnt(0)
    s_barrier
    v_mov_b32 v8, 163616
    ds_read_b64 v[10:11], v8
    s_waitcnt lgkmcnt(0)
    v_readfirstlane_b32 s42, v10
    v_readfirstlane_b32 s43, v11
    s_cmp_lt_u32 s35, 3
    s_cbranch_scc1 L_noffn_114
    s_lshr_b32 s36, s2, 6
    s_mul_i32 s36, s36, 5
    s_add_u32 s36, s36, s35
    s_sub_u32 s36, s36, 3
    s_cmp_ge_u32 s36, 18
    s_cbranch_scc1 L_noffn_114
    s_and_b32 s37, s2, 7
    s_mul_i32 s37, s37, 18
    s_add_u32 s86, s37, s36
    v_and_b32 v22, 15, v0
    v_lshrrev_b32 v23, 4, v0
    s_and_b32 s84, s39, 1
    s_lshr_b32 s85, s39, 1
    s_cmp_eq_u32 s84, 0
    s_cselect_b32 s56, s18, s20
    s_cselect_b32 s57, s19, s21
    s_and_b32 s57, s57, 0xffff
    s_mov_b32 s58, 5308416
    s_mov_b32 s59, 0x20000
    s_mov_b32 s72, s22
    s_and_b32 s73, s23, 0xffff
    s_mov_b32 s74, 5308416
    s_mov_b32 s75, 0x20000
    v_lshrrev_b32 v8, 2, v0
    v_and_b32 v9, 3, v0
    v_lshlrev_b32 v9, 4, v9
    v_mul_u32_u24 v10, 1152, v8
    v_add_u32 v10, v10, v9
    v_mul_u32_u24 v8, 9216, v8
    v_add_u32 v8, v8, v9
    s_mul_i32 s36, s85, 2654208
    s_lshl_b32 s37, s86, 6
    s_add_u32 s36, s36, s37
    buffer_load_dwordx4 v[24:27], v8, s[56:59], s36 offen
    s_add_u32 s36, s36, 147456
    buffer_load_dwordx4 v[28:31], v8, s[56:59], s36 offen
    s_add_u32 s36, s36, 147456
    buffer_load_dwordx4 v[32:35], v8, s[56:59], s36 offen
    s_add_u32 s36, s36, 147456
    buffer_load_dwordx4 v[36:39], v8, s[56:59], s36 offen
    s_add_u32 s36, s36, 147456
    buffer_load_dwordx4 v[40:43], v8, s[56:59], s36 offen
    s_add_u32 s36, s36, 147456
    buffer_load_dwordx4 v[44:47], v8, s[56:59], s36 offen
    s_add_u32 s36, s36, 147456
    buffer_load_dwordx4 v[48:51], v8, s[56:59], s36 offen
    s_add_u32 s36, s36, 147456
    buffer_load_dwordx4 v[52:55], v8, s[56:59], s36 offen
    s_add_u32 s36, s36, 147456
    buffer_load_dwordx4 v[56:59], v8, s[56:59], s36 offen
    s_add_u32 s36, s36, 147456
    buffer_load_dwordx4 v[60:63], v8, s[56:59], s36 offen
    s_add_u32 s36, s36, 147456
    buffer_load_dwordx4 v[64:67], v8, s[56:59], s36 offen
    s_add_u32 s36, s36, 147456
    buffer_load_dwordx4 v[68:71], v8, s[56:59], s36 offen
    s_add_u32 s36, s36, 147456
    buffer_load_dwordx4 v[72:75], v8, s[56:59], s36 offen
    s_add_u32 s36, s36, 147456
    buffer_load_dwordx4 v[76:79], v8, s[56:59], s36 offen
    s_add_u32 s36, s36, 147456
    buffer_load_dwordx4 v[80:83], v8, s[56:59], s36 offen
    s_add_u32 s36, s36, 147456
    buffer_load_dwordx4 v[84:87], v8, s[56:59], s36 offen
    s_add_u32 s36, s36, 147456
    buffer_load_dwordx4 v[88:91], v8, s[56:59], s36 offen
    s_add_u32 s36, s36, 147456
    buffer_load_dwordx4 v[92:95], v8, s[56:59], s36 offen
    s_add_u32 s36, s36, 147456
    v_mov_b32 v8, s42
    v_mov_b32 v9, s43
    v_cmp_eq_u32 vcc, 1, v22
    s_nop 1
    v_cndmask_b32 v8, v8, v9, vcc
    v_mul_u32_u24 v8, 1152, v8
    v_lshl_add_u32 v8, v23, 4, v8
    s_mul_i32 s36, s85, 576
    buffer_load_dwordx4 v[96:99], v8, s[44:47], s36 offen offset:0
    buffer_load_dwordx4 v[100:103], v8, s[44:47], s36 offen offset:64
    buffer_load_dwordx4 v[104:107], v8, s[44:47], s36 offen offset:128
    buffer_load_dwordx4 v[108:111], v8, s[44:47], s36 offen offset:192
    buffer_load_dwordx4 v[112:115], v8, s[44:47], s36 offen offset:256
    buffer_load_dwordx4 v[116:119], v8, s[44:47], s36 offen offset:320
    buffer_load_dwordx4 v[120:123], v8, s[44:47], s36 offen offset:384
    buffer_load_dwordx4 v[124:127], v8, s[44:47], s36 offen offset:448
    buffer_load_dwordx4 v[128:131], v8, s[44:47], s36 offen offset:512
    s_lshl_b32 s36, s39, 11
    s_add_u32 s36, s36, 151552
    v_add_u32 v11, s36, v6
    v_bfe_u32 v13, v0, 2, 2
    v_lshl_add_u32 v13, v23, 3, v13
    v_and_b32 v14, 3, v0
    v_lshlrev_b32 v14, 3, v14
    v_lshl_add_u32 v12, v13, 6, v14
    v_add_u32 v12, s36, v12
    s_waitcnt vmcnt(0)
    ds_write_b128 v11, v[24:27]
    ds_write_b128 v11, v[28:31] offset:1024
    s_waitcnt lgkmcnt(0)
    ds_read_b64_tr_b16 v[152:153], v12 offset:0
    ds_read_b64_tr_b16 v[154:155], v12 offset:256
    ds_read_b64_tr_b16 v[156:157], v12 offset:32
    ds_read_b64_tr_b16 v[158:159], v12 offset:288
    s_waitcnt lgkmcnt(0)
    v_mfma_f32_16x16x32_bf16 v[160:163], v[152:155], v[96:99], 0
    v_mfma_f32_16x16x32_bf16 v[164:167], v[156:159], v[96:99], 0
    ds_write_b128 v11, v[32:35]
    ds_write_b128 v11, v[36:39] offset:1024
    s_waitcnt lgkmcnt(0)
    ds_read_b64_tr_b16 v[152:153], v12 offset:0
    ds_read_b64_tr_b16 v[154:155], v12 offset:256
    ds_read_b64_tr_b16 v[156:157], v12 offset:32
    ds_read_b64_tr_b16 v[158:159], v12 offset:288
    s_waitcnt lgkmcnt(0)
    v_mfma_f32_16x16x32_bf16 v[160:163], v[152:155], v[100:103], v[160:163]
    v_mfma_f32_16x16x32_bf16 v[164:167], v[156:159], v[100:103], v[164:167]
    ds_write_b128 v11, v[40:43]
    ds_write_b128 v11, v[44:47] offset:1024
    s_waitcnt lgkmcnt(0)
    ds_read_b64_tr_b16 v[152:153], v12 offset:0
    ds_read_b64_tr_b16 v[154:155], v12 offset:256
    ds_read_b64_tr_b16 v[156:157], v12 offset:32
    ds_read_b64_tr_b16 v[158:159], v12 offset:288
    s_waitcnt lgkmcnt(0)
    v_mfma_f32_16x16x32_bf16 v[160:163], v[152:155], v[104:107], v[160:163]
    v_mfma_f32_16x16x32_bf16 v[164:167], v[156:159], v[104:107], v[164:167]
    ds_write_b128 v11, v[48:51]
    ds_write_b128 v11, v[52:55] offset:1024
    s_waitcnt lgkmcnt(0)
    ds_read_b64_tr_b16 v[152:153], v12 offset:0
    ds_read_b64_tr_b16 v[154:155], v12 offset:256
    ds_read_b64_tr_b16 v[156:157], v12 offset:32
    ds_read_b64_tr_b16 v[158:159], v12 offset:288
    s_waitcnt lgkmcnt(0)
    v_mfma_f32_16x16x32_bf16 v[160:163], v[152:155], v[108:111], v[160:163]
    v_mfma_f32_16x16x32_bf16 v[164:167], v[156:159], v[108:111], v[164:167]
    ds_write_b128 v11, v[56:59]
    ds_write_b128 v11, v[60:63] offset:1024
    s_waitcnt lgkmcnt(0)
    ds_read_b64_tr_b16 v[152:153], v12 offset:0
    ds_read_b64_tr_b16 v[154:155], v12 offset:256
    ds_read_b64_tr_b16 v[156:157], v12 offset:32
    ds_read_b64_tr_b16 v[158:159], v12 offset:288
    s_waitcnt lgkmcnt(0)
    v_mfma_f32_16x16x32_bf16 v[160:163], v[152:155], v[112:115], v[160:163]
    v_mfma_f32_16x16x32_bf16 v[164:167], v[156:159], v[112:115], v[164:167]
    s_mul_i32 s36, s86, 36864
    s_mul_i32 s37, s39, 288
    s_add_u32 s36, s36, s37
    s_add_u32 s37, s36, 18432
    buffer_load_dwordx4 v[24:27], v10, s[72:75], s36 offen offset:0
    buffer_load_dwordx4 v[28:31], v10, s[72:75], s37 offen offset:0
    buffer_load_dwordx4 v[32:35], v10, s[72:75], s36 offen offset:64
    buffer_load_dwordx4 v[36:39], v10, s[72:75], s37 offen offset:64
    buffer_load_dwordx4 v[40:43], v10, s[72:75], s36 offen offset:128
    buffer_load_dwordx4 v[44:47], v10, s[72:75], s37 offen offset:128
    buffer_load_dwordx4 v[48:51], v10, s[72:75], s36 offen offset:192
    buffer_load_dwordx4 v[52:55], v10, s[72:75], s37 offen offset:192
    buffer_load_dwordx4 v[56:59], v10, s[72:75], s36 offen offset:256
    buffer_load_dwordx4 v[60:63], v10, s[72:75], s37 offen offset:256
    ds_write_b128 v11, v[64:67]
    ds_write_b128 v11, v[68:71] offset:1024
    s_waitcnt lgkmcnt(0)
    ds_read_b64_tr_b16 v[152:153], v12 offset:0
    ds_read_b64_tr_b16 v[154:155], v12 offset:256
    ds_read_b64_tr_b16 v[156:157], v12 offset:32
    ds_read_b64_tr_b16 v[158:159], v12 offset:288
    s_waitcnt lgkmcnt(0)
    v_mfma_f32_16x16x32_bf16 v[160:163], v[152:155], v[116:119], v[160:163]
    v_mfma_f32_16x16x32_bf16 v[164:167], v[156:159], v[116:119], v[164:167]
    ds_write_b128 v11, v[72:75]
    ds_write_b128 v11, v[76:79] offset:1024
    s_waitcnt lgkmcnt(0)
    ds_read_b64_tr_b16 v[152:153], v12 offset:0
    ds_read_b64_tr_b16 v[154:155], v12 offset:256
    ds_read_b64_tr_b16 v[156:157], v12 offset:32
    ds_read_b64_tr_b16 v[158:159], v12 offset:288
    s_waitcnt lgkmcnt(0)
    v_mfma_f32_16x16x32_bf16 v[160:163], v[152:155], v[120:123], v[160:163]
    v_mfma_f32_16x16x32_bf16 v[164:167], v[156:159], v[120:123], v[164:167]
    ds_write_b128 v11, v[80:83]
    ds_write_b128 v11, v[84:87] offset:1024
    s_waitcnt lgkmcnt(0)
    ds_read_b64_tr_b16 v[152:153], v12 offset:0
    ds_read_b64_tr_b16 v[154:155], v12 offset:256
    ds_read_b64_tr_b16 v[156:157], v12 offset:32
    ds_read_b64_tr_b16 v[158:159], v12 offset:288
    s_waitcnt lgkmcnt(0)
    v_mfma_f32_16x16x32_bf16 v[160:163], v[152:155], v[124:127], v[160:163]
    v_mfma_f32_16x16x32_bf16 v[164:167], v[156:159], v[124:127], v[164:167]
    ds_write_b128 v11, v[88:91]
    ds_write_b128 v11, v[92:95] offset:1024
    s_waitcnt lgkmcnt(0)
    ds_read_b64_tr_b16 v[152:153], v12 offset:0
    ds_read_b64_tr_b16 v[154:155], v12 offset:256
    ds_read_b64_tr_b16 v[156:157], v12 offset:32
    ds_read_b64_tr_b16 v[158:159], v12 offset:288
    s_waitcnt lgkmcnt(0)
    v_mfma_f32_16x16x32_bf16 v[160:163], v[152:155], v[128:131], v[160:163]
    v_mfma_f32_16x16x32_bf16 v[164:167], v[156:159], v[128:131], v[164:167]
    s_nop 7
    v_lshlrev_b32 v13, 1, v23
    v_add_u32 v13, v13, v22
    v_lshlrev_b32 v13, 4, v13
    v_add_u32 v15, 159744, v13
    s_lshl_b32 s36, s39, 8
    v_add_u32 v14, s36, v15
    v_cmp_gt_u32 vcc, 2, v22
    s_nop 0
    s_and_saveexec_b64 s[76:77], vcc
    ds_write_b128 v14, v[160:163]
    ds_write_b128 v14, v[164:167] offset:128
    s_mov_b64 exec, s[76:77]
    s_waitcnt lgkmcnt(0)
    v_mov_b32 v20, 163584
    v_mov_b32 v21, 1
    s_mov_b64 s[76:77], exec
    s_mov_b64 exec, 1
    ds_add_u32 v20, v21
    s_mov_b64 exec, s[76:77]
    s_mov_b32 s80, 0
L_hs0_115:
    ds_read_b32 v21, v20
    s_waitcnt lgkmcnt(0)
    v_readfirstlane_b32 s81, v21
    s_nop 0
    s_cmp_ge_u32 s81, 4
    s_cbranch_scc1 L_hs0d_116
    s_sleep 1
    s_add_u32 s80, s80, 1
    s_cmp_lt_u32 s80, 0x100000
    s_cbranch_scc1 L_hs0_115
L_hs0d_116:
    s_cmp_lg_u32 s39, 3
    s_cbranch_scc1 L_noh_117
    v_lshrrev_b32 v13, 5, v0
    v_bfe_u32 v14, v0, 4, 1
    v_bfe_u32 v15, v0, 2, 2
    v_and_b32 v16, 3, v0
    v_lshl_add_u32 v15, v15, 1, v13
    v_lshlrev_b32 v15, 4, v15
    v_lshl_add_u32 v15, v14, 7, v15
    v_lshl_add_u32 v15, v16, 2, v15
    v_add_u32 v15, 159744, v15
    ds_read_b32 v96, v15 offset:0
    ds_read_b32 v97, v15 offset:256
    ds_read_b32 v98, v15 offset:512
    ds_read_b32 v99, v15 offset:768
    v_lshlrev_b32 v14, 1, v0
    v_add_u32 v14, 160768, v14
    s_waitcnt lgkmcnt(0)
    v_add_f32 v96, v96, v98
    v_add_f32 v97, v97, v99
    v_cvt_pk_bf16_f32 v96, v96, v97
    v_and_b32 v97, 0xffff0000, v96
    v_lshlrev_b32 v96, 16, v96
    v_mul_f32 v100, 0xbfb8aa3b, v96
    v_exp_f32 v100, v100
    s_nop 0
    v_add_f32 v100, 1.0, v100
    v_rcp_f32 v100, v100
    s_nop 0
    v_mul_f32 v96, v96, v100
    v_cvt_pk_bf16_f32 v96, v96, v96
    v_and_b32 v96, 0xffff0000, v96
    v_mul_f32 v96, v96, v97
    v_cvt_pk_bf16_f32 v96, v96, v96
    ds_write_b16 v14, v96
L_noh_117:
    s_waitcnt lgkmcnt(0)
    v_mov_b32 v20, 163588
    v_mov_b32 v21, 1
    s_mov_b64 s[76:77], exec
    s_mov_b64 exec, 1
    ds_add_u32 v20, v21
    s_mov_b64 exec, s[76:77]
    s_mov_b32 s80, 0
L_hs1_118:
    ds_read_b32 v21, v20
    s_waitcnt lgkmcnt(0)
    v_readfirstlane_b32 s81, v21
    s_nop 0
    s_cmp_ge_u32 s81, 4
    s_cbranch_scc1 L_hs1d_119
    s_sleep 1
    s_add_u32 s80, s80, 1
    s_cmp_lt_u32 s80, 0x100000
    s_cbranch_scc1 L_hs1_118
L_hs1d_119:
    v_and_b32 v13, 3, v22
    v_lshrrev_b32 v14, 2, v22
    v_lshlrev_b32 v15, 6, v13
    v_lshl_add_u32 v15, v23, 4, v15
    v_add_u32 v15, 160768, v15
    v_mov_b32 v16, 196608
    v_cmp_gt_u32 vcc, 2, v13
    s_nop 1
    v_cndmask_b32 v15, v16, v15, vcc
    v_cmp_eq_u32 vcc, 0, v14
    s_nop 1
    v_cndmask_b32 v13, v16, v15, vcc
    ds_read_b128 v[112:115], v13
    v_cmp_eq_u32 vcc, 1, v14
    s_nop 1
    v_cndmask_b32 v13, v16, v15, vcc
    ds_read_b128 v[116:119], v13
    v_cmp_eq_u32 vcc, 2, v14
    s_nop 1
    v_cndmask_b32 v13, v16, v15, vcc
    ds_read_b128 v[120:123], v13
    v_cmp_eq_u32 vcc, 3, v14
    s_nop 1
    v_cndmask_b32 v13, v16, v15, vcc
    ds_read_b128 v[124:127], v13
    s_waitcnt vmcnt(0)
    ds_write_b128 v11, v[24:27]
    ds_write_b128 v11, v[28:31] offset:1024
    s_waitcnt lgkmcnt(0)
    ds_read_b64_tr_b16 v[152:153], v12 offset:0
    ds_read_b64_tr_b16 v[154:155], v12 offset:256
    ds_read_b64_tr_b16 v[156:157], v12 offset:32
    ds_read_b64_tr_b16 v[158:159], v12 offset:288
    s_waitcnt lgkmcnt(0)
    v_mfma_f32_16x16x32_bf16 v[96:99], v[112:115], v[152:155], 0
    v_mfma_f32_16x16x32_bf16 v[96:99], v[116:119], v[156:159], v[96:99]
    ds_write_b128 v11, v[32:35]
    ds_write_b128 v11, v[36:39] offset:1024
    s_waitcnt lgkmcnt(0)
    ds_read_b64_tr_b16 v[152:153], v12 offset:0
    ds_read_b64_tr_b16 v[154:155], v12 offset:256
    ds_read_b64_tr_b16 v[156:157], v12 offset:32
    ds_read_b64_tr_b16 v[158:159], v12 offset:288
    s_waitcnt lgkmcnt(0)
    v_mfma_f32_16x16x32_bf16 v[96:99], v[120:123], v[152:155], v[96:99]
    v_mfma_f32_16x16x32_bf16 v[96:99], v[124:127], v[156:159], v[96:99]
    ds_write_b128 v11, v[40:43]
    ds_write_b128 v11, v[44:47] offset:1024
    s_waitcnt lgkmcnt(0)
    ds_read_b64_tr_b16 v[152:153], v12 offset:0
    ds_read_b64_tr_b16 v[154:155], v12 offset:256
    ds_read_b64_tr_b16 v[156:157], v12 offset:32
    ds_read_b64_tr_b16 v[158:159], v12 offset:288
    s_waitcnt lgkmcnt(0)
    v_mfma_f32_16x16x32_bf16 v[100:103], v[112:115], v[152:155], 0
    v_mfma_f32_16x16x32_bf16 v[100:103], v[116:119], v[156:159], v[100:103]
    ds_write_b128 v11, v[48:51]
    ds_write_b128 v11, v[52:55] offset:1024
    s_waitcnt lgkmcnt(0)
    ds_read_b64_tr_b16 v[152:153], v12 offset:0
    ds_read_b64_tr_b16 v[154:155], v12 offset:256
    ds_read_b64_tr_b16 v[156:157], v12 offset:32
    ds_read_b64_tr_b16 v[158:159], v12 offset:288
    s_waitcnt lgkmcnt(0)
    v_mfma_f32_16x16x32_bf16 v[100:103], v[120:123], v[152:155], v[100:103]
    v_mfma_f32_16x16x32_bf16 v[100:103], v[124:127], v[156:159], v[100:103]
    ds_write_b128 v11, v[56:59]
    ds_write_b128 v11, v[60:63] offset:1024
    s_waitcnt lgkmcnt(0)
    ds_read_b64_tr_b16 v[152:153], v12 offset:0
    ds_read_b64_tr_b16 v[154:155], v12 offset:256
    s_waitcnt lgkmcnt(0)
    v_mfma_f32_16x16x32_bf16 v[104:107], v[112:115], v[152:155], 0
    s_nop 7
    s_and_b32 s36, s2, 7
    s_mul_i32 s36, s36, 4608
    s_mul_i32 s37, s39, 576
    s_add_u32 s36, s36, s37
    s_add_u32 s36, s36, 161024
    s_add_u32 s37, s36, 2304
    v_lshlrev_b32 v13, 2, v0
    buffer_atomic_add_f32 v96, v13, s[52:55], s36 offen offset:0
    buffer_atomic_add_f32 v97, v13, s[52:55], s37 offen offset:0
    buffer_atomic_add_f32 v100, v13, s[52:55], s36 offen offset:256
    buffer_atomic_add_f32 v101, v13, s[52:55], s37 offen offset:256
    s_mov_b64 exec, 0xffff
    buffer_atomic_add_f32 v104, v13, s[52:55], s36 offen offset:512
    buffer_atomic_add_f32 v105, v13, s[52:55], s37 offen offset:512
    s_mov_b64 exec, -1
    s_waitcnt vmcnt(0)
    s_waitcnt lgkmcnt(0)
    v_mov_b32 v20, 163592
    v_mov_b32 v21, 1
    s_mov_b64 s[76:77], exec
    s_mov_b64 exec, 1
    ds_add_u32 v20, v21
    s_mov_b64 exec, s[76:77]
    s_mov_b32 s80, 0
L_hs2_120:
    ds_read_b32 v21, v20
    s_waitcnt lgkmcnt(0)
    v_readfirstlane_b32 s81, v21
    s_nop 0
    s_cmp_ge_u32 s81, 4
    s_cbranch_scc1 L_hs2d_121
    s_sleep 1
    s_add_u32 s80, s80, 1
    s_cmp_lt_u32 s80, 0x100000
    s_cbranch_scc1 L_hs2_120
L_hs2d_121:
    s_cmp_lg_u32 s39, 0
    s_cbranch_scc1 L_nof_122
    v_mov_b32 v8, 230656
    v_mov_b32 v9, 1
    s_mov_b64 exec, 1
    buffer_atomic_add v9, v8, s[52:55], 0 offen sc1
    s_mov_b64 exec, -1
L_nof_122:
L_noffn_114:
    s_mov_b32 s48, s12
    s_and_b32 s49, s13, 0xffff
    s_mov_b32 s50, 663552
    s_mov_b32 s51, 0x20000
    s_add_u32 s44, s30, 233472
    s_addc_u32 s45, s31, 0
    s_and_b32 s45, s45, 0xffff
    s_mov_b32 s46, 2359296
    s_mov_b32 s47, 0x20000
    v_mov_b32 v20, 163596
    s_mov_b32 s80, 0
L_rel_123:
    ds_read_b32 v21, v20
    s_waitcnt lgkmcnt(0)
    v_readfirstlane_b32 s81, v21
    s_nop 0
    s_cmp_ge_u32 s81, 512
    s_cbranch_scc1 L_reld_124
    s_sleep 16
    s_add_u32 s80, s80, 1
    s_cmp_lt_u32 s80, 0x400000
    s_cbranch_scc1 L_rel_123
L_reld_124:
    s_mul_i32 s36, s35, 144
    s_add_u32 s36, s36, 0
    s_lshl_b32 s37, s39, 11
    s_add_u32 m0, s37, 0
    s_nop 0
    buffer_load_dwordx4 v3, s[48:51], s36 offen lds
    s_lshl_b32 s37, s39, 11
    s_add_u32 m0, s37, 1024
    s_nop 0
    buffer_load_dwordx4 v4, s[48:51], s36 offen lds
    s_mul_i32 s36, s35, 144
    s_add_u32 s36, s36, 73728
    s_lshl_b32 s37, s39, 11
    s_add_u32 m0, s37, 9216
    s_nop 0
    buffer_load_dwordx4 v3, s[48:51], s36 offen lds
    s_lshl_b32 s37, s39, 11
    s_add_u32 m0, s37, 10240
    s_nop 0
    buffer_load_dwordx4 v4, s[48:51], s36 offen lds
    s_mul_i32 s36, s35, 144
    s_add_u32 s36, s36, 147456
    s_lshl_b32 s37, s39, 11
    s_add_u32 m0, s37, 18432
    s_nop 0
    buffer_load_dwordx4 v3, s[48:51], s36 offen lds
    s_lshl_b32 s37, s39, 11
    s_add_u32 m0, s37, 19456
    s_nop 0
    buffer_load_dwordx4 v4, s[48:51], s36 offen lds
    s_mul_i32 s36, s35, 144
    s_add_u32 s36, s36, 221184
    s_lshl_b32 s37, s39, 11
    s_add_u32 m0, s37, 27648
    s_nop 0
    buffer_load_dwordx4 v3, s[48:51], s36 offen lds
    s_lshl_b32 s37, s39, 11
    s_add_u32 m0, s37, 28672
    s_nop 0
    buffer_load_dwordx4 v4, s[48:51], s36 offen lds
    s_mul_i32 s36, s35, 144
    s_add_u32 s36, s36, 294912
    s_lshl_b32 s37, s39, 11
    s_add_u32 m0, s37, 36864
    s_nop 0
    buffer_load_dwordx4 v3, s[48:51], s36 offen lds
    s_lshl_b32 s37, s39, 11
    s_add_u32 m0, s37, 37888
    s_nop 0
    buffer_load_dwordx4 v4, s[48:51], s36 offen lds
    s_mul_i32 s36, s35, 144
    s_add_u32 s36, s36, 368640
    s_lshl_b32 s37, s39, 11
    s_add_u32 m0, s37, 46080
    s_nop 0
    buffer_load_dwordx4 v3, s[48:51], s36 offen lds
    s_lshl_b32 s37, s39, 11
    s_add_u32 m0, s37, 47104
    s_nop 0
    buffer_load_dwordx4 v4, s[48:51], s36 offen lds
    s_mul_i32 s36, s35, 144
    s_add_u32 s36, s36, 442368
    s_lshl_b32 s37, s39, 11
    s_add_u32 m0, s37, 55296
    s_nop 0
    buffer_load_dwordx4 v3, s[48:51], s36 offen lds
    s_lshl_b32 s37, s39, 11
    s_add_u32 m0, s37, 56320
    s_nop 0
    buffer_load_dwordx4 v4, s[48:51], s36 offen lds
    s_mul_i32 s36, s35, 144
    s_add_u32 s36, s36, 516096
    s_lshl_b32 s37, s39, 11
    s_add_u32 m0, s37, 64512
    s_nop 0
    buffer_load_dwordx4 v3, s[48:51], s36 offen lds
    s_lshl_b32 s37, s39, 11
    s_add_u32 m0, s37, 65536
    s_nop 0
    buffer_load_dwordx4 v4, s[48:51], s36 offen lds
    s_mul_i32 s36, s35, 144
    s_add_u32 s36, s36, 589824
    s_lshl_b32 s37, s39, 11
    s_add_u32 m0, s37, 73728
    s_nop 0
    buffer_load_dwordx4 v3, s[48:51], s36 offen lds
    s_lshl_b32 s37, s39, 11
    s_add_u32 m0, s37, 74752
    s_nop 0
    buffer_load_dwordx4 v4, s[48:51], s36 offen lds
    s_cmp_lg_u32 s39, 1
    s_cbranch_scc1 L_noupd_125
    s_sub_u32 s84, s42, s41
    s_sub_u32 s85, s43, s41
    s_min_u32 s86, s84, s85
    s_cmp_lt_u32 s86, 64
    s_cbranch_scc0 L_noupd_125
    s_mov_b32 s80, 0
    v_mov_b32 v8, 230656
L_ypoll_126:
    buffer_load_dword v9, v8, s[52:55], 0 offen sc1
    s_waitcnt vmcnt(0)
    v_readfirstlane_b32 s81, v9
    s_nop 0
    s_cmp_ge_u32 s81, 144
    s_cbranch_scc1 L_ydone_127
    s_sleep 8
    s_add_u32 s80, s80, 1
    s_cmp_lt_u32 s80, 0x40000
    s_cbranch_scc1 L_ypoll_126
L_ydone_127:
    v_lshlrev_b32 v8, 3, v0
    s_mul_i32 s36, s35, 288
    s_add_u32 s36, s36, 161024
    v_mov_b32 v10, 163624
    ds_read_b64 v[12:13], v10
    v_cmp_gt_u32 vcc, 36, v0
    s_nop 0
    s_and_saveexec_b64 s[76:77], vcc
    s_add_u32 s37, s36, 0
    buffer_load_dwordx2 v[24:25], v8, s[52:55], s37 offen sc1
    s_add_u32 s37, s36, 4608
    buffer_load_dwordx2 v[26:27], v8, s[52:55], s37 offen sc1
    s_add_u32 s37, s36, 9216
    buffer_load_dwordx2 v[28:29], v8, s[52:55], s37 offen sc1
    s_add_u32 s37, s36, 13824
    buffer_load_dwordx2 v[30:31], v8, s[52:55], s37 offen sc1
    s_add_u32 s37, s36, 18432
    buffer_load_dwordx2 v[32:33], v8, s[52:55], s37 offen sc1
    s_add_u32 s37, s36, 23040
    buffer_load_dwordx2 v[34:35], v8, s[52:55], s37 offen sc1
    s_add_u32 s37, s36, 27648
    buffer_load_dwordx2 v[36:37], v8, s[52:55], s37 offen sc1
    s_add_u32 s37, s36, 32256
    buffer_load_dwordx2 v[38:39], v8, s[52:55], s37 offen sc1
    s_add_u32 s37, s36, 2304
    buffer_load_dwordx2 v[40:41], v8, s[52:55], s37 offen sc1
    s_add_u32 s37, s36, 6912
    buffer_load_dwordx2 v[42:43], v8, s[52:55], s37 offen sc1
    s_add_u32 s37, s36, 11520
    buffer_load_dwordx2 v[44:45], v8, s[52:55], s37 offen sc1
    s_add_u32 s37, s36, 16128
    buffer_load_dwordx2 v[46:47], v8, s[52:55], s37 offen sc1
    s_add_u32 s37, s36, 20736
    buffer_load_dwordx2 v[48:49], v8, s[52:55], s37 offen sc1
    s_add_u32 s37, s36, 25344
    buffer_load_dwordx2 v[50:51], v8, s[52:55], s37 offen sc1
    s_add_u32 s37, s36, 29952
    buffer_load_dwordx2 v[52:53], v8, s[52:55], s37 offen sc1
    s_add_u32 s37, s36, 34560
    buffer_load_dwordx2 v[54:55], v8, s[52:55], s37 offen sc1
    s_waitcnt vmcnt(0) lgkmcnt(0)
    v_add_f32 v24, v24, v26
    v_add_f32 v25, v25, v27
    v_add_f32 v24, v24, v28
    v_add_f32 v25, v25, v29
    v_add_f32 v24, v24, v30
    v_add_f32 v25, v25, v31
    v_add_f32 v24, v24, v32
    v_add_f32 v25, v25, v33
    v_add_f32 v24, v24, v34
    v_add_f32 v25, v25, v35
    v_add_f32 v24, v24, v36
    v_add_f32 v25, v25, v37
    v_add_f32 v24, v24, v38
    v_add_f32 v25, v25, v39
    v_cvt_pk_bf16_f32 v24, v24, v24
    v_and_b32 v24, 0xffff0000, v24
    v_mul_f32 v24, v12, v24
    v_cvt_pk_bf16_f32 v24, v24, v24
    v_and_b32 v24, 0xffff0000, v24
    v_cvt_pk_bf16_f32 v25, v25, v25
    v_and_b32 v25, 0xffff0000, v25
    v_mul_f32 v25, v12, v25
    v_cvt_pk_bf16_f32 v25, v25, v25
    v_and_b32 v25, 0xffff0000, v25
    v_add_u32 v10, 160896, v8
    ds_write_b64 v10, v[24:25]
    v_add_f32 v40, v40, v42
    v_add_f32 v41, v41, v43
    v_add_f32 v40, v40, v44
    v_add_f32 v41, v41, v45
    v_add_f32 v40, v40, v46
    v_add_f32 v41, v41, v47
    v_add_f32 v40, v40, v48
    v_add_f32 v41, v41, v49
    v_add_f32 v40, v40, v50
    v_add_f32 v41, v41, v51
    v_add_f32 v40, v40, v52
    v_add_f32 v41, v41, v53
    v_add_f32 v40, v40, v54
    v_add_f32 v41, v41, v55
    v_cvt_pk_bf16_f32 v40, v40, v40
    v_and_b32 v40, 0xffff0000, v40
    v_mul_f32 v40, v13, v40
    v_cvt_pk_bf16_f32 v40, v40, v40
    v_and_b32 v40, 0xffff0000, v40
    v_cvt_pk_bf16_f32 v41, v41, v41
    v_and_b32 v41, 0xffff0000, v41
    v_mul_f32 v41, v13, v41
    v_cvt_pk_bf16_f32 v41, v41, v41
    v_and_b32 v41, 0xffff0000, v41
    v_add_u32 v10, 161184, v8
    ds_write_b64 v10, v[40:41]
    s_mov_b64 exec, -1
    s_waitcnt lgkmcnt(0)
L_noupd_125:
    s_waitcnt vmcnt(0)
    v_add_u32 v26, 512, v0
    v_lshlrev_b32 v24, 4, v26
    v_add_u32 v24, 115712, v24
    v_mul_u32_u24 v27, 7282, v26
    v_lshrrev_b32 v27, 16, v27
    v_mul_u32_u24 v28, 9, v27
    v_sub_u32 v28, v26, v28
    v_mul_u32_u24 v27, 1152, v27
    v_lshl_add_u32 v25, v28, 4, v27
    s_mul_i32 s84, s41, 1152
    s_mul_i32 s36, s35, 144
    s_add_u32 s84, s84, s36
    s_add_u32 s85, s84, 233472
    s_barrier
    s_barrier
    s_barrier
    s_cmp_lg_u32 s39, 1
    s_cbranch_scc1 L_no8_128
    ds_read_b128 v[28:31], v24
    s_waitcnt lgkmcnt(0)
    buffer_store_dwordx4 v[28:31], v25, s[52:55], s85 offen sc1
    s_waitcnt vmcnt(0)
L_no8_128:
    s_barrier
    s_cmp_lg_u32 s39, 0
    s_cbranch_scc1 L_grpskip_129
    s_mov_b32 s80, 0
    s_lshl_b32 s36, s34, 10
    s_add_u32 s36, s36, 198656
    v_mov_b32 v8, s36
L_grplp_130:
    buffer_load_dword v144, v8, s[52:55], 0 offen sc1
L_grpchk_132:
    s_waitcnt vmcnt(0)
    v_mov_b32 v10, 8
    v_cmp_le_u32 vcc, v10, v144
    s_nop 1
    s_not_b64 s[82:83], vcc
    s_cmp_eq_u64 s[82:83], 0
    s_cbranch_scc1 L_grpok_131
    s_sleep 1
    s_add_u32 s80, s80, 1
    s_cmp_lt_u32 s80, 0x80000
    s_cbranch_scc1 L_grplp_130
L_grpok_131:
L_grpskip_129:
    s_barrier
    s_mul_i32 s38, s41, 1152
    s_mul_i32 s36, s39, 18432
    s_add_u32 s36, s36, s38
    s_add_u32 s36, s36, 0
    s_lshl_b32 s37, s39, 11
    s_add_u32 m0, s37, 82944
    s_nop 0
    buffer_load_dwordx4 v1, s[44:47], s36 offen lds
    s_mul_i32 s36, s39, 18432
    s_add_u32 s36, s36, s38
    s_add_u32 s36, s36, 9216
    s_lshl_b32 s37, s39, 11
    s_add_u32 m0, s37, 83968
    s_nop 0
    buffer_load_dwordx4 v2, s[44:47], s36 offen lds
    s_mul_i32 s36, s39, 18432
    s_add_u32 s36, s36, s38
    s_add_u32 s36, s36, 128
    s_lshl_b32 s37, s39, 11
    s_add_u32 m0, s37, 91136
    s_nop 0
    buffer_load_dwordx4 v1, s[44:47], s36 offen lds
    s_mul_i32 s36, s39, 18432
    s_add_u32 s36, s36, s38
    s_add_u32 s36, s36, 9344
    s_lshl_b32 s37, s39, 11
    s_add_u32 m0, s37, 92160
    s_nop 0
    buffer_load_dwordx4 v2, s[44:47], s36 offen lds
    s_mul_i32 s36, s39, 18432
    s_add_u32 s36, s36, s38
    s_add_u32 s36, s36, 256
    s_lshl_b32 s37, s39, 11
    s_add_u32 m0, s37, 99328
    s_nop 0
    buffer_load_dwordx4 v1, s[44:47], s36 offen lds
    s_mul_i32 s36, s39, 18432
    s_add_u32 s36, s36, s38
    s_add_u32 s36, s36, 9472
    s_lshl_b32 s37, s39, 11
    s_add_u32 m0, s37, 100352
    s_nop 0
    buffer_load_dwordx4 v2, s[44:47], s36 offen lds
    s_mul_i32 s36, s39, 18432
    s_add_u32 s36, s36, s38
    s_add_u32 s36, s36, 384
    s_lshl_b32 s37, s39, 11
    s_add_u32 m0, s37, 107520
    s_nop 0
    buffer_load_dwordx4 v1, s[44:47], s36 offen lds
    s_mul_i32 s36, s39, 18432
    s_add_u32 s36, s36, s38
    s_add_u32 s36, s36, 9600
    s_lshl_b32 s37, s39, 11
    s_add_u32 m0, s37, 108544
    s_nop 0
    buffer_load_dwordx4 v2, s[44:47], s36 offen lds
    s_mul_i32 s36, s39, 18432
    s_add_u32 s36, s36, s38
    s_add_u32 s36, s36, 512
    s_lshl_b32 s37, s39, 11
    s_add_u32 m0, s37, 115712
    s_nop 0
    buffer_load_dwordx4 v1, s[44:47], s36 offen lds
    s_mul_i32 s36, s39, 18432
    s_add_u32 s36, s36, s38
    s_add_u32 s36, s36, 9728
    s_lshl_b32 s37, s39, 11
    s_add_u32 m0, s37, 116736
    s_nop 0
    buffer_load_dwordx4 v2, s[44:47], s36 offen lds
    s_mul_i32 s36, s39, 18432
    s_add_u32 s36, s36, s38
    s_add_u32 s36, s36, 640
    s_lshl_b32 s37, s39, 11
    s_add_u32 m0, s37, 123904
    s_nop 0
    buffer_load_dwordx4 v1, s[44:47], s36 offen lds
    s_mul_i32 s36, s39, 18432
    s_add_u32 s36, s36, s38
    s_add_u32 s36, s36, 9856
    s_lshl_b32 s37, s39, 11
    s_add_u32 m0, s37, 124928
    s_nop 0
    buffer_load_dwordx4 v2, s[44:47], s36 offen lds
    s_mul_i32 s36, s39, 18432
    s_add_u32 s36, s36, s38
    s_add_u32 s36, s36, 768
    s_lshl_b32 s37, s39, 11
    s_add_u32 m0, s37, 132096
    s_nop 0
    buffer_load_dwordx4 v1, s[44:47], s36 offen lds
    s_mul_i32 s36, s39, 18432
    s_add_u32 s36, s36, s38
    s_add_u32 s36, s36, 9984
    s_lshl_b32 s37, s39, 11
    s_add_u32 m0, s37, 133120
    s_nop 0
    buffer_load_dwordx4 v2, s[44:47], s36 offen lds
    s_mul_i32 s36, s39, 18432
    s_add_u32 s36, s36, s38
    s_add_u32 s36, s36, 896
    s_lshl_b32 s37, s39, 11
    s_add_u32 m0, s37, 140288
    s_nop 0
    buffer_load_dwordx4 v1, s[44:47], s36 offen lds
    s_mul_i32 s36, s39, 18432
    s_add_u32 s36, s36, s38
    s_add_u32 s36, s36, 10112
    s_lshl_b32 s37, s39, 11
    s_add_u32 m0, s37, 141312
    s_nop 0
    buffer_load_dwordx4 v2, s[44:47], s36 offen lds
    s_mul_i32 s36, s39, 18432
    s_add_u32 s36, s36, s38
    s_add_u32 s36, s36, 1024
    s_lshl_b32 s37, s39, 11
    s_add_u32 m0, s37, 148480
    s_nop 0
    buffer_load_dwordx4 v1, s[44:47], s36 offen lds
    s_mul_i32 s36, s39, 18432
    s_add_u32 s36, s36, s38
    s_add_u32 s36, s36, 10240
    s_lshl_b32 s37, s39, 11
    s_add_u32 m0, s37, 149504
    s_nop 0
    buffer_load_dwordx4 v2, s[44:47], s36 offen lds
    s_waitcnt vmcnt(14)
    s_barrier
    s_waitcnt vmcnt(8)
    s_barrier
    s_waitcnt vmcnt(0)
    s_barrier
    s_barrier
    s_cmp_lg_u32 s39, 1
    s_cbranch_scc1 L_no9_133
    v_subrev_u32 v24, 115712, v24
    ds_read_b128 v[28:31], v24
    s_waitcnt lgkmcnt(0)
    buffer_store_dwordx4 v[28:31], v25, s[64:67], s84 offen
L_no9_133:
    s_endpgm
L_h3_86:
    s_cmp_lt_u32 s35, 3
    s_cbranch_scc1 L_hduty_134
    s_mul_i32 s36, s35, 144
    s_add_u32 s36, s36, 0
    s_lshl_b32 s37, s39, 11
    s_add_u32 m0, s37, 73728
    s_nop 0
    buffer_load_dwordx4 v3, s[48:51], s36 offen lds
    s_lshl_b32 s37, s39, 11
    s_add_u32 m0, s37, 74752
    s_nop 0
    buffer_load_dwordx4 v4, s[48:51], s36 offen lds
    s_mov_b32 m0, 81920
    s_nop 0
    buffer_load_dwordx4 v5, s[48:51], s36 offen lds
    s_mul_i32 s36, s35, 144
    s_add_u32 s36, s36, 73728
    s_lshl_b32 s37, s39, 11
    s_add_u32 m0, s37, 82944
    s_nop 0
    buffer_load_dwordx4 v3, s[48:51], s36 offen lds
    s_lshl_b32 s37, s39, 11
    s_add_u32 m0, s37, 83968
    s_nop 0
    buffer_load_dwordx4 v4, s[48:51], s36 offen lds
    s_mov_b32 m0, 91136
    s_nop 0
    buffer_load_dwordx4 v5, s[48:51], s36 offen lds
    s_mul_i32 s36, s35, 144
    s_add_u32 s36, s36, 147456
    s_lshl_b32 s37, s39, 11
    s_add_u32 m0, s37, 92160
    s_nop 0
    buffer_load_dwordx4 v3, s[48:51], s36 offen lds
    s_lshl_b32 s37, s39, 11
    s_add_u32 m0, s37, 93184
    s_nop 0
    buffer_load_dwordx4 v4, s[48:51], s36 offen lds
    s_mov_b32 m0, 100352
    s_nop 0
    buffer_load_dwordx4 v5, s[48:51], s36 offen lds
    s_mul_i32 s36, s35, 144
    s_add_u32 s36, s36, 221184
    s_lshl_b32 s37, s39, 11
    s_add_u32 m0, s37, 101376
    s_nop 0
    buffer_load_dwordx4 v3, s[48:51], s36 offen lds
    s_lshl_b32 s37, s39, 11
    s_add_u32 m0, s37, 102400
    s_nop 0
    buffer_load_dwordx4 v4, s[48:51], s36 offen lds
    s_mov_b32 m0, 109568
    s_nop 0
    buffer_load_dwordx4 v5, s[48:51], s36 offen lds
    s_mul_i32 s36, s35, 144
    s_add_u32 s36, s36, 294912
    s_lshl_b32 s37, s39, 11
    s_add_u32 m0, s37, 110592
    s_nop 0
    buffer_load_dwordx4 v3, s[48:51], s36 offen lds
    s_lshl_b32 s37, s39, 11
    s_add_u32 m0, s37, 111616
    s_nop 0
    buffer_load_dwordx4 v4, s[48:51], s36 offen lds
    s_mov_b32 m0, 118784
    s_nop 0
    buffer_load_dwordx4 v5, s[48:51], s36 offen lds
    s_mul_i32 s36, s35, 144
    s_add_u32 s36, s36, 368640
    s_lshl_b32 s37, s39, 11
    s_add_u32 m0, s37, 119808
    s_nop 0
    buffer_load_dwordx4 v3, s[48:51], s36 offen lds
    s_lshl_b32 s37, s39, 11
    s_add_u32 m0, s37, 120832
    s_nop 0
    buffer_load_dwordx4 v4, s[48:51], s36 offen lds
    s_mov_b32 m0, 128000
    s_nop 0
    buffer_load_dwordx4 v5, s[48:51], s36 offen lds
    s_mul_i32 s36, s35, 144
    s_add_u32 s36, s36, 442368
    s_lshl_b32 s37, s39, 11
    s_add_u32 m0, s37, 129024
    s_nop 0
    buffer_load_dwordx4 v3, s[48:51], s36 offen lds
    s_lshl_b32 s37, s39, 11
    s_add_u32 m0, s37, 130048
    s_nop 0
    buffer_load_dwordx4 v4, s[48:51], s36 offen lds
    s_mov_b32 m0, 137216
    s_nop 0
    buffer_load_dwordx4 v5, s[48:51], s36 offen lds
    s_mul_i32 s36, s35, 144
    s_add_u32 s36, s36, 516096
    s_lshl_b32 s37, s39, 11
    s_add_u32 m0, s37, 138240
    s_nop 0
    buffer_load_dwordx4 v3, s[48:51], s36 offen lds
    s_lshl_b32 s37, s39, 11
    s_add_u32 m0, s37, 139264
    s_nop 0
    buffer_load_dwordx4 v4, s[48:51], s36 offen lds
    s_mov_b32 m0, 146432
    s_nop 0
    buffer_load_dwordx4 v5, s[48:51], s36 offen lds
    s_mul_i32 s36, s35, 144
    s_add_u32 s36, s36, 589824
    s_lshl_b32 s37, s39, 11
    s_add_u32 m0, s37, 147456
    s_nop 0
    buffer_load_dwordx4 v3, s[48:51], s36 offen lds
    s_lshl_b32 s37, s39, 11
    s_add_u32 m0, s37, 148480
    s_nop 0
    buffer_load_dwordx4 v4, s[48:51], s36 offen lds
    s_mov_b32 m0, 155648
    s_nop 0
    buffer_load_dwordx4 v5, s[48:51], s36 offen lds
    s_waitcnt vmcnt(27)
    s_barrier
    s_waitcnt vmcnt(21)
    s_barrier
    s_waitcnt vmcnt(15)
    s_barrier
    s_waitcnt vmcnt(9)
    s_barrier
    v_mov_b32 v147, 0
    s_sub_u32 s36, s39, 1
    s_cmp_lt_u32 s36, 2
    s_cbranch_scc1 L_iissue_136
    buffer_load_dword v146, v147, s[68:71], 0 offen
L_iissue_136:
    s_waitcnt vmcnt(0)
    s_barrier
    s_sub_u32 s36, s39, 1
    s_cmp_lt_u32 s36, 2
    s_cbranch_scc1 L_icheck_137
    s_waitcnt vmcnt(0)
    s_mov_b32 s80, 0
L_icheckp_138:
    v_readfirstlane_b32 s81, v146
    s_nop 0
    s_cmp_ge_u32 s81, 32
    s_cbranch_scc1 L_icheck_137
    s_sleep 8
    buffer_load_dword v146, v147, s[68:71], 0 offen sc1
    s_waitcnt vmcnt(0)
    s_add_u32 s80, s80, 1
    s_cmp_lt_u32 s80, 0x40000
    s_cbranch_scc1 L_icheckp_138
L_icheck_137:
    s_cmp_lg_u32 s39, 0
    s_cbranch_scc1 L_pissue_139
    v_and_b32 v8, 1, v0
    v_lshlrev_b32 v8, 2, v8
    v_and_b32 v9, 2, v0
    v_lshl_add_u32 v8, v9, 7, v8
    s_lshl_b32 s36, s34, 10
    s_add_u32 s36, s36, 197888
    v_add_u32 v8, s36, v8
    buffer_load_dword v144, v8, s[52:55], 0 offen sc1
L_pissue_139:
    s_barrier
    s_branch L_hj_135
L_hduty_134:
    s_mul_i32 s36, s35, 144
    s_add_u32 s36, s36, 0
    s_lshl_b32 s37, s39, 11
    s_add_u32 m0, s37, 73728
    s_nop 0
    buffer_load_dwordx4 v3, s[48:51], s36 offen lds
    s_lshl_b32 s37, s39, 11
    s_add_u32 m0, s37, 74752
    s_nop 0
    buffer_load_dwordx4 v4, s[48:51], s36 offen lds
    s_mov_b32 m0, 81920
    s_nop 0
    buffer_load_dwordx4 v5, s[48:51], s36 offen lds
    s_mul_i32 s36, s35, 144
    s_add_u32 s36, s36, 73728
    s_lshl_b32 s37, s39, 11
    s_add_u32 m0, s37, 82944
    s_nop 0
    buffer_load_dwordx4 v3, s[48:51], s36 offen lds
    s_lshl_b32 s37, s39, 11
    s_add_u32 m0, s37, 83968
    s_nop 0
    buffer_load_dwordx4 v4, s[48:51], s36 offen lds
    s_mov_b32 m0, 91136
    s_nop 0
    buffer_load_dwordx4 v5, s[48:51], s36 offen lds
    s_mul_i32 s36, s35, 144
    s_add_u32 s36, s36, 147456
    s_lshl_b32 s37, s39, 11
    s_add_u32 m0, s37, 92160
    s_nop 0
    buffer_load_dwordx4 v3, s[48:51], s36 offen lds
    s_lshl_b32 s37, s39, 11
    s_add_u32 m0, s37, 93184
    s_nop 0
    buffer_load_dwordx4 v4, s[48:51], s36 offen lds
    s_mov_b32 m0, 100352
    s_nop 0
    buffer_load_dwordx4 v5, s[48:51], s36 offen lds
    s_mul_i32 s36, s35, 144
    s_add_u32 s36, s36, 221184
    s_lshl_b32 s37, s39, 11
    s_add_u32 m0, s37, 101376
    s_nop 0
    buffer_load_dwordx4 v3, s[48:51], s36 offen lds
    s_lshl_b32 s37, s39, 11
    s_add_u32 m0, s37, 102400
    s_nop 0
    buffer_load_dwordx4 v4, s[48:51], s36 offen lds
    s_mov_b32 m0, 109568
    s_nop 0
    buffer_load_dwordx4 v5, s[48:51], s36 offen lds
    s_mul_i32 s36, s35, 144
    s_add_u32 s36, s36, 294912
    s_lshl_b32 s37, s39, 11
    s_add_u32 m0, s37, 110592
    s_nop 0
    buffer_load_dwordx4 v3, s[48:51], s36 offen lds
    s_lshl_b32 s37, s39, 11
    s_add_u32 m0, s37, 111616
    s_nop 0
    buffer_load_dwordx4 v4, s[48:51], s36 offen lds
    s_mov_b32 m0, 118784
    s_nop 0
    buffer_load_dwordx4 v5, s[48:51], s36 offen lds
    s_mul_i32 s36, s35, 144
    s_add_u32 s36, s36, 368640
    s_lshl_b32 s37, s39, 11
    s_add_u32 m0, s37, 119808
    s_nop 0
    buffer_load_dwordx4 v3, s[48:51], s36 offen lds
    s_lshl_b32 s37, s39, 11
    s_add_u32 m0, s37, 120832
    s_nop 0
    buffer_load_dwordx4 v4, s[48:51], s36 offen lds
    s_mov_b32 m0, 128000
    s_nop 0
    buffer_load_dwordx4 v5, s[48:51], s36 offen lds
    s_waitcnt vmcnt(18)
    s_barrier
    s_barrier
    s_mul_i32 s36, s35, 144
    s_add_u32 s36, s36, 442368
    s_lshl_b32 s37, s39, 11
    s_add_u32 m0, s37, 129024
    s_nop 0
    buffer_load_dwordx4 v3, s[48:51], s36 offen lds
    s_lshl_b32 s37, s39, 11
    s_add_u32 m0, s37, 130048
    s_nop 0
    buffer_load_dwordx4 v4, s[48:51], s36 offen lds
    s_mov_b32 m0, 137216
    s_nop 0
    buffer_load_dwordx4 v5, s[48:51], s36 offen lds
    s_mul_i32 s36, s35, 144
    s_add_u32 s36, s36, 516096
    s_lshl_b32 s37, s39, 11
    s_add_u32 m0, s37, 138240
    s_nop 0
    buffer_load_dwordx4 v3, s[48:51], s36 offen lds
    s_lshl_b32 s37, s39, 11
    s_add_u32 m0, s37, 139264
    s_nop 0
    buffer_load_dwordx4 v4, s[48:51], s36 offen lds
    s_mov_b32 m0, 146432
    s_nop 0
    buffer_load_dwordx4 v5, s[48:51], s36 offen lds
    s_mul_i32 s36, s35, 144
    s_add_u32 s36, s36, 589824
    s_lshl_b32 s37, s39, 11
    s_add_u32 m0, s37, 147456
    s_nop 0
    buffer_load_dwordx4 v3, s[48:51], s36 offen lds
    s_lshl_b32 s37, s39, 11
    s_add_u32 m0, s37, 148480
    s_nop 0
    buffer_load_dwordx4 v4, s[48:51], s36 offen lds
    s_mov_b32 m0, 155648
    s_nop 0
    buffer_load_dwordx4 v5, s[48:51], s36 offen lds
    s_waitcnt vmcnt(9)
    s_barrier
    v_mov_b32 v147, 0
    s_sub_u32 s36, s39, 1
    s_cmp_lt_u32 s36, 2
    s_cbranch_scc1 L_iissue_140
    buffer_load_dword v146, v147, s[68:71], 0 offen
L_iissue_140:
    s_waitcnt vmcnt(0)
    s_barrier
    s_sub_u32 s36, s39, 1
    s_cmp_lt_u32 s36, 2
    s_cbranch_scc1 L_icheck_141
    s_waitcnt vmcnt(0)
    s_mov_b32 s80, 0
L_icheckp_142:
    v_readfirstlane_b32 s81, v146
    s_nop 0
    s_cmp_ge_u32 s81, 32
    s_cbranch_scc1 L_icheck_141
    s_sleep 8
    buffer_load_dword v146, v147, s[68:71], 0 offen sc1
    s_waitcnt vmcnt(0)
    s_add_u32 s80, s80, 1
    s_cmp_lt_u32 s80, 0x40000
    s_cbranch_scc1 L_icheckp_142
L_icheck_141:
    s_cmp_lg_u32 s35, 0
    s_cbranch_scc1 L_nopk_143
    s_cmp_lg_u32 s39, 3
    s_cbranch_scc1 L_nopk_143
    v_lshrrev_b32 v8, 5, v0
    v_and_b32 v9, 31, v0
    v_lshlrev_b32 v10, 10, v8
    v_lshl_add_u32 v10, v9, 4, v10
    v_add_u32 v10, 156672, v10
    v_lshlrev_b32 v11, 3, v9
    v_lshl_add_u32 v11, v8, 2, v11
    v_add_u32 v11, 158720, v11
    ds_read_b128 v[28:31], v10
    ds_read_b128 v[32:35], v10 offset:512
    ds_read_b32 v36, v11
    s_waitcnt lgkmcnt(0)
    v_dot2_f32_bf16 v8, v28, v28, 0
    v_dot2_f32_bf16 v8, v29, v29, v8
    v_dot2_f32_bf16 v8, v30, v30, v8
    v_dot2_f32_bf16 v8, v31, v31, v8
    v_dot2_f32_bf16 v8, v32, v32, v8
    v_dot2_f32_bf16 v8, v33, v33, v8
    v_dot2_f32_bf16 v8, v34, v34, v8
    v_dot2_f32_bf16 v8, v35, v35, v8
    v_dot2_f32_bf16 v8, v36, v36, v8
    s_nop 2
    v_max_f32_dpp v8, v8, v8 row_ror:1 row_mask:0xf bank_mask:0xf
    s_nop 1
    v_max_f32_dpp v8, v8, v8 row_ror:2 row_mask:0xf bank_mask:0xf
    s_nop 1
    v_max_f32_dpp v8, v8, v8 row_ror:4 row_mask:0xf bank_mask:0xf
    s_nop 1
    v_max_f32_dpp v8, v8, v8 row_ror:8 row_mask:0xf bank_mask:0xf
    s_nop 0
    v_readlane_b32 s80, v8, 0
    v_readlane_b32 s81, v8, 16
    s_nop 0
    s_max_u32 s80, s80, s81
    v_readlane_b32 s81, v8, 32
    s_nop 0
    s_max_u32 s80, s80, s81
    v_readlane_b32 s81, v8, 48
    s_nop 0
    s_max_u32 s80, s80, s81
    v_mov_b32 v8, s80
    v_mul_f32 v8, 0x3f8020c5, v8
    v_or_b32 v8, 1, v8
    s_lshl_b32 s36, s34, 2
    s_add_u32 s36, s36, 198784
    v_lshlrev_b32 v9, 10, v0
    v_cmp_gt_u32 vcc, 32, v0
    s_nop 0
    s_and_saveexec_b64 s[76:77], vcc
    buffer_store_dword v8, v9, s[52:55], s36 offen sc1
    s_mov_b64 exec, s[76:77]
L_nopk_143:
    s_cmp_lg_u32 s39, 0
    s_cbranch_scc1 L_pissue_144
    v_and_b32 v8, 1, v0
    v_lshlrev_b32 v8, 2, v8
    v_and_b32 v9, 2, v0
    v_lshl_add_u32 v8, v9, 7, v8
    s_lshl_b32 s36, s34, 10
    s_add_u32 s36, s36, 197888
    v_add_u32 v8, s36, v8
    buffer_load_dword v144, v8, s[52:55], 0 offen sc1
L_pissue_144:
    s_barrier
L_hj_135:
    s_cmp_lg_u32 s39, 0
    s_cbranch_scc1 L_kv0skip_145
    s_mov_b32 s80, 0
    s_branch L_kv0chk_148
L_kv0lp_146:
    buffer_load_dword v144, v8, s[52:55], 0 offen sc1
L_kv0chk_148:
    s_waitcnt vmcnt(0)
    v_mov_b32 v10, 0x01010101
    v_cmp_eq_u32 vcc, v10, v144
    s_nop 1
    s_not_b64 s[82:83], vcc
    s_cmp_eq_u64 s[82:83], 0
    s_cbranch_scc1 L_kv0ok_147
    s_sleep 1
    s_add_u32 s80, s80, 1
    s_cmp_lt_u32 s80, 0x80000
    s_cbranch_scc1 L_kv0lp_146
L_kv0ok_147:
L_kv0skip_145:
    s_barrier
    s_lshl_b32 s37, s39, 10
    s_add_u32 s36, s37, 0
    s_mov_b32 m0, s36
    s_nop 0
    buffer_load_dwordx4 v6, s[60:63], s36 offen lds
    s_add_u32 s36, s37, 4096
    s_mov_b32 m0, s36
    s_nop 0
    buffer_load_dwordx4 v6, s[60:63], s36 offen lds
    s_add_u32 s36, s37, 8192
    s_mov_b32 m0, s36
    s_nop 0
    buffer_load_dwordx4 v6, s[60:63], s36 offen lds
    s_add_u32 s36, s37, 12288
    s_mov_b32 m0, s36
    s_nop 0
    buffer_load_dwordx4 v6, s[60:63], s36 offen lds
    s_add_u32 s36, s37, 16384
    s_mov_b32 m0, s36
    s_nop 0
    buffer_load_dwordx4 v6, s[60:63], s36 offen lds
    s_add_u32 s36, s37, 20480
    s_mov_b32 m0, s36
    s_nop 0
    buffer_load_dwordx4 v6, s[60:63], s36 offen lds
    s_add_u32 s36, s37, 24576
    s_mov_b32 m0, s36
    s_nop 0
    buffer_load_dwordx4 v6, s[60:63], s36 offen lds
    s_add_u32 s36, s37, 28672
    s_mov_b32 m0, s36
    s_nop 0
    buffer_load_dwordx4 v6, s[60:63], s36 offen lds
    s_add_u32 s36, s37, 32768
    s_mov_b32 m0, s36
    s_nop 0
    buffer_load_dwordx4 v6, s[60:63], s36 offen lds
    s_cmp_ge_u32 s39, 1
    s_cbranch_scc1 L_kvt_149
    s_add_u32 s36, s37, 36864
    s_mov_b32 m0, s36
    s_nop 0
    buffer_load_dwordx4 v6, s[60:63], s36 offen lds
L_kvt_149:
    s_waitcnt vmcnt(0)
    s_barrier
    s_cmp_lg_u32 s39, 0
    s_cbranch_scc1 L_kvpskip_150
    s_mov_b32 s80, 0
    v_min_u32 v8, 23, v0
    v_and_b32 v9, 3, v8
    v_lshrrev_b32 v8, 2, v8
    v_lshlrev_b32 v8, 7, v8
    v_lshl_add_u32 v8, v9, 2, v8
    s_lshl_b32 s36, s34, 10
    s_add_u32 s36, s36, 197888
    v_add_u32 v8, s36, v8
L_kvplp_151:
    buffer_load_dword v144, v8, s[52:55], 0 offen sc1
L_kvpchk_153:
    s_waitcnt vmcnt(0)
    v_mov_b32 v10, 0x01010101
    v_cmp_eq_u32 vcc, v10, v144
    s_nop 1
    s_not_b64 s[82:83], vcc
    s_cmp_eq_u64 s[82:83], 0
    s_cbranch_scc1 L_kvpok_152
    s_sleep 1
    s_add_u32 s80, s80, 1
    s_cmp_lt_u32 s80, 0x80000
    s_cbranch_scc1 L_kvplp_151
L_kvpok_152:
L_kvpskip_150:
    s_waitcnt lgkmcnt(0)
    v_mov_b32 v20, 163600
    v_mov_b32 v21, 1
    s_mov_b64 s[76:77], exec
    s_mov_b64 exec, 1
    ds_add_u32 v20, v21
    s_mov_b64 exec, s[76:77]
    s_mov_b32 s80, 0
L_hsall_154:
    ds_read_b32 v21, v20
    s_waitcnt lgkmcnt(0)
    v_readfirstlane_b32 s81, v21
    s_nop 0
    s_cmp_ge_u32 s81, 4
    s_cbranch_scc1 L_hsalld_155
    s_sleep 4
    s_add_u32 s80, s80, 1
    s_cmp_lt_u32 s80, 0x100000
    s_cbranch_scc1 L_hsall_154
L_hsalld_155:
    s_mov_b32 s36, 160000
    buffer_load_dwordx4 v[148:151], v6, s[52:55], s36 offen
    s_lshl_b32 s37, s39, 10
    s_add_u32 s36, s37, 37888
    s_mov_b32 m0, s36
    s_nop 0
    buffer_load_dwordx4 v6, s[60:63], s36 offen lds
    s_add_u32 s36, s37, 41984
    s_mov_b32 m0, s36
    s_nop 0
    buffer_load_dwordx4 v6, s[60:63], s36 offen lds
    s_add_u32 s36, s37, 46080
    s_mov_b32 m0, s36
    s_nop 0
    buffer_load_dwordx4 v6, s[60:63], s36 offen lds
    s_add_u32 s36, s37, 50176
    s_mov_b32 m0, s36
    s_nop 0
    buffer_load_dwordx4 v6, s[60:63], s36 offen lds
    s_add_u32 s36, s37, 54272
    s_mov_b32 m0, s36
    s_nop 0
    buffer_load_dwordx4 v6, s[60:63], s36 offen lds
    s_add_u32 s36, s37, 58368
    s_mov_b32 m0, s36
    s_nop 0
    buffer_load_dwordx4 v6, s[60:63], s36 offen lds
    s_add_u32 s36, s37, 62464
    s_mov_b32 m0, s36
    s_nop 0
    buffer_load_dwordx4 v6, s[60:63], s36 offen lds
    s_add_u32 s36, s37, 66560
    s_mov_b32 m0, s36
    s_nop 0
    buffer_load_dwordx4 v6, s[60:63], s36 offen lds
    s_add_u32 s36, s37, 70656
    s_mov_b32 m0, s36
    s_nop 0
    buffer_load_dwordx4 v6, s[60:63], s36 offen lds
    s_add_u32 s36, s37, 74752
    s_mov_b32 m0, s36
    s_nop 0
    buffer_load_dwordx4 v6, s[60:63], s36 offen lds
    s_add_u32 s36, s37, 78848
    s_mov_b32 m0, s36
    s_nop 0
    buffer_load_dwordx4 v6, s[60:63], s36 offen lds
    s_add_u32 s36, s37, 82944
    s_mov_b32 m0, s36
    s_nop 0
    buffer_load_dwordx4 v6, s[60:63], s36 offen lds
    s_add_u32 s36, s37, 87040
    s_mov_b32 m0, s36
    s_nop 0
    buffer_load_dwordx4 v6, s[60:63], s36 offen lds
    s_add_u32 s36, s37, 91136
    s_mov_b32 m0, s36
    s_nop 0
    buffer_load_dwordx4 v6, s[60:63], s36 offen lds
    s_add_u32 s36, s37, 95232
    s_mov_b32 m0, s36
    s_nop 0
    buffer_load_dwordx4 v6, s[60:63], s36 offen lds
    s_add_u32 s36, s37, 99328
    s_mov_b32 m0, s36
    s_nop 0
    buffer_load_dwordx4 v6, s[60:63], s36 offen lds
    s_add_u32 s36, s37, 103424
    s_mov_b32 m0, s36
    s_nop 0
    buffer_load_dwordx4 v6, s[60:63], s36 offen lds
    s_add_u32 s36, s37, 107520
    s_mov_b32 m0, s36
    s_nop 0
    buffer_load_dwordx4 v6, s[60:63], s36 offen lds
    s_add_u32 s36, s37, 111616
    s_mov_b32 m0, s36
    s_nop 0
    buffer_load_dwordx4 v6, s[60:63], s36 offen lds
    s_add_u32 s36, s37, 115712
    s_mov_b32 m0, s36
    s_nop 0
    buffer_load_dwordx4 v6, s[60:63], s36 offen lds
    s_add_u32 s36, s37, 119808
    s_mov_b32 m0, s36
    s_nop 0
    buffer_load_dwordx4 v6, s[60:63], s36 offen lds
    s_add_u32 s36, s37, 123904
    s_mov_b32 m0, s36
    s_nop 0
    buffer_load_dwordx4 v6, s[60:63], s36 offen lds
    s_add_u32 s36, s37, 128000
    s_mov_b32 m0, s36
    s_nop 0
    buffer_load_dwordx4 v6, s[60:63], s36 offen lds
    s_add_u32 s36, s37, 132096
    s_mov_b32 m0, s36
    s_nop 0
    buffer_load_dwordx4 v6, s[60:63], s36 offen lds
    s_add_u32 s36, s37, 136192
    s_mov_b32 m0, s36
    s_nop 0
    buffer_load_dwordx4 v6, s[60:63], s36 offen lds
    s_add_u32 s36, s37, 140288
    s_mov_b32 m0, s36
    s_nop 0
    buffer_load_dwordx4 v6, s[60:63], s36 offen lds
    s_add_u32 s36, s37, 144384
    s_mov_b32 m0, s36
    s_nop 0
    buffer_load_dwordx4 v6, s[60:63], s36 offen lds
    s_cmp_ge_u32 s39, 3
    s_cbranch_scc1 L_kvt_156
    s_add_u32 s36, s37, 148480
    s_mov_b32 m0, s36
    s_nop 0
    buffer_load_dwordx4 v6, s[60:63], s36 offen lds
L_kvt_156:
    v_and_b32 v8, 31, v0
    v_lshlrev_b32 v8, 2, v8
    s_lshl_b32 s36, s34, 10
    s_add_u32 s36, s36, 198784
    v_add_u32 v8, s36, v8
    s_cmp_lg_u32 s39, 1
    s_cbranch_scc1 L_nokn_157
    s_mov_b32 s80, 0
L_knp_158:
    buffer_load_dword v9, v8, s[52:55], 0 offen sc1
    s_waitcnt vmcnt(0)
    v_cmp_eq_u32 vcc, 0, v9
    s_nop 1
    s_cmp_eq_u64 vcc, 0
    s_cbranch_scc1 L_knd_159
    s_sleep 4
    s_add_u32 s80, s80, 1
    s_cmp_lt_u32 s80, 0x40000
    s_cbranch_scc1 L_knp_158
L_knd_159:
    v_max_f32_dpp v9, v9, v9 row_ror:1 row_mask:0xf bank_mask:0xf
    s_nop 1
    v_max_f32_dpp v9, v9, v9 row_ror:2 row_mask:0xf bank_mask:0xf
    s_nop 1
    v_max_f32_dpp v9, v9, v9 row_ror:4 row_mask:0xf bank_mask:0xf
    s_nop 1
    v_max_f32_dpp v9, v9, v9 row_ror:8 row_mask:0xf bank_mask:0xf
    s_nop 0
    v_readlane_b32 s80, v9, 0
    v_readlane_b32 s81, v9, 16
    s_nop 0
    s_max_u32 s80, s80, s81
    v_mov_b32 v8, 163632
    v_mov_b32 v9, s80
    ds_write_b32 v8, v9
L_nokn_157:
    s_waitcnt vmcnt(0)
    s_cmp_lg_u32 s39, 0
    s_cbranch_scc1 L_nosel_160
    v_max_u32 v8, v148, v149
    v_min_u32 v9, v148, v149
    v_med3_u32 v9, v8, v9, v150
    v_max_u32 v8, v8, v150
    v_med3_u32 v9, v8, v9, v151
    v_max_u32 v8, v8, v151
    v_mov_b32 v10, v8
    s_nop 1
    v_max_u32_dpp v10, v10, v10 row_ror:1 row_mask:0xf bank_mask:0xf
    s_nop 1
    v_max_u32_dpp v10, v10, v10 row_ror:2 row_mask:0xf bank_mask:0xf
    s_nop 1
    v_max_u32_dpp v10, v10, v10 row_ror:4 row_mask:0xf bank_mask:0xf
    s_nop 1
    v_max_u32_dpp v10, v10, v10 row_ror:8 row_mask:0xf bank_mask:0xf
    s_nop 0
    v_readlane_b32 s80, v10, 0
    v_readlane_b32 s36, v10, 16
    s_nop 0
    s_max_u32 s80, s80, s36
    v_readlane_b32 s36, v10, 32
    s_nop 0
    s_max_u32 s80, s80, s36
    v_readlane_b32 s36, v10, 48
    s_nop 0
    s_max_u32 s80, s80, s36
    v_cmp_eq_u32 vcc, s80, v8
    s_nop 1
    v_cndmask_b32 v8, v8, v9, vcc
    v_mov_b32 v10, v8
    s_nop 1
    v_max_u32_dpp v10, v10, v10 row_ror:1 row_mask:0xf bank_mask:0xf
    s_nop 1
    v_max_u32_dpp v10, v10, v10 row_ror:2 row_mask:0xf bank_mask:0xf
    s_nop 1
    v_max_u32_dpp v10, v10, v10 row_ror:4 row_mask:0xf bank_mask:0xf
    s_nop 1
    v_max_u32_dpp v10, v10, v10 row_ror:8 row_mask:0xf bank_mask:0xf
    s_nop 0
    v_readlane_b32 s81, v10, 0
    v_readlane_b32 s36, v10, 16
    s_nop 0
    s_max_u32 s81, s81, s36
    v_readlane_b32 s36, v10, 32
    s_nop 0
    s_max_u32 s81, s81, s36
    v_readlane_b32 s36, v10, 48
    s_nop 0
    s_max_u32 s81, s81, s36
    v_mov_b32 v8, s80
    v_mov_b32 v9, s81
    v_cmp_eq_u32 vcc, 1, v0
    s_nop 1
    v_cndmask_b32 v8, v8, v9, vcc
    v_lshrrev_b32 v9, 16, v8
    v_xor_b32 v10, 0x8000, v9
    v_xor_b32 v11, 0xffff, v9
    v_cmp_lt_u32 vcc, 0x7fff, v9
    s_nop 1
    v_cndmask_b32 v9, v11, v10, vcc
    v_lshlrev_b32 v9, 16, v9
    v_mul_f32 v9, 0xbfb8aa3b, v9
    v_exp_f32 v9, v9
    s_nop 0
    v_add_f32 v9, 1.0, v9
    v_rcp_f32 v9, v9
    s_nop 0
    v_cvt_pk_bf16_f32 v9, v9, v9
    v_and_b32 v9, 0xffff0000, v9
    v_and_b32 v8, 0xffff, v8
    v_sub_u32 v8, 0xffff, v8
    v_min_u32 v8, 2047, v8
    v_lshlrev_b32 v10, 2, v0
    v_add_u32 v10, 163616, v10
    v_cmp_gt_u32 vcc, 2, v0
    s_nop 0
    s_and_saveexec_b64 s[76:77], vcc
    ds_write_b32 v10, v8
    ds_write_b32 v10, v9 offset:8
    s_mov_b64 exec, s[76:77]
L_nosel_160:
    s_waitcnt vmcnt(0) lgkmcnt(0)
    s_barrier
    v_mov_b32 v8, 163616
    ds_read_b64 v[10:11], v8
    s_waitcnt lgkmcnt(0)
    v_readfirstlane_b32 s42, v10
    v_readfirstlane_b32 s43, v11
    s_cmp_lt_u32 s35, 3
    s_cbranch_scc1 L_noffn_161
    s_lshr_b32 s36, s2, 6
    s_mul_i32 s36, s36, 5
    s_add_u32 s36, s36, s35
    s_sub_u32 s36, s36, 3
    s_cmp_ge_u32 s36, 18
    s_cbranch_scc1 L_noffn_161
    s_and_b32 s37, s2, 7
    s_mul_i32 s37, s37, 18
    s_add_u32 s86, s37, s36
    v_and_b32 v22, 15, v0
    v_lshrrev_b32 v23, 4, v0
    s_and_b32 s84, s39, 1
    s_lshr_b32 s85, s39, 1
    s_cmp_eq_u32 s84, 0
    s_cselect_b32 s56, s18, s20
    s_cselect_b32 s57, s19, s21
    s_and_b32 s57, s57, 0xffff
    s_mov_b32 s58, 5308416
    s_mov_b32 s59, 0x20000
    s_mov_b32 s72, s22
    s_and_b32 s73, s23, 0xffff
    s_mov_b32 s74, 5308416
    s_mov_b32 s75, 0x20000
    v_lshrrev_b32 v8, 2, v0
    v_and_b32 v9, 3, v0
    v_lshlrev_b32 v9, 4, v9
    v_mul_u32_u24 v10, 1152, v8
    v_add_u32 v10, v10, v9
    v_mul_u32_u24 v8, 9216, v8
    v_add_u32 v8, v8, v9
    s_mul_i32 s36, s85, 2654208
    s_lshl_b32 s37, s86, 6
    s_add_u32 s36, s36, s37
    buffer_load_dwordx4 v[24:27], v8, s[56:59], s36 offen
    s_add_u32 s36, s36, 147456
    buffer_load_dwordx4 v[28:31], v8, s[56:59], s36 offen
    s_add_u32 s36, s36, 147456
    buffer_load_dwordx4 v[32:35], v8, s[56:59], s36 offen
    s_add_u32 s36, s36, 147456
    buffer_load_dwordx4 v[36:39], v8, s[56:59], s36 offen
    s_add_u32 s36, s36, 147456
    buffer_load_dwordx4 v[40:43], v8, s[56:59], s36 offen
    s_add_u32 s36, s36, 147456
    buffer_load_dwordx4 v[44:47], v8, s[56:59], s36 offen
    s_add_u32 s36, s36, 147456
    buffer_load_dwordx4 v[48:51], v8, s[56:59], s36 offen
    s_add_u32 s36, s36, 147456
    buffer_load_dwordx4 v[52:55], v8, s[56:59], s36 offen
    s_add_u32 s36, s36, 147456
    buffer_load_dwordx4 v[56:59], v8, s[56:59], s36 offen
    s_add_u32 s36, s36, 147456
    buffer_load_dwordx4 v[60:63], v8, s[56:59], s36 offen
    s_add_u32 s36, s36, 147456
    buffer_load_dwordx4 v[64:67], v8, s[56:59], s36 offen
    s_add_u32 s36, s36, 147456
    buffer_load_dwordx4 v[68:71], v8, s[56:59], s36 offen
    s_add_u32 s36, s36, 147456
    buffer_load_dwordx4 v[72:75], v8, s[56:59], s36 offen
    s_add_u32 s36, s36, 147456
    buffer_load_dwordx4 v[76:79], v8, s[56:59], s36 offen
    s_add_u32 s36, s36, 147456
    buffer_load_dwordx4 v[80:83], v8, s[56:59], s36 offen
    s_add_u32 s36, s36, 147456
    buffer_load_dwordx4 v[84:87], v8, s[56:59], s36 offen
    s_add_u32 s36, s36, 147456
    buffer_load_dwordx4 v[88:91], v8, s[56:59], s36 offen
    s_add_u32 s36, s36, 147456
    buffer_load_dwordx4 v[92:95], v8, s[56:59], s36 offen
    s_add_u32 s36, s36, 147456
    v_mov_b32 v8, s42
    v_mov_b32 v9, s43
    v_cmp_eq_u32 vcc, 1, v22
    s_nop 1
    v_cndmask_b32 v8, v8, v9, vcc
    v_mul_u32_u24 v8, 1152, v8
    v_lshl_add_u32 v8, v23, 4, v8
    s_mul_i32 s36, s85, 576
    buffer_load_dwordx4 v[96:99], v8, s[44:47], s36 offen offset:0
    buffer_load_dwordx4 v[100:103], v8, s[44:47], s36 offen offset:64
    buffer_load_dwordx4 v[104:107], v8, s[44:47], s36 offen offset:128
    buffer_load_dwordx4 v[108:111], v8, s[44:47], s36 offen offset:192
    buffer_load_dwordx4 v[112:115], v8, s[44:47], s36 offen offset:256
    buffer_load_dwordx4 v[116:119], v8, s[44:47], s36 offen offset:320
    buffer_load_dwordx4 v[120:123], v8, s[44:47], s36 offen offset:384
    buffer_load_dwordx4 v[124:127], v8, s[44:47], s36 offen offset:448
    buffer_load_dwordx4 v[128:131], v8, s[44:47], s36 offen offset:512
    s_lshl_b32 s36, s39, 11
    s_add_u32 s36, s36, 151552
    v_add_u32 v11, s36, v6
    v_bfe_u32 v13, v0, 2, 2
    v_lshl_add_u32 v13, v23, 3, v13
    v_and_b32 v14, 3, v0
    v_lshlrev_b32 v14, 3, v14
    v_lshl_add_u32 v12, v13, 6, v14
    v_add_u32 v12, s36, v12
    s_waitcnt vmcnt(0)
    ds_write_b128 v11, v[24:27]
    ds_write_b128 v11, v[28:31] offset:1024
    s_waitcnt lgkmcnt(0)
    ds_read_b64_tr_b16 v[152:153], v12 offset:0
    ds_read_b64_tr_b16 v[154:155], v12 offset:256
    ds_read_b64_tr_b16 v[156:157], v12 offset:32
    ds_read_b64_tr_b16 v[158:159], v12 offset:288
    s_waitcnt lgkmcnt(0)
    v_mfma_f32_16x16x32_bf16 v[160:163], v[152:155], v[96:99], 0
    v_mfma_f32_16x16x32_bf16 v[164:167], v[156:159], v[96:99], 0
    ds_write_b128 v11, v[32:35]
    ds_write_b128 v11, v[36:39] offset:1024
    s_waitcnt lgkmcnt(0)
    ds_read_b64_tr_b16 v[152:153], v12 offset:0
    ds_read_b64_tr_b16 v[154:155], v12 offset:256
    ds_read_b64_tr_b16 v[156:157], v12 offset:32
    ds_read_b64_tr_b16 v[158:159], v12 offset:288
    s_waitcnt lgkmcnt(0)
    v_mfma_f32_16x16x32_bf16 v[160:163], v[152:155], v[100:103], v[160:163]
    v_mfma_f32_16x16x32_bf16 v[164:167], v[156:159], v[100:103], v[164:167]
    ds_write_b128 v11, v[40:43]
    ds_write_b128 v11, v[44:47] offset:1024
    s_waitcnt lgkmcnt(0)
    ds_read_b64_tr_b16 v[152:153], v12 offset:0
    ds_read_b64_tr_b16 v[154:155], v12 offset:256
    ds_read_b64_tr_b16 v[156:157], v12 offset:32
    ds_read_b64_tr_b16 v[158:159], v12 offset:288
    s_waitcnt lgkmcnt(0)
    v_mfma_f32_16x16x32_bf16 v[160:163], v[152:155], v[104:107], v[160:163]
    v_mfma_f32_16x16x32_bf16 v[164:167], v[156:159], v[104:107], v[164:167]
    ds_write_b128 v11, v[48:51]
    ds_write_b128 v11, v[52:55] offset:1024
    s_waitcnt lgkmcnt(0)
    ds_read_b64_tr_b16 v[152:153], v12 offset:0
    ds_read_b64_tr_b16 v[154:155], v12 offset:256
    ds_read_b64_tr_b16 v[156:157], v12 offset:32
    ds_read_b64_tr_b16 v[158:159], v12 offset:288
    s_waitcnt lgkmcnt(0)
    v_mfma_f32_16x16x32_bf16 v[160:163], v[152:155], v[108:111], v[160:163]
    v_mfma_f32_16x16x32_bf16 v[164:167], v[156:159], v[108:111], v[164:167]
    ds_write_b128 v11, v[56:59]
    ds_write_b128 v11, v[60:63] offset:1024
    s_waitcnt lgkmcnt(0)
    ds_read_b64_tr_b16 v[152:153], v12 offset:0
    ds_read_b64_tr_b16 v[154:155], v12 offset:256
    ds_read_b64_tr_b16 v[156:157], v12 offset:32
    ds_read_b64_tr_b16 v[158:159], v12 offset:288
    s_waitcnt lgkmcnt(0)
    v_mfma_f32_16x16x32_bf16 v[160:163], v[152:155], v[112:115], v[160:163]
    v_mfma_f32_16x16x32_bf16 v[164:167], v[156:159], v[112:115], v[164:167]
    s_mul_i32 s36, s86, 36864
    s_mul_i32 s37, s39, 288
    s_add_u32 s36, s36, s37
    s_add_u32 s37, s36, 18432
    buffer_load_dwordx4 v[24:27], v10, s[72:75], s36 offen offset:0
    buffer_load_dwordx4 v[28:31], v10, s[72:75], s37 offen offset:0
    buffer_load_dwordx4 v[32:35], v10, s[72:75], s36 offen offset:64
    buffer_load_dwordx4 v[36:39], v10, s[72:75], s37 offen offset:64
    buffer_load_dwordx4 v[40:43], v10, s[72:75], s36 offen offset:128
    buffer_load_dwordx4 v[44:47], v10, s[72:75], s37 offen offset:128
    buffer_load_dwordx4 v[48:51], v10, s[72:75], s36 offen offset:192
    buffer_load_dwordx4 v[52:55], v10, s[72:75], s37 offen offset:192
    buffer_load_dwordx4 v[56:59], v10, s[72:75], s36 offen offset:256
    buffer_load_dwordx4 v[60:63], v10, s[72:75], s37 offen offset:256
    ds_write_b128 v11, v[64:67]
    ds_write_b128 v11, v[68:71] offset:1024
    s_waitcnt lgkmcnt(0)
    ds_read_b64_tr_b16 v[152:153], v12 offset:0
    ds_read_b64_tr_b16 v[154:155], v12 offset:256
    ds_read_b64_tr_b16 v[156:157], v12 offset:32
    ds_read_b64_tr_b16 v[158:159], v12 offset:288
    s_waitcnt lgkmcnt(0)
    v_mfma_f32_16x16x32_bf16 v[160:163], v[152:155], v[116:119], v[160:163]
    v_mfma_f32_16x16x32_bf16 v[164:167], v[156:159], v[116:119], v[164:167]
    ds_write_b128 v11, v[72:75]
    ds_write_b128 v11, v[76:79] offset:1024
    s_waitcnt lgkmcnt(0)
    ds_read_b64_tr_b16 v[152:153], v12 offset:0
    ds_read_b64_tr_b16 v[154:155], v12 offset:256
    ds_read_b64_tr_b16 v[156:157], v12 offset:32
    ds_read_b64_tr_b16 v[158:159], v12 offset:288
    s_waitcnt lgkmcnt(0)
    v_mfma_f32_16x16x32_bf16 v[160:163], v[152:155], v[120:123], v[160:163]
    v_mfma_f32_16x16x32_bf16 v[164:167], v[156:159], v[120:123], v[164:167]
    ds_write_b128 v11, v[80:83]
    ds_write_b128 v11, v[84:87] offset:1024
    s_waitcnt lgkmcnt(0)
    ds_read_b64_tr_b16 v[152:153], v12 offset:0
    ds_read_b64_tr_b16 v[154:155], v12 offset:256
    ds_read_b64_tr_b16 v[156:157], v12 offset:32
    ds_read_b64_tr_b16 v[158:159], v12 offset:288
    s_waitcnt lgkmcnt(0)
    v_mfma_f32_16x16x32_bf16 v[160:163], v[152:155], v[124:127], v[160:163]
    v_mfma_f32_16x16x32_bf16 v[164:167], v[156:159], v[124:127], v[164:167]
    ds_write_b128 v11, v[88:91]
    ds_write_b128 v11, v[92:95] offset:1024
    s_waitcnt lgkmcnt(0)
    ds_read_b64_tr_b16 v[152:153], v12 offset:0
    ds_read_b64_tr_b16 v[154:155], v12 offset:256
    ds_read_b64_tr_b16 v[156:157], v12 offset:32
    ds_read_b64_tr_b16 v[158:159], v12 offset:288
    s_waitcnt lgkmcnt(0)
    v_mfma_f32_16x16x32_bf16 v[160:163], v[152:155], v[128:131], v[160:163]
    v_mfma_f32_16x16x32_bf16 v[164:167], v[156:159], v[128:131], v[164:167]
    s_nop 7
    v_lshlrev_b32 v13, 1, v23
    v_add_u32 v13, v13, v22
    v_lshlrev_b32 v13, 4, v13
    v_add_u32 v15, 159744, v13
    s_lshl_b32 s36, s39, 8
    v_add_u32 v14, s36, v15
    v_cmp_gt_u32 vcc, 2, v22
    s_nop 0
    s_and_saveexec_b64 s[76:77], vcc
    ds_write_b128 v14, v[160:163]
    ds_write_b128 v14, v[164:167] offset:128
    s_mov_b64 exec, s[76:77]
    s_waitcnt lgkmcnt(0)
    v_mov_b32 v20, 163584
    v_mov_b32 v21, 1
    s_mov_b64 s[76:77], exec
    s_mov_b64 exec, 1
    ds_add_u32 v20, v21
    s_mov_b64 exec, s[76:77]
    s_mov_b32 s80, 0
L_hs0_162:
    ds_read_b32 v21, v20
    s_waitcnt lgkmcnt(0)
    v_readfirstlane_b32 s81, v21
    s_nop 0
    s_cmp_ge_u32 s81, 4
    s_cbranch_scc1 L_hs0d_163
    s_sleep 1
    s_add_u32 s80, s80, 1
    s_cmp_lt_u32 s80, 0x100000
    s_cbranch_scc1 L_hs0_162
L_hs0d_163:
    s_cmp_lg_u32 s39, 3
    s_cbranch_scc1 L_noh_164
    v_lshrrev_b32 v13, 5, v0
    v_bfe_u32 v14, v0, 4, 1
    v_bfe_u32 v15, v0, 2, 2
    v_and_b32 v16, 3, v0
    v_lshl_add_u32 v15, v15, 1, v13
    v_lshlrev_b32 v15, 4, v15
    v_lshl_add_u32 v15, v14, 7, v15
    v_lshl_add_u32 v15, v16, 2, v15
    v_add_u32 v15, 159744, v15
    ds_read_b32 v96, v15 offset:0
    ds_read_b32 v97, v15 offset:256
    ds_read_b32 v98, v15 offset:512
    ds_read_b32 v99, v15 offset:768
    v_lshlrev_b32 v14, 1, v0
    v_add_u32 v14, 160768, v14
    s_waitcnt lgkmcnt(0)
    v_add_f32 v96, v96, v98
    v_add_f32 v97, v97, v99
    v_cvt_pk_bf16_f32 v96, v96, v97
    v_and_b32 v97, 0xffff0000, v96
    v_lshlrev_b32 v96, 16, v96
    v_mul_f32 v100, 0xbfb8aa3b, v96
    v_exp_f32 v100, v100
    s_nop 0
    v_add_f32 v100, 1.0, v100
    v_rcp_f32 v100, v100
    s_nop 0
    v_mul_f32 v96, v96, v100
    v_cvt_pk_bf16_f32 v96, v96, v96
    v_and_b32 v96, 0xffff0000, v96
    v_mul_f32 v96, v96, v97
    v_cvt_pk_bf16_f32 v96, v96, v96
    ds_write_b16 v14, v96
L_noh_164:
    s_waitcnt lgkmcnt(0)
    v_mov_b32 v20, 163588
    v_mov_b32 v21, 1
    s_mov_b64 s[76:77], exec
    s_mov_b64 exec, 1
    ds_add_u32 v20, v21
    s_mov_b64 exec, s[76:77]
    s_mov_b32 s80, 0
L_hs1_165:
    ds_read_b32 v21, v20
    s_waitcnt lgkmcnt(0)
    v_readfirstlane_b32 s81, v21
    s_nop 0
    s_cmp_ge_u32 s81, 4
    s_cbranch_scc1 L_hs1d_166
    s_sleep 1
    s_add_u32 s80, s80, 1
    s_cmp_lt_u32 s80, 0x100000
    s_cbranch_scc1 L_hs1_165
L_hs1d_166:
    v_and_b32 v13, 3, v22
    v_lshrrev_b32 v14, 2, v22
    v_lshlrev_b32 v15, 6, v13
    v_lshl_add_u32 v15, v23, 4, v15
    v_add_u32 v15, 160768, v15
    v_mov_b32 v16, 196608
    v_cmp_gt_u32 vcc, 2, v13
    s_nop 1
    v_cndmask_b32 v15, v16, v15, vcc
    v_cmp_eq_u32 vcc, 0, v14
    s_nop 1
    v_cndmask_b32 v13, v16, v15, vcc
    ds_read_b128 v[112:115], v13
    v_cmp_eq_u32 vcc, 1, v14
    s_nop 1
    v_cndmask_b32 v13, v16, v15, vcc
    ds_read_b128 v[116:119], v13
    v_cmp_eq_u32 vcc, 2, v14
    s_nop 1
    v_cndmask_b32 v13, v16, v15, vcc
    ds_read_b128 v[120:123], v13
    v_cmp_eq_u32 vcc, 3, v14
    s_nop 1
    v_cndmask_b32 v13, v16, v15, vcc
    ds_read_b128 v[124:127], v13
    s_waitcnt vmcnt(0)
    ds_write_b128 v11, v[24:27]
    ds_write_b128 v11, v[28:31] offset:1024
    s_waitcnt lgkmcnt(0)
    ds_read_b64_tr_b16 v[152:153], v12 offset:0
    ds_read_b64_tr_b16 v[154:155], v12 offset:256
    ds_read_b64_tr_b16 v[156:157], v12 offset:32
    ds_read_b64_tr_b16 v[158:159], v12 offset:288
    s_waitcnt lgkmcnt(0)
    v_mfma_f32_16x16x32_bf16 v[96:99], v[112:115], v[152:155], 0
    v_mfma_f32_16x16x32_bf16 v[96:99], v[116:119], v[156:159], v[96:99]
    ds_write_b128 v11, v[32:35]
    ds_write_b128 v11, v[36:39] offset:1024
    s_waitcnt lgkmcnt(0)
    ds_read_b64_tr_b16 v[152:153], v12 offset:0
    ds_read_b64_tr_b16 v[154:155], v12 offset:256
    ds_read_b64_tr_b16 v[156:157], v12 offset:32
    ds_read_b64_tr_b16 v[158:159], v12 offset:288
    s_waitcnt lgkmcnt(0)
    v_mfma_f32_16x16x32_bf16 v[96:99], v[120:123], v[152:155], v[96:99]
    v_mfma_f32_16x16x32_bf16 v[96:99], v[124:127], v[156:159], v[96:99]
    ds_write_b128 v11, v[40:43]
    ds_write_b128 v11, v[44:47] offset:1024
    s_waitcnt lgkmcnt(0)
    ds_read_b64_tr_b16 v[152:153], v12 offset:0
    ds_read_b64_tr_b16 v[154:155], v12 offset:256
    ds_read_b64_tr_b16 v[156:157], v12 offset:32
    ds_read_b64_tr_b16 v[158:159], v12 offset:288
    s_waitcnt lgkmcnt(0)
    v_mfma_f32_16x16x32_bf16 v[100:103], v[112:115], v[152:155], 0
    v_mfma_f32_16x16x32_bf16 v[100:103], v[116:119], v[156:159], v[100:103]
    ds_write_b128 v11, v[48:51]
    ds_write_b128 v11, v[52:55] offset:1024
    s_waitcnt lgkmcnt(0)
    ds_read_b64_tr_b16 v[152:153], v12 offset:0
    ds_read_b64_tr_b16 v[154:155], v12 offset:256
    ds_read_b64_tr_b16 v[156:157], v12 offset:32
    ds_read_b64_tr_b16 v[158:159], v12 offset:288
    s_waitcnt lgkmcnt(0)
    v_mfma_f32_16x16x32_bf16 v[100:103], v[120:123], v[152:155], v[100:103]
    v_mfma_f32_16x16x32_bf16 v[100:103], v[124:127], v[156:159], v[100:103]
    ds_write_b128 v11, v[56:59]
    ds_write_b128 v11, v[60:63] offset:1024
    s_waitcnt lgkmcnt(0)
    ds_read_b64_tr_b16 v[152:153], v12 offset:0
    ds_read_b64_tr_b16 v[154:155], v12 offset:256
    s_waitcnt lgkmcnt(0)
    v_mfma_f32_16x16x32_bf16 v[104:107], v[112:115], v[152:155], 0
    s_nop 7
    s_and_b32 s36, s2, 7
    s_mul_i32 s36, s36, 4608
    s_mul_i32 s37, s39, 576
    s_add_u32 s36, s36, s37
    s_add_u32 s36, s36, 161024
    s_add_u32 s37, s36, 2304
    v_lshlrev_b32 v13, 2, v0
    buffer_atomic_add_f32 v96, v13, s[52:55], s36 offen offset:0
    buffer_atomic_add_f32 v97, v13, s[52:55], s37 offen offset:0
    buffer_atomic_add_f32 v100, v13, s[52:55], s36 offen offset:256
    buffer_atomic_add_f32 v101, v13, s[52:55], s37 offen offset:256
    s_mov_b64 exec, 0xffff
    buffer_atomic_add_f32 v104, v13, s[52:55], s36 offen offset:512
    buffer_atomic_add_f32 v105, v13, s[52:55], s37 offen offset:512
    s_mov_b64 exec, -1
    s_waitcnt vmcnt(0)
    s_waitcnt lgkmcnt(0)
    v_mov_b32 v20, 163592
    v_mov_b32 v21, 1
    s_mov_b64 s[76:77], exec
    s_mov_b64 exec, 1
    ds_add_u32 v20, v21
    s_mov_b64 exec, s[76:77]
    s_mov_b32 s80, 0
L_hs2_167:
    ds_read_b32 v21, v20
    s_waitcnt lgkmcnt(0)
    v_readfirstlane_b32 s81, v21
    s_nop 0
    s_cmp_ge_u32 s81, 4
    s_cbranch_scc1 L_hs2d_168
    s_sleep 1
    s_add_u32 s80, s80, 1
    s_cmp_lt_u32 s80, 0x100000
    s_cbranch_scc1 L_hs2_167
L_hs2d_168:
    s_cmp_lg_u32 s39, 0
    s_cbranch_scc1 L_nof_169
    v_mov_b32 v8, 230656
    v_mov_b32 v9, 1
    s_mov_b64 exec, 1
    buffer_atomic_add v9, v8, s[52:55], 0 offen sc1
    s_mov_b64 exec, -1
L_nof_169:
L_noffn_161:
    s_mov_b32 s48, s12
    s_and_b32 s49, s13, 0xffff
    s_mov_b32 s50, 663552
    s_mov_b32 s51, 0x20000
    s_add_u32 s44, s30, 233472
    s_addc_u32 s45, s31, 0
    s_and_b32 s45, s45, 0xffff
    s_mov_b32 s46, 2359296
    s_mov_b32 s47, 0x20000
    v_mov_b32 v20, 163596
    s_mov_b32 s80, 0
L_rel_170:
    ds_read_b32 v21, v20
    s_waitcnt lgkmcnt(0)
    v_readfirstlane_b32 s81, v21
    s_nop 0
    s_cmp_ge_u32 s81, 512
    s_cbranch_scc1 L_reld_171
    s_sleep 16
    s_add_u32 s80, s80, 1
    s_cmp_lt_u32 s80, 0x400000
    s_cbranch_scc1 L_rel_170
L_reld_171:
    s_mul_i32 s36, s35, 144
    s_add_u32 s36, s36, 0
    s_lshl_b32 s37, s39, 11
    s_add_u32 m0, s37, 0
    s_nop 0
    buffer_load_dwordx4 v3, s[48:51], s36 offen lds
    s_lshl_b32 s37, s39, 11
    s_add_u32 m0, s37, 1024
    s_nop 0
    buffer_load_dwordx4 v4, s[48:51], s36 offen lds
    s_mov_b32 m0, 8192
    s_nop 0
    buffer_load_dwordx4 v5, s[48:51], s36 offen lds
    s_mul_i32 s36, s35, 144
    s_add_u32 s36, s36, 73728
    s_lshl_b32 s37, s39, 11
    s_add_u32 m0, s37, 9216
    s_nop 0
    buffer_load_dwordx4 v3, s[48:51], s36 offen lds
    s_lshl_b32 s37, s39, 11
    s_add_u32 m0, s37, 10240
    s_nop 0
    buffer_load_dwordx4 v4, s[48:51], s36 offen lds
    s_mov_b32 m0, 17408
    s_nop 0
    buffer_load_dwordx4 v5, s[48:51], s36 offen lds
    s_mul_i32 s36, s35, 144
    s_add_u32 s36, s36, 147456
    s_lshl_b32 s37, s39, 11
    s_add_u32 m0, s37, 18432
    s_nop 0
    buffer_load_dwordx4 v3, s[48:51], s36 offen lds
    s_lshl_b32 s37, s39, 11
    s_add_u32 m0, s37, 19456
    s_nop 0
    buffer_load_dwordx4 v4, s[48:51], s36 offen lds
    s_mov_b32 m0, 26624
    s_nop 0
    buffer_load_dwordx4 v5, s[48:51], s36 offen lds
    s_mul_i32 s36, s35, 144
    s_add_u32 s36, s36, 221184
    s_lshl_b32 s37, s39, 11
    s_add_u32 m0, s37, 27648
    s_nop 0
    buffer_load_dwordx4 v3, s[48:51], s36 offen lds
    s_lshl_b32 s37, s39, 11
    s_add_u32 m0, s37, 28672
    s_nop 0
    buffer_load_dwordx4 v4, s[48:51], s36 offen lds
    s_mov_b32 m0, 35840
    s_nop 0
    buffer_load_dwordx4 v5, s[48:51], s36 offen lds
    s_mul_i32 s36, s35, 144
    s_add_u32 s36, s36, 294912
    s_lshl_b32 s37, s39, 11
    s_add_u32 m0, s37, 36864
    s_nop 0
    buffer_load_dwordx4 v3, s[48:51], s36 offen lds
    s_lshl_b32 s37, s39, 11
    s_add_u32 m0, s37, 37888
    s_nop 0
    buffer_load_dwordx4 v4, s[48:51], s36 offen lds
    s_mov_b32 m0, 45056
    s_nop 0
    buffer_load_dwordx4 v5, s[48:51], s36 offen lds
    s_mul_i32 s36, s35, 144
    s_add_u32 s36, s36, 368640
    s_lshl_b32 s37, s39, 11
    s_add_u32 m0, s37, 46080
    s_nop 0
    buffer_load_dwordx4 v3, s[48:51], s36 offen lds
    s_lshl_b32 s37, s39, 11
    s_add_u32 m0, s37, 47104
    s_nop 0
    buffer_load_dwordx4 v4, s[48:51], s36 offen lds
    s_mov_b32 m0, 54272
    s_nop 0
    buffer_load_dwordx4 v5, s[48:51], s36 offen lds
    s_mul_i32 s36, s35, 144
    s_add_u32 s36, s36, 442368
    s_lshl_b32 s37, s39, 11
    s_add_u32 m0, s37, 55296
    s_nop 0
    buffer_load_dwordx4 v3, s[48:51], s36 offen lds
    s_lshl_b32 s37, s39, 11
    s_add_u32 m0, s37, 56320
    s_nop 0
    buffer_load_dwordx4 v4, s[48:51], s36 offen lds
    s_mov_b32 m0, 63488
    s_nop 0
    buffer_load_dwordx4 v5, s[48:51], s36 offen lds
    s_mul_i32 s36, s35, 144
    s_add_u32 s36, s36, 516096
    s_lshl_b32 s37, s39, 11
    s_add_u32 m0, s37, 64512
    s_nop 0
    buffer_load_dwordx4 v3, s[48:51], s36 offen lds
    s_lshl_b32 s37, s39, 11
    s_add_u32 m0, s37, 65536
    s_nop 0
    buffer_load_dwordx4 v4, s[48:51], s36 offen lds
    s_mov_b32 m0, 72704
    s_nop 0
    buffer_load_dwordx4 v5, s[48:51], s36 offen lds
    s_mul_i32 s36, s35, 144
    s_add_u32 s36, s36, 589824
    s_lshl_b32 s37, s39, 11
    s_add_u32 m0, s37, 73728
    s_nop 0
    buffer_load_dwordx4 v3, s[48:51], s36 offen lds
    s_lshl_b32 s37, s39, 11
    s_add_u32 m0, s37, 74752
    s_nop 0
    buffer_load_dwordx4 v4, s[48:51], s36 offen lds
    s_mov_b32 m0, 81920
    s_nop 0
    buffer_load_dwordx4 v5, s[48:51], s36 offen lds
    s_cmp_lg_u32 s39, 1
    s_cbranch_scc1 L_noupd_172
    s_sub_u32 s84, s42, s41
    s_sub_u32 s85, s43, s41
    s_min_u32 s86, s84, s85
    s_cmp_lt_u32 s86, 64
    s_cbranch_scc0 L_noupd_172
    s_mov_b32 s80, 0
    v_mov_b32 v8, 230656
L_ypoll_173:
    buffer_load_dword v9, v8, s[52:55], 0 offen sc1
    s_waitcnt vmcnt(0)
    v_readfirstlane_b32 s81, v9
    s_nop 0
    s_cmp_ge_u32 s81, 144
    s_cbranch_scc1 L_ydone_174
    s_sleep 8
    s_add_u32 s80, s80, 1
    s_cmp_lt_u32 s80, 0x40000
    s_cbranch_scc1 L_ypoll_173
L_ydone_174:
    v_lshlrev_b32 v8, 3, v0
    s_mul_i32 s36, s35, 288
    s_add_u32 s36, s36, 161024
    v_mov_b32 v10, 163624
    ds_read_b64 v[12:13], v10
    v_cmp_gt_u32 vcc, 36, v0
    s_nop 0
    s_and_saveexec_b64 s[76:77], vcc
    s_add_u32 s37, s36, 0
    buffer_load_dwordx2 v[24:25], v8, s[52:55], s37 offen sc1
    s_add_u32 s37, s36, 4608
    buffer_load_dwordx2 v[26:27], v8, s[52:55], s37 offen sc1
    s_add_u32 s37, s36, 9216
    buffer_load_dwordx2 v[28:29], v8, s[52:55], s37 offen sc1
    s_add_u32 s37, s36, 13824
    buffer_load_dwordx2 v[30:31], v8, s[52:55], s37 offen sc1
    s_add_u32 s37, s36, 18432
    buffer_load_dwordx2 v[32:33], v8, s[52:55], s37 offen sc1
    s_add_u32 s37, s36, 23040
    buffer_load_dwordx2 v[34:35], v8, s[52:55], s37 offen sc1
    s_add_u32 s37, s36, 27648
    buffer_load_dwordx2 v[36:37], v8, s[52:55], s37 offen sc1
    s_add_u32 s37, s36, 32256
    buffer_load_dwordx2 v[38:39], v8, s[52:55], s37 offen sc1
    s_add_u32 s37, s36, 2304
    buffer_load_dwordx2 v[40:41], v8, s[52:55], s37 offen sc1
    s_add_u32 s37, s36, 6912
    buffer_load_dwordx2 v[42:43], v8, s[52:55], s37 offen sc1
    s_add_u32 s37, s36, 11520
    buffer_load_dwordx2 v[44:45], v8, s[52:55], s37 offen sc1
    s_add_u32 s37, s36, 16128
    buffer_load_dwordx2 v[46:47], v8, s[52:55], s37 offen sc1
    s_add_u32 s37, s36, 20736
    buffer_load_dwordx2 v[48:49], v8, s[52:55], s37 offen sc1
    s_add_u32 s37, s36, 25344
    buffer_load_dwordx2 v[50:51], v8, s[52:55], s37 offen sc1
    s_add_u32 s37, s36, 29952
    buffer_load_dwordx2 v[52:53], v8, s[52:55], s37 offen sc1
    s_add_u32 s37, s36, 34560
    buffer_load_dwordx2 v[54:55], v8, s[52:55], s37 offen sc1
    s_waitcnt vmcnt(0) lgkmcnt(0)
    v_add_f32 v24, v24, v26
    v_add_f32 v25, v25, v27
    v_add_f32 v24, v24, v28
    v_add_f32 v25, v25, v29
    v_add_f32 v24, v24, v30
    v_add_f32 v25, v25, v31
    v_add_f32 v24, v24, v32
    v_add_f32 v25, v25, v33
    v_add_f32 v24, v24, v34
    v_add_f32 v25, v25, v35
    v_add_f32 v24, v24, v36
    v_add_f32 v25, v25, v37
    v_add_f32 v24, v24, v38
    v_add_f32 v25, v25, v39
    v_cvt_pk_bf16_f32 v24, v24, v24
    v_and_b32 v24, 0xffff0000, v24
    v_mul_f32 v24, v12, v24
    v_cvt_pk_bf16_f32 v24, v24, v24
    v_and_b32 v24, 0xffff0000, v24
    v_cvt_pk_bf16_f32 v25, v25, v25
    v_and_b32 v25, 0xffff0000, v25
    v_mul_f32 v25, v12, v25
    v_cvt_pk_bf16_f32 v25, v25, v25
    v_and_b32 v25, 0xffff0000, v25
    v_add_u32 v10, 160896, v8
    ds_write_b64 v10, v[24:25]
    v_add_f32 v40, v40, v42
    v_add_f32 v41, v41, v43
    v_add_f32 v40, v40, v44
    v_add_f32 v41, v41, v45
    v_add_f32 v40, v40, v46
    v_add_f32 v41, v41, v47
    v_add_f32 v40, v40, v48
    v_add_f32 v41, v41, v49
    v_add_f32 v40, v40, v50
    v_add_f32 v41, v41, v51
    v_add_f32 v40, v40, v52
    v_add_f32 v41, v41, v53
    v_add_f32 v40, v40, v54
    v_add_f32 v41, v41, v55
    v_cvt_pk_bf16_f32 v40, v40, v40
    v_and_b32 v40, 0xffff0000, v40
    v_mul_f32 v40, v13, v40
    v_cvt_pk_bf16_f32 v40, v40, v40
    v_and_b32 v40, 0xffff0000, v40
    v_cvt_pk_bf16_f32 v41, v41, v41
    v_and_b32 v41, 0xffff0000, v41
    v_mul_f32 v41, v13, v41
    v_cvt_pk_bf16_f32 v41, v41, v41
    v_and_b32 v41, 0xffff0000, v41
    v_add_u32 v10, 161184, v8
    ds_write_b64 v10, v[40:41]
    s_mov_b64 exec, -1
    s_waitcnt lgkmcnt(0)
L_noupd_172:
    s_waitcnt vmcnt(0)
    v_add_u32 v26, 512, v0
    v_lshlrev_b32 v24, 4, v26
    v_add_u32 v24, 115712, v24
    v_mul_u32_u24 v27, 7282, v26
    v_lshrrev_b32 v27, 16, v27
    v_mul_u32_u24 v28, 9, v27
    v_sub_u32 v28, v26, v28
    v_mul_u32_u24 v27, 1152, v27
    v_lshl_add_u32 v25, v28, 4, v27
    s_mul_i32 s84, s41, 1152
    s_mul_i32 s36, s35, 144
    s_add_u32 s84, s84, s36
    s_add_u32 s85, s84, 233472
    s_barrier
    s_barrier
    s_barrier
    s_cmp_lg_u32 s39, 1
    s_cbranch_scc1 L_no8_175
    ds_read_b128 v[28:31], v24
    s_waitcnt lgkmcnt(0)
    buffer_store_dwordx4 v[28:31], v25, s[52:55], s85 offen sc1
    s_waitcnt vmcnt(0)
L_no8_175:
    s_barrier
    s_cmp_lg_u32 s39, 0
    s_cbranch_scc1 L_grpskip_176
    s_mov_b32 s80, 0
    s_lshl_b32 s36, s34, 10
    s_add_u32 s36, s36, 198656
    v_mov_b32 v8, s36
L_grplp_177:
    buffer_load_dword v144, v8, s[52:55], 0 offen sc1
L_grpchk_179:
    s_waitcnt vmcnt(0)
    v_mov_b32 v10, 8
    v_cmp_le_u32 vcc, v10, v144
    s_nop 1
    s_not_b64 s[82:83], vcc
    s_cmp_eq_u64 s[82:83], 0
    s_cbranch_scc1 L_grpok_178
    s_sleep 1
    s_add_u32 s80, s80, 1
    s_cmp_lt_u32 s80, 0x80000
    s_cbranch_scc1 L_grplp_177
L_grpok_178:
L_grpskip_176:
    s_barrier
    s_mul_i32 s38, s41, 1152
    s_mul_i32 s36, s39, 18432
    s_add_u32 s36, s36, s38
    s_add_u32 s36, s36, 0
    s_lshl_b32 s37, s39, 11
    s_add_u32 m0, s37, 82944
    s_nop 0
    buffer_load_dwordx4 v1, s[44:47], s36 offen lds
    s_mul_i32 s36, s39, 18432
    s_add_u32 s36, s36, s38
    s_add_u32 s36, s36, 9216
    s_lshl_b32 s37, s39, 11
    s_add_u32 m0, s37, 83968
    s_nop 0
    buffer_load_dwordx4 v2, s[44:47], s36 offen lds
    s_mul_i32 s36, s39, 18432
    s_add_u32 s36, s36, s38
    s_add_u32 s36, s36, 128
    s_lshl_b32 s37, s39, 11
    s_add_u32 m0, s37, 91136
    s_nop 0
    buffer_load_dwordx4 v1, s[44:47], s36 offen lds
    s_mul_i32 s36, s39, 18432
    s_add_u32 s36, s36, s38
    s_add_u32 s36, s36, 9344
    s_lshl_b32 s37, s39, 11
    s_add_u32 m0, s37, 92160
    s_nop 0
    buffer_load_dwordx4 v2, s[44:47], s36 offen lds
    s_mul_i32 s36, s39, 18432
    s_add_u32 s36, s36, s38
    s_add_u32 s36, s36, 256
    s_lshl_b32 s37, s39, 11
    s_add_u32 m0, s37, 99328
    s_nop 0
    buffer_load_dwordx4 v1, s[44:47], s36 offen lds
    s_mul_i32 s36, s39, 18432
    s_add_u32 s36, s36, s38
    s_add_u32 s36, s36, 9472
    s_lshl_b32 s37, s39, 11
    s_add_u32 m0, s37, 100352
    s_nop 0
    buffer_load_dwordx4 v2, s[44:47], s36 offen lds
    s_mul_i32 s36, s39, 18432
    s_add_u32 s36, s36, s38
    s_add_u32 s36, s36, 384
    s_lshl_b32 s37, s39, 11
    s_add_u32 m0, s37, 107520
    s_nop 0
    buffer_load_dwordx4 v1, s[44:47], s36 offen lds
    s_mul_i32 s36, s39, 18432
    s_add_u32 s36, s36, s38
    s_add_u32 s36, s36, 9600
    s_lshl_b32 s37, s39, 11
    s_add_u32 m0, s37, 108544
    s_nop 0
    buffer_load_dwordx4 v2, s[44:47], s36 offen lds
    s_mul_i32 s36, s39, 18432
    s_add_u32 s36, s36, s38
    s_add_u32 s36, s36, 512
    s_lshl_b32 s37, s39, 11
    s_add_u32 m0, s37, 115712
    s_nop 0
    buffer_load_dwordx4 v1, s[44:47], s36 offen lds
    s_mul_i32 s36, s39, 18432
    s_add_u32 s36, s36, s38
    s_add_u32 s36, s36, 9728
    s_lshl_b32 s37, s39, 11
    s_add_u32 m0, s37, 116736
    s_nop 0
    buffer_load_dwordx4 v2, s[44:47], s36 offen lds
    s_mul_i32 s36, s39, 18432
    s_add_u32 s36, s36, s38
    s_add_u32 s36, s36, 640
    s_lshl_b32 s37, s39, 11
    s_add_u32 m0, s37, 123904
    s_nop 0
    buffer_load_dwordx4 v1, s[44:47], s36 offen lds
    s_mul_i32 s36, s39, 18432
    s_add_u32 s36, s36, s38
    s_add_u32 s36, s36, 9856
    s_lshl_b32 s37, s39, 11
    s_add_u32 m0, s37, 124928
    s_nop 0
    buffer_load_dwordx4 v2, s[44:47], s36 offen lds
    s_mul_i32 s36, s39, 18432
    s_add_u32 s36, s36, s38
    s_add_u32 s36, s36, 768
    s_lshl_b32 s37, s39, 11
    s_add_u32 m0, s37, 132096
    s_nop 0
    buffer_load_dwordx4 v1, s[44:47], s36 offen lds
    s_mul_i32 s36, s39, 18432
    s_add_u32 s36, s36, s38
    s_add_u32 s36, s36, 9984
    s_lshl_b32 s37, s39, 11
    s_add_u32 m0, s37, 133120
    s_nop 0
    buffer_load_dwordx4 v2, s[44:47], s36 offen lds
    s_mul_i32 s36, s39, 18432
    s_add_u32 s36, s36, s38
    s_add_u32 s36, s36, 896
    s_lshl_b32 s37, s39, 11
    s_add_u32 m0, s37, 140288
    s_nop 0
    buffer_load_dwordx4 v1, s[44:47], s36 offen lds
    s_mul_i32 s36, s39, 18432
    s_add_u32 s36, s36, s38
    s_add_u32 s36, s36, 10112
    s_lshl_b32 s37, s39, 11
    s_add_u32 m0, s37, 141312
    s_nop 0
    buffer_load_dwordx4 v2, s[44:47], s36 offen lds
    s_mul_i32 s36, s39, 18432
    s_add_u32 s36, s36, s38
    s_add_u32 s36, s36, 1024
    s_lshl_b32 s37, s39, 11
    s_add_u32 m0, s37, 148480
    s_nop 0
    buffer_load_dwordx4 v1, s[44:47], s36 offen lds
    s_mul_i32 s36, s39, 18432
    s_add_u32 s36, s36, s38
    s_add_u32 s36, s36, 10240
    s_lshl_b32 s37, s39, 11
    s_add_u32 m0, s37, 149504
    s_nop 0
    buffer_load_dwordx4 v2, s[44:47], s36 offen lds
    s_waitcnt vmcnt(14)
    s_barrier
    s_waitcnt vmcnt(8)
    s_barrier
    s_waitcnt vmcnt(0)
    s_barrier
    s_barrier
    s_cmp_lg_u32 s39, 1
    s_cbranch_scc1 L_no9_180
    v_subrev_u32 v24, 115712, v24
    ds_read_b128 v[28:31], v24
    s_waitcnt lgkmcnt(0)
    buffer_store_dwordx4 v[28:31], v25, s[64:67], s84 offen
L_no9_180:
    s_endpgm
L_end:
    s_endpgm
.section .rodata,"a"
.p2align 6
.amdhsa_kernel gated_mix__grouped_kv_mqa__moe_arch_mod__prompt_kernel
  .amdhsa_next_free_vgpr 168
  .amdhsa_next_free_sgpr 102
  .amdhsa_accum_offset 168
  .amdhsa_group_segment_fixed_size 0
  .amdhsa_kernarg_size 112
  .amdhsa_user_sgpr_count 2
  .amdhsa_user_sgpr_kernarg_segment_ptr 1
  .amdhsa_system_sgpr_workgroup_id_x 1
  .amdhsa_float_denorm_mode_32 3
.end_amdhsa_kernel
```
